```python
import torch

def _softmax(x, axis=-1):
    return torch.softmax(x, dim=axis)
def _gelu(x):
    return torch.nn.functional.gelu(x, approximate="tanh")
def _silu(x):
    return torch.nn.functional.silu(x)
def _sigmoid(x):
    return torch.sigmoid(x)
def _layernorm(x, axis=-1, eps=1e-5):
    m = x.mean(dim=axis, keepdim=True)
    v = x.var(dim=axis, keepdim=True, unbiased=False)
    return (x - m) / torch.sqrt(v + eps)
def _scatter_add(tgt, idx, src, axis=0):
    return tgt.clone().index_add_(axis, idx, src)
def _segment_sum(src, seg, n):
    out = torch.zeros((n,) + src.shape[1:], dtype=src.dtype)
    return out.index_add_(0, seg, src)
def _pad(x, pw):
    flat = tuple(v for pair in reversed(pw) for v in pair)
    return torch.nn.functional.pad(x, flat)

kernel_name = 'recurrent_scan__spectral_fnet__dense_activation_gelu__prompt'

def setup_inputs():

    _w = (lambda a: (lambda t: t.to(torch.bfloat16) if t.is_floating_point() else t)(torch.as_tensor(a)))
    def _A_setup():
        B, S, D = 1, 2048, 1024
        ns = torch.arange(S)[:, None] * torch.arange(S)[None, :]
        nd = torch.arange(D)[:, None] * torch.arange(D)[None, :]
        Ws_re = torch.cos(-2.0 * torch.pi * ns / S).to(float)
        Ws_im = torch.sin(-2.0 * torch.pi * ns / S).to(float)
        Wd_re = torch.cos(-2.0 * torch.pi * nd / D).to(float)
        Wd_im = torch.sin(-2.0 * torch.pi * nd / D).to(float)
        return {
            "x": _w((lambda *s: torch.randn(*s, dtype=torch.bfloat16) * 0.05)(B, S, D)),
            "dft_seq_re": _w(Ws_re),
            "dft_seq_im": _w(Ws_im),
            "dft_hid_re": _w(Wd_re),
            "dft_hid_im": _w(Wd_im),
        }
    _A_in = _A_setup()

    def _B_setup():
        B, S, D, F = 1, 2048, 1024, 3584
        return {
            "x": _w((lambda *s: torch.randn(*s, dtype=torch.bfloat16) * 0.05)(B, S, D)),
            "w1": _w((lambda *s: torch.randn(*s, dtype=torch.bfloat16) * 0.2)(D, F) * (D ** -0.5)),
            "b1": _w((lambda *s: torch.randn(*s, dtype=torch.bfloat16) * 3.2)(F) * 0.01),
            "w2": _w((lambda *s: torch.randn(*s, dtype=torch.bfloat16) * 0.05)(F, D) * (F ** -0.5)),
            "b2": _w((lambda *s: torch.randn(*s, dtype=torch.bfloat16) * 0.1)(D) * 0.01),
        }
    _B_in = _B_setup()

    return {
        "A_x": _A_in["x"],
        "A_dft_seq_re": _A_in["dft_seq_re"],
        "A_dft_seq_im": _A_in["dft_seq_im"],
        "A_dft_hid_re": _A_in["dft_hid_re"],
        "A_dft_hid_im": _A_in["dft_hid_im"],
        "B_x": _B_in["x"],
        "B_w1": _B_in["w1"],
        "B_b1": _B_in["b1"],
        "B_w2": _B_in["w2"],
        "B_b2": _B_in["b2"],
    }

def reference(A_x, A_dft_seq_re, A_dft_seq_im, A_dft_hid_re, A_dft_hid_im, B_x, B_w1, B_b1, B_w2, B_b2):
    def _A_ref(x, dft_seq_re, dft_seq_im, dft_hid_re, dft_hid_im):
        a = torch.einsum("bsd,ed->bse", x, dft_hid_re)
        b = torch.einsum("bsd,ed->bse", x, dft_hid_im)
        y = torch.einsum("ts,bse->bte", dft_seq_re, a) - torch.einsum("ts,bse->bte", dft_seq_im, b)
        return y

    def _B_ref(x, w1, b1, w2, b2):
        h = torch.einsum("bsd,df->bsf", x, w1) + b1
        h = _gelu(h)
        return torch.einsum("bsf,fd->bsd", h, w2) + b2

    x = A_x
    xn = _layernorm(x, axis=-1)
    s = _A_ref(xn, A_dft_seq_re, A_dft_seq_im, A_dft_hid_re, A_dft_hid_im)
    g = _silu(_B_ref(xn, B_w1, B_b1, B_w2, B_b2))
    return x + s * g
```

```asm
; @launch grid=(256,1,1) block=(512,1,1) lds=156160
.amdgcn_target "amdgcn-amd-amdhsa--gfx950"
.text
.globl recurrent_scan__spectral_fnet__dense_activation_gelu__prompt_kernel
.p2align 8
.type recurrent_scan__spectral_fnet__dense_activation_gelu__prompt_kernel,@function
recurrent_scan__spectral_fnet__dense_activation_gelu__prompt_kernel:
    s_cmp_ge_u32 s2, 256
    s_cbranch_scc1 k_done
    s_load_dwordx2 s[32:33], s[0:1], 0
    s_getpc_b64 s[36:37]
entry_pc:
    v_lshlrev_b32 v60, 7, v0
    v_min_u32 v60, k_done-entry_pc, v60
    global_load_dword v61, v60, s[36:37]
    s_load_dwordx4 s[20:23], s[0:1], 24
    s_load_dwordx4 s[24:27], s[0:1], 48
    s_load_dwordx4 s[28:31], s[0:1], 88
    v_lshrrev_b32 v1, 6, v0
    s_nop 0
    v_readfirstlane_b32 s51, v1
    v_and_b32 v1, 63, v0
    s_nop 2
    s_and_b32 s3, s51, 3
    s_mov_b32 s39, s51
    s_lshl_b32 s38, s2, 3
    s_add_u32 s38, s38, s39
    v_lshlrev_b32 v2, 4, v1
    s_lshl_b32 s37, s38, 11
    s_mul_i32 s38, s38, 2176
    v_mov_b32 v3, 155648
    v_mov_b32 v4, 0
    v_mov_b32 v5, 0
    v_mov_b32 v6, 0
    v_mov_b32 v7, 0
    ds_write_b128 v3, v[4:7]
    ds_write_b128 v3, v[4:7] offset:16
    ds_write_b128 v3, v[4:7] offset:48
    s_waitcnt lgkmcnt(0)
    s_mov_b32 s64, s32
    s_mov_b32 s65, s33
    s_mov_b32 s66, 4194304
    s_mov_b32 s67, 0x20000
    buffer_load_dwordx4 v[4:7], v2, s[64:67], s37 offen
    buffer_load_dwordx4 v[8:11], v2, s[64:67], s37 offen offset:1024
    s_mov_b32 s68, s28
    s_mov_b32 s69, s29
    s_mov_b32 s70, 256
    s_mov_b32 s71, 0x20000
    s_mov_b64 s[28:29], s[30:31]
    s_add_u32 s96, s28, 32505856
    s_addc_u32 s97, s29, 0
    s_mov_b32 s98, 16384
    s_mov_b32 s99, 0x20000
    s_cmp_lg_u32 s39, 4
    s_cbranch_scc1 nonce_done
    v_mov_b32 v12, 0
    s_cmp_lg_u32 s2, 0
    s_cbranch_scc1 nonce_poll
    s_memrealtime s[100:101]
    s_waitcnt lgkmcnt(0)
    s_or_b32 s100, s100, 1
    v_mov_b32 v13, s100
    buffer_store_dword v13, v12, s[68:71], 0 offen sc1
    s_branch nonce_got
nonce_poll:
    s_mov_b32 s51, 200000
nonce_l:
    buffer_load_dword v13, v12, s[68:71], 0 offen sc1
    s_waitcnt vmcnt(0)
    v_cmp_eq_u32 vcc, 0, v13
    s_cbranch_vccz nonce_got
    s_sleep 2
    s_sub_u32 s51, s51, 1
    s_cmp_lg_u32 s51, 0
    s_cbranch_scc1 nonce_l
nonce_got:
    ds_write_b32 v3, v13 offset:32
    s_waitcnt lgkmcnt(0)
nonce_done:
    s_mov_b32 s8, s28
    s_mov_b32 s9, s29
    s_mov_b32 s10, 4456448
    s_mov_b32 s11, 0x20000
    s_and_b32 s30, s2, 1
    s_lshl_b32 s30, s30, 2
    s_lshr_b32 s31, s2, 3
    s_and_b32 s40, s31, 3
    s_add_u32 s40, s40, s30
    s_lshl_b32 s40, s40, 8
    s_and_b32 s30, s2, 6
    s_lshl_b32 s30, s30, 2
    s_lshr_b32 s41, s31, 2
    s_add_u32 s41, s41, s30
    s_mov_b32 s60, 16
    s_mov_b32 s42, 0
    s_mov_b32 s43, 0
    s_mov_b32 s44, 0
    s_waitcnt vmcnt(0)
    v_lshlrev_b32 v16, 16, v4
    v_and_b32 v17, 0xffff0000, v4
    v_lshlrev_b32 v18, 16, v5
    v_and_b32 v19, 0xffff0000, v5
    v_lshlrev_b32 v20, 16, v6
    v_and_b32 v21, 0xffff0000, v6
    v_lshlrev_b32 v22, 16, v7
    v_and_b32 v23, 0xffff0000, v7
    v_lshlrev_b32 v24, 16, v8
    v_and_b32 v25, 0xffff0000, v8
    v_lshlrev_b32 v26, 16, v9
    v_and_b32 v27, 0xffff0000, v9
    v_lshlrev_b32 v28, 16, v10
    v_and_b32 v29, 0xffff0000, v10
    v_lshlrev_b32 v30, 16, v11
    v_and_b32 v31, 0xffff0000, v11
    v_add_f32 v40, v16, v17
    v_add_f32 v41, v18, v19
    v_add_f32 v42, v20, v21
    v_add_f32 v43, v22, v23
    v_add_f32 v44, v24, v25
    v_add_f32 v45, v26, v27
    v_add_f32 v46, v28, v29
    v_add_f32 v47, v30, v31
    v_add_f32 v40, v40, v44
    v_add_f32 v41, v41, v45
    v_add_f32 v42, v42, v46
    v_add_f32 v43, v43, v47
    v_add_f32 v40, v40, v42
    v_add_f32 v41, v41, v43
    v_add_f32 v3, v40, v41
    s_nop 1
    v_add_f32_dpp v3, v3, v3 row_ror:1 row_mask:0xf bank_mask:0xf
    s_nop 1
    v_add_f32_dpp v3, v3, v3 row_ror:2 row_mask:0xf bank_mask:0xf
    s_nop 1
    v_add_f32_dpp v3, v3, v3 row_ror:4 row_mask:0xf bank_mask:0xf
    s_nop 1
    v_add_f32_dpp v3, v3, v3 row_ror:8 row_mask:0xf bank_mask:0xf
    v_mov_b32 v48, v3
    s_nop 1
    v_permlane32_swap_b32 v3, v48
    v_add_f32 v3, v3, v48
    v_mov_b32 v48, v3
    s_nop 1
    v_permlane16_swap_b32 v3, v48
    v_add_f32 v3, v3, v48
    v_mul_f32 v3, 0x3a800000, v3
    v_sub_f32 v52, v16, v3
    v_sub_f32 v53, v17, v3
    v_sub_f32 v54, v18, v3
    v_sub_f32 v55, v19, v3
    v_sub_f32 v56, v20, v3
    v_sub_f32 v57, v21, v3
    v_sub_f32 v58, v22, v3
    v_sub_f32 v59, v23, v3
    v_sub_f32 v60, v24, v3
    v_sub_f32 v61, v25, v3
    v_sub_f32 v62, v26, v3
    v_sub_f32 v63, v27, v3
    v_sub_f32 v64, v28, v3
    v_sub_f32 v65, v29, v3
    v_sub_f32 v66, v30, v3
    v_sub_f32 v67, v31, v3
    v_mul_f32 v52, v52, v52
    v_mul_f32 v53, v53, v53
    v_mul_f32 v54, v54, v54
    v_mul_f32 v55, v55, v55
    v_mul_f32 v56, v56, v56
    v_mul_f32 v57, v57, v57
    v_mul_f32 v58, v58, v58
    v_mul_f32 v59, v59, v59
    v_mul_f32 v60, v60, v60
    v_mul_f32 v61, v61, v61
    v_mul_f32 v62, v62, v62
    v_mul_f32 v63, v63, v63
    v_mul_f32 v64, v64, v64
    v_mul_f32 v65, v65, v65
    v_mul_f32 v66, v66, v66
    v_mul_f32 v67, v67, v67
    v_add_f32 v40, v52, v53
    v_add_f32 v41, v54, v55
    v_add_f32 v42, v56, v57
    v_add_f32 v43, v58, v59
    v_add_f32 v44, v60, v61
    v_add_f32 v45, v62, v63
    v_add_f32 v46, v64, v65
    v_add_f32 v47, v66, v67
    v_add_f32 v40, v40, v44
    v_add_f32 v41, v41, v45
    v_add_f32 v42, v42, v46
    v_add_f32 v43, v43, v47
    v_add_f32 v40, v40, v42
    v_add_f32 v41, v41, v43
    v_add_f32 v12, v40, v41
    s_nop 1
    v_add_f32_dpp v12, v12, v12 row_ror:1 row_mask:0xf bank_mask:0xf
    s_nop 1
    v_add_f32_dpp v12, v12, v12 row_ror:2 row_mask:0xf bank_mask:0xf
    s_nop 1
    v_add_f32_dpp v12, v12, v12 row_ror:4 row_mask:0xf bank_mask:0xf
    s_nop 1
    v_add_f32_dpp v12, v12, v12 row_ror:8 row_mask:0xf bank_mask:0xf
    v_mov_b32 v48, v12
    s_nop 1
    v_permlane32_swap_b32 v12, v48
    v_add_f32 v12, v12, v48
    v_mov_b32 v48, v12
    s_nop 1
    v_permlane16_swap_b32 v12, v48
    v_add_f32 v12, v12, v48
    v_mul_f32 v12, 0x3a800000, v12
    v_cvt_pk_bf16_f32 v13, v3, v12
    v_lshlrev_b32 v3, 16, v13
    v_and_b32 v12, 0xffff0000, v13
    v_add_f32 v12, 0x3727c5ac, v12
    v_cvt_pk_bf16_f32 v13, v12, v12
    v_lshlrev_b32 v12, 16, v13
    v_sqrt_f32 v12, v12
    s_nop 0
    v_cvt_pk_bf16_f32 v13, v12, v12
    v_lshlrev_b32 v12, 16, v13
    v_rcp_f32 v14, v12
    v_sub_f32 v16, v16, v3
    v_sub_f32 v17, v17, v3
    v_cvt_pk_bf16_f32 v4, v16, v17
    v_lshlrev_b32 v16, 16, v4
    v_and_b32 v17, 0xffff0000, v4
    v_sub_f32 v18, v18, v3
    v_sub_f32 v19, v19, v3
    v_cvt_pk_bf16_f32 v5, v18, v19
    v_lshlrev_b32 v18, 16, v5
    v_and_b32 v19, 0xffff0000, v5
    v_sub_f32 v20, v20, v3
    v_sub_f32 v21, v21, v3
    v_cvt_pk_bf16_f32 v6, v20, v21
    v_lshlrev_b32 v20, 16, v6
    v_and_b32 v21, 0xffff0000, v6
    v_sub_f32 v22, v22, v3
    v_sub_f32 v23, v23, v3
    v_cvt_pk_bf16_f32 v7, v22, v23
    v_lshlrev_b32 v22, 16, v7
    v_and_b32 v23, 0xffff0000, v7
    v_sub_f32 v24, v24, v3
    v_sub_f32 v25, v25, v3
    v_cvt_pk_bf16_f32 v8, v24, v25
    v_lshlrev_b32 v24, 16, v8
    v_and_b32 v25, 0xffff0000, v8
    v_sub_f32 v26, v26, v3
    v_sub_f32 v27, v27, v3
    v_cvt_pk_bf16_f32 v9, v26, v27
    v_lshlrev_b32 v26, 16, v9
    v_and_b32 v27, 0xffff0000, v9
    v_sub_f32 v28, v28, v3
    v_sub_f32 v29, v29, v3
    v_cvt_pk_bf16_f32 v10, v28, v29
    v_lshlrev_b32 v28, 16, v10
    v_and_b32 v29, 0xffff0000, v10
    v_sub_f32 v30, v30, v3
    v_sub_f32 v31, v31, v3
    v_cvt_pk_bf16_f32 v11, v30, v31
    v_lshlrev_b32 v30, 16, v11
    v_and_b32 v31, 0xffff0000, v11
    v_mul_f32 v52, v16, v14
    v_fma_f32 v16, -v52, v12, v16
    v_fma_f32 v52, v16, v14, v52
    v_mul_f32 v53, v17, v14
    v_fma_f32 v17, -v53, v12, v17
    v_fma_f32 v53, v17, v14, v53
    v_mul_f32 v54, v18, v14
    v_fma_f32 v18, -v54, v12, v18
    v_fma_f32 v54, v18, v14, v54
    v_mul_f32 v55, v19, v14
    v_fma_f32 v19, -v55, v12, v19
    v_fma_f32 v55, v19, v14, v55
    v_mul_f32 v56, v20, v14
    v_fma_f32 v20, -v56, v12, v20
    v_fma_f32 v56, v20, v14, v56
    v_mul_f32 v57, v21, v14
    v_fma_f32 v21, -v57, v12, v21
    v_fma_f32 v57, v21, v14, v57
    v_mul_f32 v58, v22, v14
    v_fma_f32 v22, -v58, v12, v22
    v_fma_f32 v58, v22, v14, v58
    v_mul_f32 v59, v23, v14
    v_fma_f32 v23, -v59, v12, v23
    v_fma_f32 v59, v23, v14, v59
    v_mul_f32 v60, v24, v14
    v_fma_f32 v24, -v60, v12, v24
    v_fma_f32 v60, v24, v14, v60
    v_mul_f32 v61, v25, v14
    v_fma_f32 v25, -v61, v12, v25
    v_fma_f32 v61, v25, v14, v61
    v_mul_f32 v62, v26, v14
    v_fma_f32 v26, -v62, v12, v26
    v_fma_f32 v62, v26, v14, v62
    v_mul_f32 v63, v27, v14
    v_fma_f32 v27, -v63, v12, v27
    v_fma_f32 v63, v27, v14, v63
    v_mul_f32 v64, v28, v14
    v_fma_f32 v28, -v64, v12, v28
    v_fma_f32 v64, v28, v14, v64
    v_mul_f32 v65, v29, v14
    v_fma_f32 v29, -v65, v12, v29
    v_fma_f32 v65, v29, v14, v65
    v_mul_f32 v66, v30, v14
    v_fma_f32 v30, -v66, v12, v30
    v_fma_f32 v66, v30, v14, v66
    v_mul_f32 v67, v31, v14
    v_fma_f32 v31, -v67, v12, v31
    v_fma_f32 v67, v31, v14, v67
    v_cvt_pk_bf16_f32 v4, v52, v53
    v_cvt_pk_bf16_f32 v5, v54, v55
    v_cvt_pk_bf16_f32 v6, v56, v57
    v_cvt_pk_bf16_f32 v7, v58, v59
    v_cvt_pk_bf16_f32 v8, v60, v61
    v_cvt_pk_bf16_f32 v9, v62, v63
    v_cvt_pk_bf16_f32 v10, v64, v65
    v_cvt_pk_bf16_f32 v11, v66, v67
    buffer_store_dwordx4 v[4:7], v2, s[8:11], s38 offen sc1
    buffer_store_dwordx4 v[8:11], v2, s[8:11], s38 offen offset:1024 sc1
    s_cmp_lt_u32 s41, 11
    s_cbranch_scc1 g1d_start
    s_cmp_eq_u32 s41, 11
    s_cbranch_scc1 g1m_start
    s_branch g1f_start
g1d_start:
    s_cmp_ge_u32 s39, 4
    s_cbranch_scc0 g1d_comp
    s_lshl_b32 s49, s3, 6
    s_add_u32 s49, s49, s40
    v_lshrrev_b32 v2, 2, v1
    v_and_b32 v2, 7, v2
    s_mov_b32 s50, 2176
    v_mul_lo_u32 v2, v2, s50
    v_lshrrev_b32 v3, 5, v1
    v_lshl_add_u32 v2, v3, 6, v2
    v_lshrrev_b32 v3, 3, v1
    v_and_b32 v3, 2, v3
    v_and_b32 v4, 3, v1
    v_xor_b32 v3, v3, v4
    v_lshlrev_b32 v3, 4, v3
    v_xor_b32 v4, 48, v3
    v_add_u32 v3, v3, v2
    v_add_u32 v4, v4, v2
    s_mul_i32 s49, s49, 2176
    s_add_u32 s50, s49, 0
    v_add_u32 v8, s50, v3
    s_add_u32 s50, s49, 16384
    v_add_u32 v9, s50, v4
    s_add_u32 s50, s49, 32768
    v_add_u32 v10, s50, v3
    s_add_u32 s50, s49, 49152
    v_add_u32 v11, s50, v4
    s_add_u32 s50, s49, 69632
    v_add_u32 v12, s50, v3
    s_add_u32 s50, s49, 86016
    v_add_u32 v13, s50, v4
    s_add_u32 s50, s49, 102400
    v_add_u32 v14, s50, v3
    s_add_u32 s50, s49, 118784
    v_add_u32 v15, s50, v4
    s_lshl_b32 s52, s3, 13
    s_add_u32 s53, s52, 4096
    s_mul_i32 s54, s3, 6144
    s_add_u32 s54, s54, 65536
    s_add_u32 s55, s54, 4096
    v_lshrrev_b32 v2, 2, v1
    v_and_b32 v2, 7, v2
    s_mov_b32 s50, 2048
    v_mul_lo_u32 v2, v2, s50
    v_lshrrev_b32 v3, 5, v1
    v_lshl_add_u32 v2, v3, 6, v2
    v_lshrrev_b32 v3, 3, v1
    v_and_b32 v3, 2, v3
    v_and_b32 v4, 3, v1
    v_xor_b32 v3, v3, v4
    v_lshlrev_b32 v3, 4, v3
    v_xor_b32 v4, 48, v3
    v_add_u32 v3, v3, v2
    v_add_u32 v4, v4, v2
    s_mul_i32 s49, s41, 22
    s_mul_i32 s50, s3, 6
    s_add_u32 s50, s50, 0
    s_add_u32 s49, s49, s50
    s_cmp_lt_u32 s49, 128
    s_cselect_b32 s64, s20, s22
    s_cselect_b32 s65, s21, s23
    s_and_b32 s49, s49, 127
    s_lshl_b32 s49, s49, 14
    s_cmp_lt_u32 s50, 22
    s_cselect_b32 s66, 2097152, 0
    s_mov_b32 s67, 0x20000
    s_cselect_b32 s49, s49, 4096
    v_add_u32 v16, s49, v3
    s_mul_i32 s49, s41, 22
    s_mul_i32 s50, s3, 6
    s_add_u32 s50, s50, 1
    s_add_u32 s49, s49, s50
    s_cmp_lt_u32 s49, 128
    s_cselect_b32 s68, s20, s22
    s_cselect_b32 s69, s21, s23
    s_and_b32 s49, s49, 127
    s_lshl_b32 s49, s49, 14
    s_cmp_lt_u32 s50, 22
    s_cselect_b32 s70, 2097152, 0
    s_mov_b32 s71, 0x20000
    s_cselect_b32 s49, s49, 4096
    s_sub_u32 s49, s49, 1024
    v_add_u32 v17, s49, v4
    s_mul_i32 s49, s41, 22
    s_mul_i32 s50, s3, 6
    s_add_u32 s50, s50, 2
    s_add_u32 s49, s49, s50
    s_cmp_lt_u32 s49, 128
    s_cselect_b32 s72, s20, s22
    s_cselect_b32 s73, s21, s23
    s_and_b32 s49, s49, 127
    s_lshl_b32 s49, s49, 14
    s_cmp_lt_u32 s50, 22
    s_cselect_b32 s74, 2097152, 0
    s_mov_b32 s75, 0x20000
    s_cselect_b32 s49, s49, 4096
    s_sub_u32 s49, s49, 2048
    v_add_u32 v18, s49, v3
    s_mul_i32 s49, s41, 22
    s_mul_i32 s50, s3, 6
    s_add_u32 s50, s50, 3
    s_add_u32 s49, s49, s50
    s_cmp_lt_u32 s49, 128
    s_cselect_b32 s76, s20, s22
    s_cselect_b32 s77, s21, s23
    s_and_b32 s49, s49, 127
    s_lshl_b32 s49, s49, 14
    s_cmp_lt_u32 s50, 22
    s_cselect_b32 s78, 2097152, 0
    s_mov_b32 s79, 0x20000
    s_cselect_b32 s49, s49, 4096
    s_sub_u32 s49, s49, 3072
    v_add_u32 v19, s49, v4
    s_mul_i32 s49, s41, 22
    s_mul_i32 s50, s3, 6
    s_add_u32 s50, s50, 4
    s_add_u32 s49, s49, s50
    s_cmp_lt_u32 s49, 128
    s_cselect_b32 s80, s20, s22
    s_cselect_b32 s81, s21, s23
    s_and_b32 s49, s49, 127
    s_lshl_b32 s49, s49, 14
    s_cmp_lt_u32 s50, 22
    s_cselect_b32 s82, 2097152, 0
    s_mov_b32 s83, 0x20000
    s_cselect_b32 s49, s49, 4096
    v_add_u32 v20, s49, v3
    s_mul_i32 s49, s41, 22
    s_mul_i32 s50, s3, 6
    s_add_u32 s50, s50, 5
    s_add_u32 s49, s49, s50
    s_cmp_lt_u32 s49, 128
    s_cselect_b32 s84, s20, s22
    s_cselect_b32 s85, s21, s23
    s_and_b32 s49, s49, 127
    s_lshl_b32 s49, s49, 14
    s_cmp_lt_u32 s50, 22
    s_cselect_b32 s86, 2097152, 0
    s_mov_b32 s87, 0x20000
    s_cselect_b32 s49, s49, 4096
    s_sub_u32 s49, s49, 1024
    v_add_u32 v21, s49, v4
    s_mov_b32 s46, 0
    s_mov_b32 s61, s60
    s_mov_b32 s92, 0
    s_mov_b32 s93, s60
    s_add_u32 m0, s92, s54
    s_nop 0
    buffer_load_dwordx4 v16, s[64:67], s43 offen lds
    buffer_load_dwordx4 v17, s[68:71], s43 offen offset:1024 lds
    buffer_load_dwordx4 v18, s[72:75], s43 offen offset:2048 lds
    buffer_load_dwordx4 v19, s[76:79], s43 offen offset:3072 lds
    s_add_u32 m0, s92, s55
    s_nop 0
    buffer_load_dwordx4 v20, s[80:83], s43 offen lds
    buffer_load_dwordx4 v21, s[84:87], s43 offen offset:1024 lds
    s_add_u32 s43, s43, 128
    s_add_u32 s92, s92, 24576
    s_cmp_ge_u32 s92, 73728
    s_cselect_b32 s92, 0, s92
    s_sub_u32 s93, s93, 1
    s_cmp_lt_i32 s93, 1
    s_cselect_b32 s66, 0, s66
    s_cselect_b32 s70, 0, s70
    s_cselect_b32 s74, 0, s74
    s_cselect_b32 s78, 0, s78
    s_cselect_b32 s82, 0, s82
    s_cselect_b32 s86, 0, s86
    s_add_u32 m0, s92, s54
    s_nop 0
    buffer_load_dwordx4 v16, s[64:67], s43 offen lds
    buffer_load_dwordx4 v17, s[68:71], s43 offen offset:1024 lds
    buffer_load_dwordx4 v18, s[72:75], s43 offen offset:2048 lds
    buffer_load_dwordx4 v19, s[76:79], s43 offen offset:3072 lds
    s_add_u32 m0, s92, s55
    s_nop 0
    buffer_load_dwordx4 v20, s[80:83], s43 offen lds
    buffer_load_dwordx4 v21, s[84:87], s43 offen offset:1024 lds
    s_add_u32 s43, s43, 128
    s_add_u32 s92, s92, 24576
    s_cmp_ge_u32 s92, 73728
    s_cselect_b32 s92, 0, s92
    s_sub_u32 s93, s93, 1
    s_cmp_lt_i32 s93, 1
    s_cselect_b32 s66, 0, s66
    s_cselect_b32 s70, 0, s70
    s_cselect_b32 s74, 0, s74
    s_cselect_b32 s78, 0, s78
    s_cselect_b32 s82, 0, s82
    s_cselect_b32 s86, 0, s86
    s_add_u32 m0, s92, s54
    s_nop 0
    buffer_load_dwordx4 v16, s[64:67], s43 offen lds
    buffer_load_dwordx4 v17, s[68:71], s43 offen offset:1024 lds
    buffer_load_dwordx4 v18, s[72:75], s43 offen offset:2048 lds
    buffer_load_dwordx4 v19, s[76:79], s43 offen offset:3072 lds
    s_add_u32 m0, s92, s55
    s_nop 0
    buffer_load_dwordx4 v20, s[80:83], s43 offen lds
    buffer_load_dwordx4 v21, s[84:87], s43 offen offset:1024 lds
    s_add_u32 s43, s43, 128
    s_add_u32 s92, s92, 24576
    s_cmp_ge_u32 s92, 73728
    s_cselect_b32 s92, 0, s92
    s_sub_u32 s93, s93, 1
    s_cmp_lt_i32 s93, 1
    s_cselect_b32 s66, 0, s66
    s_cselect_b32 s70, 0, s70
    s_cselect_b32 s74, 0, s74
    s_cselect_b32 s78, 0, s78
    s_cselect_b32 s82, 0, s82
    s_cselect_b32 s86, 0, s86
    s_waitcnt vmcnt(18)
    s_barrier
    v_mov_b32 v2, 155680
    ds_read_b32 v2, v2
    s_waitcnt lgkmcnt(0)
    v_readfirstlane_b32 s95, v2
    s_nop 3
    s_cmp_lg_u32 s3, 0
    s_cbranch_scc1 g1d_nf
    s_lshl_b32 s37, s2, 2
    v_mov_b32 v2, 0
    v_mov_b32 v3, s95
    s_mov_b64 exec, 1
    buffer_store_dword v3, v2, s[96:99], s37 offen sc1
    s_mov_b64 exec, -1
g1d_nf:
    s_lshr_b32 s49, s40, 1
    v_and_b32 v2, 31, v1
    v_lshl_add_u32 v2, v2, 2, s49
    v_mov_b32 v4, 155700
    s_cmp_lg_u32 s3, 0
    s_cbranch_scc1 lw_g1d
    s_mov_b32 s51, 200000
poll_g1d:
    buffer_load_dword v3, v2, s[96:99], 0 offen sc1
    s_waitcnt vmcnt(0)
    v_cmp_ne_u32 vcc, s95, v3
    s_cbranch_vccz polld_g1d
    s_sleep 1
    s_sub_u32 s51, s51, 1
    s_cmp_lg_u32 s51, 0
    s_cbranch_scc1 poll_g1d
polld_g1d:
    v_mov_b32 v3, 1
    ds_write_b32 v4, v3
    s_branch lwd_g1d
lw_g1d:
    s_mov_b32 s51, 4000000
lwl_g1d:
    ds_read_b32 v3, v4
    s_waitcnt lgkmcnt(0)
    v_cmp_ne_u32 vcc, 1, v3
    s_cbranch_vccz lwd_g1d
    s_sleep 1
    s_sub_u32 s51, s51, 1
    s_cmp_lg_u32 s51, 0
    s_cbranch_scc1 lwl_g1d
lwd_g1d:
    s_add_u32 m0, s46, s52
    s_nop 0
    buffer_load_dwordx4 v8, s[8:11], s42 offen sc1 lds
    buffer_load_dwordx4 v9, s[8:11], s42 offen offset:1024 sc1 lds
    buffer_load_dwordx4 v10, s[8:11], s42 offen offset:2048 sc1 lds
    buffer_load_dwordx4 v11, s[8:11], s42 offen offset:3072 sc1 lds
    s_add_u32 m0, s46, s53
    s_nop 0
    buffer_load_dwordx4 v12, s[8:11], s42 offen sc1 lds
    buffer_load_dwordx4 v13, s[8:11], s42 offen offset:1024 sc1 lds
    buffer_load_dwordx4 v14, s[8:11], s42 offen offset:2048 sc1 lds
    buffer_load_dwordx4 v15, s[8:11], s42 offen offset:3072 sc1 lds
    s_add_u32 s42, s42, 128
    s_add_u32 s46, s46, 32768
    s_cmp_ge_u32 s46, 65536
    s_cselect_b32 s46, 0, s46
    s_sub_u32 s61, s61, 1
    s_cmp_lt_i32 s61, 1
    s_cselect_b32 s10, 0, s10
    s_add_u32 m0, s46, s52
    s_nop 0
    buffer_load_dwordx4 v8, s[8:11], s42 offen sc1 lds
    buffer_load_dwordx4 v9, s[8:11], s42 offen offset:1024 sc1 lds
    buffer_load_dwordx4 v10, s[8:11], s42 offen offset:2048 sc1 lds
    buffer_load_dwordx4 v11, s[8:11], s42 offen offset:3072 sc1 lds
    s_add_u32 m0, s46, s53
    s_nop 0
    buffer_load_dwordx4 v12, s[8:11], s42 offen sc1 lds
    buffer_load_dwordx4 v13, s[8:11], s42 offen offset:1024 sc1 lds
    buffer_load_dwordx4 v14, s[8:11], s42 offen offset:2048 sc1 lds
    buffer_load_dwordx4 v15, s[8:11], s42 offen offset:3072 sc1 lds
    s_add_u32 s42, s42, 128
    s_add_u32 s46, s46, 32768
    s_cmp_ge_u32 s46, 65536
    s_cselect_b32 s46, 0, s46
    s_sub_u32 s61, s61, 1
    s_cmp_lt_i32 s61, 1
    s_cselect_b32 s10, 0, s10
    s_waitcnt vmcnt(8)
    s_barrier
    s_mov_b32 s45, s60
    s_waitcnt vmcnt(0)
    s_branch g1d_lmid
g1d_lloop:
    s_waitcnt vmcnt(6)
g1d_lmid:
    s_barrier
    s_add_u32 m0, s46, s52
    s_nop 0
    buffer_load_dwordx4 v8, s[8:11], s42 offen sc1 lds
    buffer_load_dwordx4 v9, s[8:11], s42 offen offset:1024 sc1 lds
    buffer_load_dwordx4 v10, s[8:11], s42 offen offset:2048 sc1 lds
    buffer_load_dwordx4 v11, s[8:11], s42 offen offset:3072 sc1 lds
    s_add_u32 m0, s46, s53
    s_nop 0
    buffer_load_dwordx4 v12, s[8:11], s42 offen sc1 lds
    buffer_load_dwordx4 v13, s[8:11], s42 offen offset:1024 sc1 lds
    buffer_load_dwordx4 v14, s[8:11], s42 offen offset:2048 sc1 lds
    buffer_load_dwordx4 v15, s[8:11], s42 offen offset:3072 sc1 lds
    s_add_u32 m0, s92, s54
    s_nop 0
    buffer_load_dwordx4 v16, s[64:67], s43 offen lds
    buffer_load_dwordx4 v17, s[68:71], s43 offen offset:1024 lds
    buffer_load_dwordx4 v18, s[72:75], s43 offen offset:2048 lds
    buffer_load_dwordx4 v19, s[76:79], s43 offen offset:3072 lds
    s_add_u32 m0, s92, s55
    s_nop 0
    buffer_load_dwordx4 v20, s[80:83], s43 offen lds
    buffer_load_dwordx4 v21, s[84:87], s43 offen offset:1024 lds
    s_add_u32 s42, s42, 128
    s_add_u32 s46, s46, 32768
    s_cmp_ge_u32 s46, 65536
    s_cselect_b32 s46, 0, s46
    s_sub_u32 s61, s61, 1
    s_cmp_lt_i32 s61, 1
    s_cselect_b32 s10, 0, s10
    s_add_u32 s43, s43, 128
    s_add_u32 s92, s92, 24576
    s_cmp_ge_u32 s92, 73728
    s_cselect_b32 s92, 0, s92
    s_sub_u32 s93, s93, 1
    s_cmp_lt_i32 s93, 1
    s_cselect_b32 s66, 0, s66
    s_cselect_b32 s70, 0, s70
    s_cselect_b32 s74, 0, s74
    s_cselect_b32 s78, 0, s78
    s_cselect_b32 s82, 0, s82
    s_cselect_b32 s86, 0, s86
    s_sub_u32 s45, s45, 1
    s_cmp_lg_u32 s45, 0
    s_cbranch_scc1 g1d_lloop
    s_branch g2_loader
g1d_comp:
    s_waitcnt vmcnt(0)
    s_barrier
    v_mov_b32 v4, 155680
    ds_read_b32 v4, v4
    s_waitcnt lgkmcnt(0)
    v_readfirstlane_b32 s95, v4
    s_nop 3
    s_mov_b32 m0, 155904
    s_lshr_b32 s34, s2, 3
    s_cmp_ge_u32 s34, 3
    s_cbranch_scc1 g1d_w1
    s_lshl_b32 s34, s34, 2
    s_add_u32 s34, s34, s3
    s_lshl_b32 s34, s34, 13
    v_lshlrev_b32 v4, 7, v1
    v_add_u32 v4, s34, v4
    v_min_u32 v4, k_done-recurrent_scan__spectral_fnet__dense_activation_gelu__prompt_kernel, v4
    s_getpc_b64 s[34:35]
g1d_pc:
    s_sub_u32 s34, s34, g1d_pc-recurrent_scan__spectral_fnet__dense_activation_gelu__prompt_kernel
    s_subb_u32 s35, s35, 0
    global_load_lds_dword v4, s[34:35]
g1d_w1:
    s_load_dwordx4 s[64:67], s[0:1], 8
    s_load_dwordx2 s[68:69], s[0:1], 64
    s_load_dwordx2 s[70:71], s[0:1], 80
    v_lshlrev_b32 v4, 21, v1
    s_waitcnt lgkmcnt(0)
    s_cmp_eq_u32 s3, 0
    s_cselect_b32 s72, s28, s64
    s_cselect_b32 s73, s29, s65
    s_mov_b32 s74, 8388608
    s_cselect_b32 s74, 67108864, s74
    s_cmp_eq_u32 s3, 2
    s_cselect_b32 s72, s66, s72
    s_cselect_b32 s73, s67, s73
    s_cmp_eq_u32 s3, 3
    s_cselect_b32 s72, s68, s72
    s_cselect_b32 s73, s69, s73
    s_cselect_b32 s74, 7340032, s74
    s_mov_b32 s75, 0x20000
    buffer_load_dword v4, s[72:75], 0 offen lds
    s_mov_b32 s72, s70
    s_mov_b32 s73, s71
    s_mov_b32 s74, 4194304
    s_mov_b32 s75, 0x20000
    buffer_load_dword v4, s[72:75], 0 offen lds
    s_load_dwordx2 s[64:65], s[0:1], 8
    s_load_dwordx2 s[68:69], s[0:1], 16
    s_load_dwordx2 s[70:71], s[0:1], 64
    s_mov_b32 m0, 155904
    s_lshl_b32 s74, s2, 2
    s_add_u32 s74, s74, s3
    s_lshl_b32 s74, s74, 13
    s_mov_b32 s94, s74
    s_mov_b32 s66, 8388608
    s_mov_b32 s67, 0x20000
    s_mov_b32 s72, 8388608
    s_mov_b32 s73, 7340032
    v_cmp_gt_u32 vcc, 16, v1
    v_lshlrev_b32 v30, 7, v1
    v_mov_b32 v31, 0x7ff00000
    v_cndmask_b32 v30, v31, v30, vcc
    s_waitcnt lgkmcnt(0)
    v_mov_b32 v20, v1
    s_mul_i32 s49, s3, 8192
    s_mov_b32 s50, 0
    v_and_b32 v4, 15, v20
    v_lshrrev_b32 v5, 4, v20
    v_lshrrev_b32 v6, 3, v4
    v_lshrrev_b32 v7, 2, v4
    v_and_b32 v7, 1, v7
    v_xor_b32 v7, v7, v6
    v_lshl_add_u32 v7, v7, 1, v6
    v_xor_b32 v7, v7, v5
    v_lshlrev_b32 v7, 4, v7
    v_lshl_add_u32 v15, v4, 6, v7
    v_lshl_add_u32 v7, v6, 10, v7
    v_and_b32 v6, 7, v4
    v_lshl_add_u32 v6, v6, 6, v7
    v_lshrrev_b32 v8, 2, v20
    v_and_b32 v8, 3, v8
    v_and_b32 v9, 3, v20
    s_mul_i32 s51, s50, 22528
    s_add_u32 s51, s51, 65536
    v_add_u32 v10, s51, v6
    v_mov_b32 v1, v10
    v_add_u32 v0, s49, v6
    v_mov_b32 v80, 0
    v_mov_b32 v81, 0
    v_mov_b32 v82, 0
    v_mov_b32 v83, 0
    v_mov_b32 v84, 0
    v_mov_b32 v85, 0
    v_mov_b32 v86, 0
    v_mov_b32 v87, 0
    v_mov_b32 v88, 0
    v_mov_b32 v89, 0
    v_mov_b32 v90, 0
    v_mov_b32 v91, 0
    v_mov_b32 v92, 0
    v_mov_b32 v93, 0
    v_mov_b32 v94, 0
    v_mov_b32 v95, 0
    v_mov_b32 v96, 0
    v_mov_b32 v97, 0
    v_mov_b32 v98, 0
    v_mov_b32 v99, 0
    v_mov_b32 v100, 0
    v_mov_b32 v101, 0
    v_mov_b32 v102, 0
    v_mov_b32 v103, 0
    v_mov_b32 v104, 0
    v_mov_b32 v105, 0
    v_mov_b32 v106, 0
    v_mov_b32 v107, 0
    v_mov_b32 v108, 0
    v_mov_b32 v109, 0
    v_mov_b32 v110, 0
    v_mov_b32 v111, 0
    v_mov_b32 v112, 0
    v_mov_b32 v113, 0
    v_mov_b32 v114, 0
    v_mov_b32 v115, 0
    v_mov_b32 v116, 0
    v_mov_b32 v117, 0
    v_mov_b32 v118, 0
    v_mov_b32 v119, 0
    v_mov_b32 v120, 0
    v_mov_b32 v121, 0
    v_mov_b32 v122, 0
    v_mov_b32 v123, 0
    v_mov_b32 v124, 0
    v_mov_b32 v125, 0
    v_mov_b32 v126, 0
    v_mov_b32 v127, 0
    v_mov_b32 v128, 0
    v_mov_b32 v129, 0
    v_mov_b32 v130, 0
    v_mov_b32 v131, 0
    v_mov_b32 v132, 0
    v_mov_b32 v133, 0
    v_mov_b32 v134, 0
    v_mov_b32 v135, 0
    v_mov_b32 v136, 0
    v_mov_b32 v137, 0
    v_mov_b32 v138, 0
    v_mov_b32 v139, 0
    v_mov_b32 v140, 0
    v_mov_b32 v141, 0
    v_mov_b32 v142, 0
    v_mov_b32 v143, 0
    v_mov_b32 v144, 0
    v_mov_b32 v145, 0
    v_mov_b32 v146, 0
    v_mov_b32 v147, 0
    v_mov_b32 v148, 0
    v_mov_b32 v149, 0
    v_mov_b32 v150, 0
    v_mov_b32 v151, 0
    v_mov_b32 v152, 0
    v_mov_b32 v153, 0
    v_mov_b32 v154, 0
    v_mov_b32 v155, 0
    v_mov_b32 v156, 0
    v_mov_b32 v157, 0
    v_mov_b32 v158, 0
    v_mov_b32 v159, 0
    v_mov_b32 v160, 0
    v_mov_b32 v161, 0
    v_mov_b32 v162, 0
    v_mov_b32 v163, 0
    v_mov_b32 v164, 0
    v_mov_b32 v165, 0
    v_mov_b32 v166, 0
    v_mov_b32 v167, 0
    v_mov_b32 v168, 0
    v_mov_b32 v169, 0
    v_mov_b32 v170, 0
    v_mov_b32 v171, 0
    v_mov_b32 v172, 0
    v_mov_b32 v173, 0
    v_mov_b32 v174, 0
    v_mov_b32 v175, 0
    v_mov_b32 v176, 0
    v_mov_b32 v177, 0
    v_mov_b32 v178, 0
    v_mov_b32 v179, 0
    v_mov_b32 v180, 0
    v_mov_b32 v181, 0
    v_mov_b32 v182, 0
    v_mov_b32 v183, 0
    v_mov_b32 v184, 0
    v_mov_b32 v185, 0
    v_mov_b32 v186, 0
    v_mov_b32 v187, 0
    v_mov_b32 v188, 0
    v_mov_b32 v189, 0
    v_mov_b32 v190, 0
    v_mov_b32 v191, 0
    v_mov_b32 v192, 0
    v_mov_b32 v193, 0
    v_mov_b32 v194, 0
    v_mov_b32 v195, 0
    v_mov_b32 v196, 0
    v_mov_b32 v197, 0
    v_mov_b32 v198, 0
    v_mov_b32 v199, 0
    v_mov_b32 v200, 0
    v_mov_b32 v201, 0
    v_mov_b32 v202, 0
    v_mov_b32 v203, 0
    v_mov_b32 v204, 0
    v_mov_b32 v205, 0
    v_mov_b32 v206, 0
    v_mov_b32 v207, 0
    v_mov_b32 v208, 0
    v_mov_b32 v209, 0
    v_mov_b32 v210, 0
    v_mov_b32 v211, 0
    v_mov_b32 v212, 0
    v_mov_b32 v213, 0
    v_mov_b32 v214, 0
    v_mov_b32 v215, 0
    v_mov_b32 v216, 0
    v_mov_b32 v217, 0
    v_mov_b32 v218, 0
    v_mov_b32 v219, 0
    v_mov_b32 v220, 0
    v_mov_b32 v221, 0
    v_mov_b32 v222, 0
    v_mov_b32 v223, 0
    v_mov_b32 v224, 0
    v_mov_b32 v225, 0
    v_mov_b32 v226, 0
    v_mov_b32 v227, 0
    v_mov_b32 v228, 0
    v_mov_b32 v229, 0
    v_mov_b32 v230, 0
    v_mov_b32 v231, 0
    v_mov_b32 v232, 0
    v_mov_b32 v233, 0
    v_mov_b32 v234, 0
    v_mov_b32 v235, 0
    v_mov_b32 v236, 0
    v_mov_b32 v237, 0
    v_mov_b32 v238, 0
    v_mov_b32 v239, 0
    v_mov_b32 v240, 0
    v_mov_b32 v241, 0
    v_mov_b32 v242, 0
    v_mov_b32 v243, 0
    v_mov_b32 v244, 0
    v_mov_b32 v245, 0
    v_mov_b32 v246, 0
    v_mov_b32 v247, 0
    v_mov_b32 v248, 0
    v_mov_b32 v249, 0
    v_mov_b32 v250, 0
    v_mov_b32 v251, 0
    v_mov_b32 v252, 0
    v_mov_b32 v253, 0
    v_mov_b32 v254, 0
    v_mov_b32 v255, 0
    v_mov_b32 v3, v30
    s_mov_b32 s47, 0
    s_mov_b32 s88, 24576
    s_mov_b32 s48, 24576
    s_barrier
    ds_read_b128 v[4:7], v0 offset:0
    ds_read_b128 v[8:11], v0 offset:2048
    ds_read_b128 v[12:15], v0 offset:4096
    ds_read_b128 v[16:19], v0 offset:6144
    ds_read_b128 v[36:39], v1 offset:0
    ds_read_b128 v[40:43], v1 offset:2048
    ds_read_b128 v[44:47], v1 offset:4096
    ds_read_b128 v[48:51], v1 offset:6144
    ds_read_b128 v[52:55], v1 offset:8192
    ds_read_b128 v[56:59], v1 offset:10240
    ds_read_b128 v[60:63], v1 offset:12288
    ds_read_b128 v[64:67], v1 offset:14336
    ds_read_b128 v[68:71], v1 offset:16384
    ds_read_b128 v[72:75], v1 offset:18432
    ds_read_b128 v[76:79], v1 offset:20480
    s_mov_b32 s45, s60
    s_waitcnt lgkmcnt(0)
    s_branch g1d_mid
.p2align 6
g1d_top:
    v_mfma_f32_16x16x32_bf16 v[180:183], v[28:31], v[48:51], v[180:183]
    ds_read_b128 v[16:19], v0 offset:6144
    v_mfma_f32_16x16x32_bf16 v[224:227], v[32:35], v[48:51], v[224:227]
    ds_read_b128 v[36:39], v1 offset:0
    v_mfma_f32_16x16x32_bf16 v[96:99], v[20:23], v[52:55], v[96:99]
    ds_read_b128 v[40:43], v1 offset:2048
    v_mfma_f32_16x16x32_bf16 v[140:143], v[24:27], v[52:55], v[140:143]
    ds_read_b128 v[44:47], v1 offset:4096
    v_mfma_f32_16x16x32_bf16 v[184:187], v[28:31], v[52:55], v[184:187]
    ds_read_b128 v[48:51], v1 offset:6144
    v_mfma_f32_16x16x32_bf16 v[228:231], v[32:35], v[52:55], v[228:231]
    ds_read_b128 v[52:55], v1 offset:8192
    v_mfma_f32_16x16x32_bf16 v[100:103], v[20:23], v[56:59], v[100:103]
    v_mfma_f32_16x16x32_bf16 v[144:147], v[24:27], v[56:59], v[144:147]
    v_mfma_f32_16x16x32_bf16 v[188:191], v[28:31], v[56:59], v[188:191]
    v_mfma_f32_16x16x32_bf16 v[232:235], v[32:35], v[56:59], v[232:235]
    ds_read_b128 v[56:59], v1 offset:10240
    v_mfma_f32_16x16x32_bf16 v[104:107], v[20:23], v[60:63], v[104:107]
    v_mfma_f32_16x16x32_bf16 v[148:151], v[24:27], v[60:63], v[148:151]
    v_mfma_f32_16x16x32_bf16 v[192:195], v[28:31], v[60:63], v[192:195]
    v_mfma_f32_16x16x32_bf16 v[236:239], v[32:35], v[60:63], v[236:239]
    ds_read_b128 v[60:63], v1 offset:12288
    v_mfma_f32_16x16x32_bf16 v[108:111], v[20:23], v[64:67], v[108:111]
    v_mfma_f32_16x16x32_bf16 v[152:155], v[24:27], v[64:67], v[152:155]
    v_mfma_f32_16x16x32_bf16 v[196:199], v[28:31], v[64:67], v[196:199]
    v_mfma_f32_16x16x32_bf16 v[240:243], v[32:35], v[64:67], v[240:243]
    ds_read_b128 v[64:67], v1 offset:14336
    v_mfma_f32_16x16x32_bf16 v[112:115], v[20:23], v[68:71], v[112:115]
    v_mfma_f32_16x16x32_bf16 v[156:159], v[24:27], v[68:71], v[156:159]
    v_mfma_f32_16x16x32_bf16 v[200:203], v[28:31], v[68:71], v[200:203]
    v_mfma_f32_16x16x32_bf16 v[244:247], v[32:35], v[68:71], v[244:247]
    ds_read_b128 v[68:71], v1 offset:16384
    v_mfma_f32_16x16x32_bf16 v[116:119], v[20:23], v[72:75], v[116:119]
    v_mfma_f32_16x16x32_bf16 v[160:163], v[24:27], v[72:75], v[160:163]
    v_mfma_f32_16x16x32_bf16 v[204:207], v[28:31], v[72:75], v[204:207]
    v_mfma_f32_16x16x32_bf16 v[248:251], v[32:35], v[72:75], v[248:251]
    ds_read_b128 v[72:75], v1 offset:18432
    v_mfma_f32_16x16x32_bf16 v[120:123], v[20:23], v[76:79], v[120:123]
    v_mfma_f32_16x16x32_bf16 v[164:167], v[24:27], v[76:79], v[164:167]
    v_mfma_f32_16x16x32_bf16 v[208:211], v[28:31], v[76:79], v[208:211]
    v_mfma_f32_16x16x32_bf16 v[252:255], v[32:35], v[76:79], v[252:255]
g1d_mid:
    ds_read_b128 v[76:79], v1 offset:20480
    s_waitcnt lgkmcnt(10)
    v_mfma_f32_16x16x32_bf16 v[80:83], v[4:7], v[36:39], v[80:83]
    ds_read_b128 v[20:23], v0 offset:512
    v_mfma_f32_16x16x32_bf16 v[124:127], v[8:11], v[36:39], v[124:127]
    ds_read_b128 v[24:27], v0 offset:2560
    v_mfma_f32_16x16x32_bf16 v[168:171], v[12:15], v[36:39], v[168:171]
    ds_read_b128 v[28:31], v0 offset:4608
    v_mfma_f32_16x16x32_bf16 v[212:215], v[16:19], v[36:39], v[212:215]
    ds_read_b128 v[32:35], v0 offset:6656
    s_waitcnt lgkmcnt(13)
    v_mfma_f32_16x16x32_bf16 v[84:87], v[4:7], v[40:43], v[84:87]
    ds_read_b128 v[36:39], v1 offset:512
    v_mfma_f32_16x16x32_bf16 v[128:131], v[8:11], v[40:43], v[128:131]
    s_add_u32 s47, s47, 24576
    s_cmp_ge_u32 s47, 73728
    v_mfma_f32_16x16x32_bf16 v[172:175], v[12:15], v[40:43], v[172:175]
    s_cselect_b32 s47, 0, s47
    s_cselect_b32 s48, 4294918144, s88
    v_mfma_f32_16x16x32_bf16 v[216:219], v[16:19], v[40:43], v[216:219]
    ds_read_b128 v[40:43], v1 offset:2560
    s_waitcnt lgkmcnt(14)
    v_mfma_f32_16x16x32_bf16 v[88:91], v[4:7], v[44:47], v[88:91]
    v_mfma_f32_16x16x32_bf16 v[132:135], v[8:11], v[44:47], v[132:135]
    v_mfma_f32_16x16x32_bf16 v[176:179], v[12:15], v[44:47], v[176:179]
    v_mfma_f32_16x16x32_bf16 v[220:223], v[16:19], v[44:47], v[220:223]
    ds_read_b128 v[44:47], v1 offset:4608
    s_waitcnt lgkmcnt(14)
    v_mfma_f32_16x16x32_bf16 v[92:95], v[4:7], v[48:51], v[92:95]
    v_mfma_f32_16x16x32_bf16 v[136:139], v[8:11], v[48:51], v[136:139]
    buffer_load_dword v3, s[64:67], s94 offen lds
    v_mfma_f32_16x16x32_bf16 v[180:183], v[12:15], v[48:51], v[180:183]
    v_mfma_f32_16x16x32_bf16 v[224:227], v[16:19], v[48:51], v[224:227]
    ds_read_b128 v[48:51], v1 offset:6656
    s_waitcnt lgkmcnt(14)
    v_mfma_f32_16x16x32_bf16 v[96:99], v[4:7], v[52:55], v[96:99]
    s_add_u32 s94, s94, 2048
    s_and_b32 s49, s45, 3
    v_mfma_f32_16x16x32_bf16 v[140:143], v[8:11], v[52:55], v[140:143]
    s_cmp_eq_u32 s49, 1
    s_cselect_b64 s[64:65], s[68:69], s[64:65]
    v_mfma_f32_16x16x32_bf16 v[184:187], v[12:15], v[52:55], v[184:187]
    s_cselect_b64 s[68:69], s[70:71], s[68:69]
    s_cselect_b32 s66, s72, s66
    v_mfma_f32_16x16x32_bf16 v[228:231], v[16:19], v[52:55], v[228:231]
    ds_read_b128 v[52:55], v1 offset:8704
    s_waitcnt lgkmcnt(14)
    v_mfma_f32_16x16x32_bf16 v[100:103], v[4:7], v[56:59], v[100:103]
    s_cselect_b32 s72, s73, s72
    s_cselect_b32 s73, 0, s73
    v_mfma_f32_16x16x32_bf16 v[144:147], v[8:11], v[56:59], v[144:147]
    s_cselect_b32 s94, s74, s94
    v_mfma_f32_16x16x32_bf16 v[188:191], v[12:15], v[56:59], v[188:191]
    v_mfma_f32_16x16x32_bf16 v[232:235], v[16:19], v[56:59], v[232:235]
    ds_read_b128 v[56:59], v1 offset:10752
    s_waitcnt lgkmcnt(14)
    v_mfma_f32_16x16x32_bf16 v[104:107], v[4:7], v[60:63], v[104:107]
    v_mfma_f32_16x16x32_bf16 v[148:151], v[8:11], v[60:63], v[148:151]
    v_mfma_f32_16x16x32_bf16 v[192:195], v[12:15], v[60:63], v[192:195]
    v_mfma_f32_16x16x32_bf16 v[236:239], v[16:19], v[60:63], v[236:239]
    ds_read_b128 v[60:63], v1 offset:12800
    s_waitcnt lgkmcnt(14)
    v_mfma_f32_16x16x32_bf16 v[108:111], v[4:7], v[64:67], v[108:111]
    v_mfma_f32_16x16x32_bf16 v[152:155], v[8:11], v[64:67], v[152:155]
    v_mfma_f32_16x16x32_bf16 v[196:199], v[12:15], v[64:67], v[196:199]
    v_mfma_f32_16x16x32_bf16 v[240:243], v[16:19], v[64:67], v[240:243]
    ds_read_b128 v[64:67], v1 offset:14848
    s_waitcnt lgkmcnt(14)
    v_mfma_f32_16x16x32_bf16 v[112:115], v[4:7], v[68:71], v[112:115]
    v_mfma_f32_16x16x32_bf16 v[156:159], v[8:11], v[68:71], v[156:159]
    v_mfma_f32_16x16x32_bf16 v[200:203], v[12:15], v[68:71], v[200:203]
    v_mfma_f32_16x16x32_bf16 v[244:247], v[16:19], v[68:71], v[244:247]
    ds_read_b128 v[68:71], v1 offset:16896
    s_waitcnt lgkmcnt(14)
    v_mfma_f32_16x16x32_bf16 v[116:119], v[4:7], v[72:75], v[116:119]
    v_mfma_f32_16x16x32_bf16 v[160:163], v[8:11], v[72:75], v[160:163]
    v_mfma_f32_16x16x32_bf16 v[204:207], v[12:15], v[72:75], v[204:207]
    v_mfma_f32_16x16x32_bf16 v[248:251], v[16:19], v[72:75], v[248:251]
    ds_read_b128 v[72:75], v1 offset:18944
    s_waitcnt lgkmcnt(14)
    v_mfma_f32_16x16x32_bf16 v[120:123], v[4:7], v[76:79], v[120:123]
    v_mfma_f32_16x16x32_bf16 v[164:167], v[8:11], v[76:79], v[164:167]
    v_mfma_f32_16x16x32_bf16 v[208:211], v[12:15], v[76:79], v[208:211]
    v_mfma_f32_16x16x32_bf16 v[252:255], v[16:19], v[76:79], v[252:255]
    ds_read_b128 v[76:79], v1 offset:20992
    s_waitcnt lgkmcnt(10)
    v_mfma_f32_16x16x32_bf16 v[80:83], v[20:23], v[36:39], v[80:83]
    v_mfma_f32_16x16x32_bf16 v[124:127], v[24:27], v[36:39], v[124:127]
    v_mfma_f32_16x16x32_bf16 v[168:171], v[28:31], v[36:39], v[168:171]
    v_mfma_f32_16x16x32_bf16 v[212:215], v[32:35], v[36:39], v[212:215]
    s_waitcnt lgkmcnt(9)
    v_mfma_f32_16x16x32_bf16 v[84:87], v[20:23], v[40:43], v[84:87]
    v_mfma_f32_16x16x32_bf16 v[128:131], v[24:27], v[40:43], v[128:131]
    v_mfma_f32_16x16x32_bf16 v[172:175], v[28:31], v[40:43], v[172:175]
    v_mfma_f32_16x16x32_bf16 v[216:219], v[32:35], v[40:43], v[216:219]
    s_waitcnt lgkmcnt(0)
    s_barrier
    v_mfma_f32_16x16x32_bf16 v[88:91], v[20:23], v[44:47], v[88:91]
    v_xor_b32 v0, 0x8000, v0
    v_add_u32 v1, s48, v1
    v_mfma_f32_16x16x32_bf16 v[132:135], v[24:27], v[44:47], v[132:135]
    ds_read_b128 v[4:7], v0 offset:0
    v_mfma_f32_16x16x32_bf16 v[176:179], v[28:31], v[44:47], v[176:179]
    ds_read_b128 v[8:11], v0 offset:2048
    v_mfma_f32_16x16x32_bf16 v[220:223], v[32:35], v[44:47], v[220:223]
    ds_read_b128 v[12:15], v0 offset:4096
    v_mfma_f32_16x16x32_bf16 v[92:95], v[20:23], v[48:51], v[92:95]
    s_sub_u32 s45, s45, 1
    s_cmp_lg_u32 s45, 0
    v_mfma_f32_16x16x32_bf16 v[136:139], v[24:27], v[48:51], v[136:139]
    s_cbranch_scc1 g1d_top
    v_mfma_f32_16x16x32_bf16 v[180:183], v[28:31], v[48:51], v[180:183]
    v_mfma_f32_16x16x32_bf16 v[224:227], v[32:35], v[48:51], v[224:227]
    v_mfma_f32_16x16x32_bf16 v[96:99], v[20:23], v[52:55], v[96:99]
    v_mfma_f32_16x16x32_bf16 v[140:143], v[24:27], v[52:55], v[140:143]
    v_mfma_f32_16x16x32_bf16 v[184:187], v[28:31], v[52:55], v[184:187]
    v_mfma_f32_16x16x32_bf16 v[228:231], v[32:35], v[52:55], v[228:231]
    v_mfma_f32_16x16x32_bf16 v[100:103], v[20:23], v[56:59], v[100:103]
    v_mfma_f32_16x16x32_bf16 v[144:147], v[24:27], v[56:59], v[144:147]
    v_mfma_f32_16x16x32_bf16 v[188:191], v[28:31], v[56:59], v[188:191]
    v_mfma_f32_16x16x32_bf16 v[232:235], v[32:35], v[56:59], v[232:235]
    v_mfma_f32_16x16x32_bf16 v[104:107], v[20:23], v[60:63], v[104:107]
    v_mfma_f32_16x16x32_bf16 v[148:151], v[24:27], v[60:63], v[148:151]
    v_mfma_f32_16x16x32_bf16 v[192:195], v[28:31], v[60:63], v[192:195]
    v_mfma_f32_16x16x32_bf16 v[236:239], v[32:35], v[60:63], v[236:239]
    v_mfma_f32_16x16x32_bf16 v[108:111], v[20:23], v[64:67], v[108:111]
    v_mfma_f32_16x16x32_bf16 v[152:155], v[24:27], v[64:67], v[152:155]
    v_mfma_f32_16x16x32_bf16 v[196:199], v[28:31], v[64:67], v[196:199]
    v_mfma_f32_16x16x32_bf16 v[240:243], v[32:35], v[64:67], v[240:243]
    v_mfma_f32_16x16x32_bf16 v[112:115], v[20:23], v[68:71], v[112:115]
    v_mfma_f32_16x16x32_bf16 v[156:159], v[24:27], v[68:71], v[156:159]
    v_mfma_f32_16x16x32_bf16 v[200:203], v[28:31], v[68:71], v[200:203]
    v_mfma_f32_16x16x32_bf16 v[244:247], v[32:35], v[68:71], v[244:247]
    v_mfma_f32_16x16x32_bf16 v[116:119], v[20:23], v[72:75], v[116:119]
    v_mfma_f32_16x16x32_bf16 v[160:163], v[24:27], v[72:75], v[160:163]
    v_mfma_f32_16x16x32_bf16 v[204:207], v[28:31], v[72:75], v[204:207]
    v_mfma_f32_16x16x32_bf16 v[248:251], v[32:35], v[72:75], v[248:251]
    v_mfma_f32_16x16x32_bf16 v[120:123], v[20:23], v[76:79], v[120:123]
    v_mfma_f32_16x16x32_bf16 v[164:167], v[24:27], v[76:79], v[164:167]
    v_mfma_f32_16x16x32_bf16 v[208:211], v[28:31], v[76:79], v[208:211]
    v_mfma_f32_16x16x32_bf16 v[252:255], v[32:35], v[76:79], v[252:255]
    s_waitcnt lgkmcnt(0)
    s_nop 7
    s_nop 7
    v_mbcnt_lo_u32_b32 v1, -1, 0
    v_mbcnt_hi_u32_b32 v1, -1, v1
    v_and_b32 v2, 15, v1
    v_lshrrev_b32 v3, 4, v1
    v_and_b32 v4, 1, v3
    v_lshlrev_b32 v4, 5, v4
    v_lshrrev_b32 v5, 1, v3
    v_lshl_add_u32 v4, v5, 4, v4
    v_lshl_add_u32 v4, v2, 6, v4
    s_lshl_b32 s49, s3, 6
    s_add_u32 s49, s49, s40
    s_lshr_b32 s36, s40, 6
    s_lshl_b32 s34, s41, 7
    s_add_u32 s34, s34, s36
    s_add_u32 s34, s34, 1024
    s_lshr_b32 s35, s40, 1
    s_lshl_b32 s37, s41, 2
    s_add_u32 s35, s35, s37
    s_add_u32 s35, s35, 4096
    s_add_u32 s12, s28, 5242880
    s_addc_u32 s13, s29, 0
    s_mov_b32 s14, 8650752
    s_mov_b32 s15, 0x20000
    s_mul_i32 s50, s41, 743424
    s_lshl_b32 s51, s49, 5
    s_add_u32 s50, s50, s51
    v_add_u32 v6, s50, v4
    s_mul_i32 s50, s41, 11
    s_add_u32 s51, s50, 0
    s_cmp_lt_u32 s51, 64
    s_cselect_b32 s48, 0, 0x80008000
    s_mov_b32 s51, 0
    v_cvt_pk_bf16_f32 v16, v80, v81
    v_cvt_pk_bf16_f32 v17, v82, v83
    v_cvt_pk_bf16_f32 v18, v124, v125
    v_cvt_pk_bf16_f32 v19, v126, v127
    v_cvt_pk_bf16_f32 v20, v168, v169
    v_cvt_pk_bf16_f32 v21, v170, v171
    v_cvt_pk_bf16_f32 v22, v212, v213
    v_cvt_pk_bf16_f32 v23, v214, v215
    v_xor_b32 v16, s48, v16
    v_xor_b32 v17, s48, v17
    v_xor_b32 v18, s48, v18
    v_xor_b32 v19, s48, v19
    v_xor_b32 v20, s48, v20
    v_xor_b32 v21, s48, v21
    v_xor_b32 v22, s48, v22
    v_xor_b32 v23, s48, v23
    s_nop 1
    v_permlane16_swap_b32 v16, v18
    v_permlane16_swap_b32 v17, v19
    v_permlane16_swap_b32 v20, v22
    v_permlane16_swap_b32 v21, v23
    buffer_store_dwordx4 v[16:19], v6, s[12:15], s51 offen sc1
    buffer_store_dwordx4 v[20:23], v6, s[12:15], s51 offen offset:1024 sc1
    s_add_u32 s51, s50, 1
    s_cmp_lt_u32 s51, 64
    s_cselect_b32 s48, 0, 0x80008000
    s_mov_b32 s51, 67584
    v_cvt_pk_bf16_f32 v24, v84, v85
    v_cvt_pk_bf16_f32 v25, v86, v87
    v_cvt_pk_bf16_f32 v26, v128, v129
    v_cvt_pk_bf16_f32 v27, v130, v131
    v_cvt_pk_bf16_f32 v28, v172, v173
    v_cvt_pk_bf16_f32 v29, v174, v175
    v_cvt_pk_bf16_f32 v30, v216, v217
    v_cvt_pk_bf16_f32 v31, v218, v219
    v_xor_b32 v24, s48, v24
    v_xor_b32 v25, s48, v25
    v_xor_b32 v26, s48, v26
    v_xor_b32 v27, s48, v27
    v_xor_b32 v28, s48, v28
    v_xor_b32 v29, s48, v29
    v_xor_b32 v30, s48, v30
    v_xor_b32 v31, s48, v31
    s_nop 1
    v_permlane16_swap_b32 v24, v26
    v_permlane16_swap_b32 v25, v27
    v_permlane16_swap_b32 v28, v30
    v_permlane16_swap_b32 v29, v31
    buffer_store_dwordx4 v[24:27], v6, s[12:15], s51 offen sc1
    buffer_store_dwordx4 v[28:31], v6, s[12:15], s51 offen offset:1024 sc1
    s_add_u32 s51, s50, 2
    s_cmp_lt_u32 s51, 64
    s_cselect_b32 s48, 0, 0x80008000
    s_mov_b32 s51, 135168
    v_cvt_pk_bf16_f32 v32, v88, v89
    v_cvt_pk_bf16_f32 v33, v90, v91
    v_cvt_pk_bf16_f32 v34, v132, v133
    v_cvt_pk_bf16_f32 v35, v134, v135
    v_cvt_pk_bf16_f32 v36, v176, v177
    v_cvt_pk_bf16_f32 v37, v178, v179
    v_cvt_pk_bf16_f32 v38, v220, v221
    v_cvt_pk_bf16_f32 v39, v222, v223
    v_xor_b32 v32, s48, v32
    v_xor_b32 v33, s48, v33
    v_xor_b32 v34, s48, v34
    v_xor_b32 v35, s48, v35
    v_xor_b32 v36, s48, v36
    v_xor_b32 v37, s48, v37
    v_xor_b32 v38, s48, v38
    v_xor_b32 v39, s48, v39
    s_nop 1
    v_permlane16_swap_b32 v32, v34
    v_permlane16_swap_b32 v33, v35
    v_permlane16_swap_b32 v36, v38
    v_permlane16_swap_b32 v37, v39
    buffer_store_dwordx4 v[32:35], v6, s[12:15], s51 offen sc1
    buffer_store_dwordx4 v[36:39], v6, s[12:15], s51 offen offset:1024 sc1
    s_add_u32 s51, s50, 3
    s_cmp_lt_u32 s51, 64
    s_cselect_b32 s48, 0, 0x80008000
    s_mov_b32 s51, 202752
    v_cvt_pk_bf16_f32 v40, v92, v93
    v_cvt_pk_bf16_f32 v41, v94, v95
    v_cvt_pk_bf16_f32 v42, v136, v137
    v_cvt_pk_bf16_f32 v43, v138, v139
    v_cvt_pk_bf16_f32 v44, v180, v181
    v_cvt_pk_bf16_f32 v45, v182, v183
    v_cvt_pk_bf16_f32 v46, v224, v225
    v_cvt_pk_bf16_f32 v47, v226, v227
    v_xor_b32 v40, s48, v40
    v_xor_b32 v41, s48, v41
    v_xor_b32 v42, s48, v42
    v_xor_b32 v43, s48, v43
    v_xor_b32 v44, s48, v44
    v_xor_b32 v45, s48, v45
    v_xor_b32 v46, s48, v46
    v_xor_b32 v47, s48, v47
    s_nop 1
    v_permlane16_swap_b32 v40, v42
    v_permlane16_swap_b32 v41, v43
    v_permlane16_swap_b32 v44, v46
    v_permlane16_swap_b32 v45, v47
    buffer_store_dwordx4 v[40:43], v6, s[12:15], s51 offen sc1
    buffer_store_dwordx4 v[44:47], v6, s[12:15], s51 offen offset:1024 sc1
    s_add_u32 s51, s50, 4
    s_cmp_lt_u32 s51, 64
    s_cselect_b32 s48, 0, 0x80008000
    s_mov_b32 s51, 270336
    v_cvt_pk_bf16_f32 v16, v96, v97
    v_cvt_pk_bf16_f32 v17, v98, v99
    v_cvt_pk_bf16_f32 v18, v140, v141
    v_cvt_pk_bf16_f32 v19, v142, v143
    v_cvt_pk_bf16_f32 v20, v184, v185
    v_cvt_pk_bf16_f32 v21, v186, v187
    v_cvt_pk_bf16_f32 v22, v228, v229
    v_cvt_pk_bf16_f32 v23, v230, v231
    v_xor_b32 v16, s48, v16
    v_xor_b32 v17, s48, v17
    v_xor_b32 v18, s48, v18
    v_xor_b32 v19, s48, v19
    v_xor_b32 v20, s48, v20
    v_xor_b32 v21, s48, v21
    v_xor_b32 v22, s48, v22
    v_xor_b32 v23, s48, v23
    s_nop 1
    v_permlane16_swap_b32 v16, v18
    v_permlane16_swap_b32 v17, v19
    v_permlane16_swap_b32 v20, v22
    v_permlane16_swap_b32 v21, v23
    buffer_store_dwordx4 v[16:19], v6, s[12:15], s51 offen sc1
    buffer_store_dwordx4 v[20:23], v6, s[12:15], s51 offen offset:1024 sc1
    s_add_u32 s51, s50, 5
    s_cmp_lt_u32 s51, 64
    s_cselect_b32 s48, 0, 0x80008000
    s_mov_b32 s51, 337920
    v_cvt_pk_bf16_f32 v24, v100, v101
    v_cvt_pk_bf16_f32 v25, v102, v103
    v_cvt_pk_bf16_f32 v26, v144, v145
    v_cvt_pk_bf16_f32 v27, v146, v147
    v_cvt_pk_bf16_f32 v28, v188, v189
    v_cvt_pk_bf16_f32 v29, v190, v191
    v_cvt_pk_bf16_f32 v30, v232, v233
    v_cvt_pk_bf16_f32 v31, v234, v235
    v_xor_b32 v24, s48, v24
    v_xor_b32 v25, s48, v25
    v_xor_b32 v26, s48, v26
    v_xor_b32 v27, s48, v27
    v_xor_b32 v28, s48, v28
    v_xor_b32 v29, s48, v29
    v_xor_b32 v30, s48, v30
    v_xor_b32 v31, s48, v31
    s_nop 1
    v_permlane16_swap_b32 v24, v26
    v_permlane16_swap_b32 v25, v27
    v_permlane16_swap_b32 v28, v30
    v_permlane16_swap_b32 v29, v31
    buffer_store_dwordx4 v[24:27], v6, s[12:15], s51 offen sc1
    buffer_store_dwordx4 v[28:31], v6, s[12:15], s51 offen offset:1024 sc1
    s_add_u32 s51, s50, 6
    s_cmp_lt_u32 s51, 64
    s_cselect_b32 s48, 0, 0x80008000
    s_mov_b32 s51, 405504
    v_cvt_pk_bf16_f32 v32, v104, v105
    v_cvt_pk_bf16_f32 v33, v106, v107
    v_cvt_pk_bf16_f32 v34, v148, v149
    v_cvt_pk_bf16_f32 v35, v150, v151
    v_cvt_pk_bf16_f32 v36, v192, v193
    v_cvt_pk_bf16_f32 v37, v194, v195
    v_cvt_pk_bf16_f32 v38, v236, v237
    v_cvt_pk_bf16_f32 v39, v238, v239
    v_xor_b32 v32, s48, v32
    v_xor_b32 v33, s48, v33
    v_xor_b32 v34, s48, v34
    v_xor_b32 v35, s48, v35
    v_xor_b32 v36, s48, v36
    v_xor_b32 v37, s48, v37
    v_xor_b32 v38, s48, v38
    v_xor_b32 v39, s48, v39
    s_nop 1
    v_permlane16_swap_b32 v32, v34
    v_permlane16_swap_b32 v33, v35
    v_permlane16_swap_b32 v36, v38
    v_permlane16_swap_b32 v37, v39
    buffer_store_dwordx4 v[32:35], v6, s[12:15], s51 offen sc1
    buffer_store_dwordx4 v[36:39], v6, s[12:15], s51 offen offset:1024 sc1
    s_add_u32 s51, s50, 7
    s_cmp_lt_u32 s51, 64
    s_cselect_b32 s48, 0, 0x80008000
    s_mov_b32 s51, 473088
    v_cvt_pk_bf16_f32 v40, v108, v109
    v_cvt_pk_bf16_f32 v41, v110, v111
    v_cvt_pk_bf16_f32 v42, v152, v153
    v_cvt_pk_bf16_f32 v43, v154, v155
    v_cvt_pk_bf16_f32 v44, v196, v197
    v_cvt_pk_bf16_f32 v45, v198, v199
    v_cvt_pk_bf16_f32 v46, v240, v241
    v_cvt_pk_bf16_f32 v47, v242, v243
    v_xor_b32 v40, s48, v40
    v_xor_b32 v41, s48, v41
    v_xor_b32 v42, s48, v42
    v_xor_b32 v43, s48, v43
    v_xor_b32 v44, s48, v44
    v_xor_b32 v45, s48, v45
    v_xor_b32 v46, s48, v46
    v_xor_b32 v47, s48, v47
    s_nop 1
    v_permlane16_swap_b32 v40, v42
    v_permlane16_swap_b32 v41, v43
    v_permlane16_swap_b32 v44, v46
    v_permlane16_swap_b32 v45, v47
    buffer_store_dwordx4 v[40:43], v6, s[12:15], s51 offen sc1
    buffer_store_dwordx4 v[44:47], v6, s[12:15], s51 offen offset:1024 sc1
    s_add_u32 s51, s50, 8
    s_cmp_lt_u32 s51, 64
    s_cselect_b32 s48, 0, 0x80008000
    s_mov_b32 s51, 540672
    v_cvt_pk_bf16_f32 v16, v112, v113
    v_cvt_pk_bf16_f32 v17, v114, v115
    v_cvt_pk_bf16_f32 v18, v156, v157
    v_cvt_pk_bf16_f32 v19, v158, v159
    v_cvt_pk_bf16_f32 v20, v200, v201
    v_cvt_pk_bf16_f32 v21, v202, v203
    v_cvt_pk_bf16_f32 v22, v244, v245
    v_cvt_pk_bf16_f32 v23, v246, v247
    v_xor_b32 v16, s48, v16
    v_xor_b32 v17, s48, v17
    v_xor_b32 v18, s48, v18
    v_xor_b32 v19, s48, v19
    v_xor_b32 v20, s48, v20
    v_xor_b32 v21, s48, v21
    v_xor_b32 v22, s48, v22
    v_xor_b32 v23, s48, v23
    s_nop 1
    v_permlane16_swap_b32 v16, v18
    v_permlane16_swap_b32 v17, v19
    v_permlane16_swap_b32 v20, v22
    v_permlane16_swap_b32 v21, v23
    buffer_store_dwordx4 v[16:19], v6, s[12:15], s51 offen sc1
    buffer_store_dwordx4 v[20:23], v6, s[12:15], s51 offen offset:1024 sc1
    s_add_u32 s51, s50, 9
    s_cmp_lt_u32 s51, 64
    s_cselect_b32 s48, 0, 0x80008000
    s_mov_b32 s51, 608256
    v_cvt_pk_bf16_f32 v24, v116, v117
    v_cvt_pk_bf16_f32 v25, v118, v119
    v_cvt_pk_bf16_f32 v26, v160, v161
    v_cvt_pk_bf16_f32 v27, v162, v163
    v_cvt_pk_bf16_f32 v28, v204, v205
    v_cvt_pk_bf16_f32 v29, v206, v207
    v_cvt_pk_bf16_f32 v30, v248, v249
    v_cvt_pk_bf16_f32 v31, v250, v251
    v_xor_b32 v24, s48, v24
    v_xor_b32 v25, s48, v25
    v_xor_b32 v26, s48, v26
    v_xor_b32 v27, s48, v27
    v_xor_b32 v28, s48, v28
    v_xor_b32 v29, s48, v29
    v_xor_b32 v30, s48, v30
    v_xor_b32 v31, s48, v31
    s_nop 1
    v_permlane16_swap_b32 v24, v26
    v_permlane16_swap_b32 v25, v27
    v_permlane16_swap_b32 v28, v30
    v_permlane16_swap_b32 v29, v31
    buffer_store_dwordx4 v[24:27], v6, s[12:15], s51 offen sc1
    buffer_store_dwordx4 v[28:31], v6, s[12:15], s51 offen offset:1024 sc1
    s_add_u32 s51, s50, 10
    s_cmp_lt_u32 s51, 64
    s_cselect_b32 s48, 0, 0x80008000
    s_mov_b32 s51, 675840
    v_cvt_pk_bf16_f32 v32, v120, v121
    v_cvt_pk_bf16_f32 v33, v122, v123
    v_cvt_pk_bf16_f32 v34, v164, v165
    v_cvt_pk_bf16_f32 v35, v166, v167
    v_cvt_pk_bf16_f32 v36, v208, v209
    v_cvt_pk_bf16_f32 v37, v210, v211
    v_cvt_pk_bf16_f32 v38, v252, v253
    v_cvt_pk_bf16_f32 v39, v254, v255
    v_xor_b32 v32, s48, v32
    v_xor_b32 v33, s48, v33
    v_xor_b32 v34, s48, v34
    v_xor_b32 v35, s48, v35
    v_xor_b32 v36, s48, v36
    v_xor_b32 v37, s48, v37
    v_xor_b32 v38, s48, v38
    v_xor_b32 v39, s48, v39
    s_nop 1
    v_permlane16_swap_b32 v32, v34
    v_permlane16_swap_b32 v33, v35
    v_permlane16_swap_b32 v36, v38
    v_permlane16_swap_b32 v37, v39
    buffer_store_dwordx4 v[32:35], v6, s[12:15], s51 offen sc1
    buffer_store_dwordx4 v[36:39], v6, s[12:15], s51 offen offset:1024 sc1
    s_mov_b32 s94, 99
    s_waitcnt vmcnt(0)
    v_mov_b32 v0, 155656
    v_mov_b32 v1, 1
    s_mov_b64 exec, 1
    ds_add_rtn_u32 v1, v0, v1
    s_waitcnt lgkmcnt(0)
    v_cmp_eq_u32 vcc, 3, v1
    s_cbranch_vccz sig_g1d
    v_mov_b32 v0, 0
    v_mov_b32 v1, s95
    buffer_store_dword v1, v0, s[96:99], s34 offen sc1
sig_g1d:
    s_mov_b64 exec, -1
    s_branch g2_comp
g1m_start:
    s_cmp_ge_u32 s39, 4
    s_cbranch_scc0 g1m_comp
    s_lshl_b32 s49, s3, 6
    s_add_u32 s49, s49, s40
    v_lshrrev_b32 v2, 2, v1
    v_and_b32 v2, 7, v2
    s_mov_b32 s50, 2176
    v_mul_lo_u32 v2, v2, s50
    v_lshrrev_b32 v3, 5, v1
    v_lshl_add_u32 v2, v3, 6, v2
    v_lshrrev_b32 v3, 3, v1
    v_and_b32 v3, 2, v3
    v_and_b32 v4, 3, v1
    v_xor_b32 v3, v3, v4
    v_lshlrev_b32 v3, 4, v3
    v_xor_b32 v4, 48, v3
    v_add_u32 v3, v3, v2
    v_add_u32 v4, v4, v2
    s_mul_i32 s49, s49, 2176
    s_add_u32 s50, s49, 0
    v_add_u32 v8, s50, v3
    s_add_u32 s50, s49, 16384
    v_add_u32 v9, s50, v4
    s_add_u32 s50, s49, 32768
    v_add_u32 v10, s50, v3
    s_add_u32 s50, s49, 49152
    v_add_u32 v11, s50, v4
    s_add_u32 s50, s49, 69632
    v_add_u32 v12, s50, v3
    s_add_u32 s50, s49, 86016
    v_add_u32 v13, s50, v4
    s_add_u32 s50, s49, 102400
    v_add_u32 v14, s50, v3
    s_add_u32 s50, s49, 118784
    v_add_u32 v15, s50, v4
    s_lshl_b32 s52, s3, 13
    s_add_u32 s53, s52, 4096
    s_mul_i32 s54, s3, 4096
    s_add_u32 s54, s54, 65536
    v_lshrrev_b32 v2, 2, v1
    v_and_b32 v2, 7, v2
    s_mov_b32 s50, 2048
    v_mul_lo_u32 v2, v2, s50
    v_lshrrev_b32 v3, 5, v1
    v_lshl_add_u32 v2, v3, 6, v2
    v_lshrrev_b32 v3, 3, v1
    v_and_b32 v3, 2, v3
    v_and_b32 v4, 3, v1
    v_xor_b32 v3, v3, v4
    v_lshlrev_b32 v3, 4, v3
    v_xor_b32 v4, 48, v3
    v_add_u32 v3, v3, v2
    v_add_u32 v4, v4, v2
    s_mul_i32 s49, s41, 22
    s_mul_i32 s50, s3, 4
    s_add_u32 s50, s50, 0
    s_add_u32 s49, s49, s50
    s_cmp_lt_u32 s49, 128
    s_cselect_b32 s64, s20, s22
    s_cselect_b32 s65, s21, s23
    s_and_b32 s49, s49, 127
    s_lshl_b32 s49, s49, 14
    s_cmp_lt_u32 s50, 14
    s_cselect_b32 s66, 2097152, 0
    s_mov_b32 s67, 0x20000
    s_cselect_b32 s49, s49, 4096
    v_add_u32 v16, s49, v3
    s_mul_i32 s49, s41, 22
    s_mul_i32 s50, s3, 4
    s_add_u32 s50, s50, 1
    s_add_u32 s49, s49, s50
    s_cmp_lt_u32 s49, 128
    s_cselect_b32 s68, s20, s22
    s_cselect_b32 s69, s21, s23
    s_and_b32 s49, s49, 127
    s_lshl_b32 s49, s49, 14
    s_cmp_lt_u32 s50, 14
    s_cselect_b32 s70, 2097152, 0
    s_mov_b32 s71, 0x20000
    s_cselect_b32 s49, s49, 4096
    s_sub_u32 s49, s49, 1024
    v_add_u32 v17, s49, v4
    s_mul_i32 s49, s41, 22
    s_mul_i32 s50, s3, 4
    s_add_u32 s50, s50, 2
    s_add_u32 s49, s49, s50
    s_cmp_lt_u32 s49, 128
    s_cselect_b32 s72, s20, s22
    s_cselect_b32 s73, s21, s23
    s_and_b32 s49, s49, 127
    s_lshl_b32 s49, s49, 14
    s_cmp_lt_u32 s50, 14
    s_cselect_b32 s74, 2097152, 0
    s_mov_b32 s75, 0x20000
    s_cselect_b32 s49, s49, 4096
    s_sub_u32 s49, s49, 2048
    v_add_u32 v18, s49, v3
    s_mul_i32 s49, s41, 22
    s_mul_i32 s50, s3, 4
    s_add_u32 s50, s50, 3
    s_add_u32 s49, s49, s50
    s_cmp_lt_u32 s49, 128
    s_cselect_b32 s76, s20, s22
    s_cselect_b32 s77, s21, s23
    s_and_b32 s49, s49, 127
    s_lshl_b32 s49, s49, 14
    s_cmp_lt_u32 s50, 14
    s_cselect_b32 s78, 2097152, 0
    s_mov_b32 s79, 0x20000
    s_cselect_b32 s49, s49, 4096
    s_sub_u32 s49, s49, 3072
    v_add_u32 v19, s49, v4
    s_mul_i32 s55, s3, 3072
    s_add_u32 s55, s55, 81920
    s_mov_b32 s80, s24
    s_mov_b32 s81, s25
    s_mov_b32 s82, 7340032
    s_mov_b32 s83, 0x20000
    s_mul_i32 s49, s41, 352
    s_sub_u32 s49, s49, 3872
    s_mul_i32 s50, s3, 192
    v_add_u32 v2, s50, v1
    v_mul_u32_u24 v3, 745, v2
    v_lshrrev_b32 v3, 16, v3
    v_mul_u32_u24 v4, 88, v3
    v_sub_u32 v2, v2, v4
    v_mul_u32_u24 v4, 103, v2
    v_lshrrev_b32 v4, 10, v4
    v_mul_u32_u24 v5, 10, v4
    v_sub_u32 v5, v2, v5
    v_lshl_add_u32 v3, v3, 3, v4
    v_mul_u32_u24 v6, 7168, v3
    v_lshl_add_u32 v6, v5, 4, v6
    v_add_u32 v6, s49, v6
    v_cmp_gt_u32 vcc, 8, v4
    v_mov_b32 v7, 0x7ff00000
    s_nop 0
    v_cndmask_b32 v6, v7, v6, vcc
    v_cmp_gt_u32 vcc, 8, v5
    s_nop 1
    v_cndmask_b32 v6, v7, v6, vcc
    v_cmp_gt_u32 vcc, 64, v3
    s_nop 1
    v_cndmask_b32 v20, v7, v6, vcc
    v_add_u32 v2, s50, v1
    v_add_u32 v2, 64, v2
    v_mul_u32_u24 v3, 745, v2
    v_lshrrev_b32 v3, 16, v3
    v_mul_u32_u24 v4, 88, v3
    v_sub_u32 v2, v2, v4
    v_mul_u32_u24 v4, 103, v2
    v_lshrrev_b32 v4, 10, v4
    v_mul_u32_u24 v5, 10, v4
    v_sub_u32 v5, v2, v5
    v_lshl_add_u32 v3, v3, 3, v4
    v_mul_u32_u24 v6, 7168, v3
    v_lshl_add_u32 v6, v5, 4, v6
    v_add_u32 v6, s49, v6
    v_subrev_u32 v6, 1024, v6
    v_cmp_gt_u32 vcc, 8, v4
    v_mov_b32 v7, 0x7ff00000
    s_nop 0
    v_cndmask_b32 v6, v7, v6, vcc
    v_cmp_gt_u32 vcc, 8, v5
    s_nop 1
    v_cndmask_b32 v6, v7, v6, vcc
    v_cmp_gt_u32 vcc, 64, v3
    s_nop 1
    v_cndmask_b32 v21, v7, v6, vcc
    v_add_u32 v2, s50, v1
    v_add_u32 v2, 128, v2
    v_mul_u32_u24 v3, 745, v2
    v_lshrrev_b32 v3, 16, v3
    v_mul_u32_u24 v4, 88, v3
    v_sub_u32 v2, v2, v4
    v_mul_u32_u24 v4, 103, v2
    v_lshrrev_b32 v4, 10, v4
    v_mul_u32_u24 v5, 10, v4
    v_sub_u32 v5, v2, v5
    v_lshl_add_u32 v3, v3, 3, v4
    v_mul_u32_u24 v6, 7168, v3
    v_lshl_add_u32 v6, v5, 4, v6
    v_add_u32 v6, s49, v6
    v_subrev_u32 v6, 2048, v6
    v_cmp_gt_u32 vcc, 8, v4
    v_mov_b32 v7, 0x7ff00000
    s_nop 0
    v_cndmask_b32 v6, v7, v6, vcc
    v_cmp_gt_u32 vcc, 8, v5
    s_nop 1
    v_cndmask_b32 v6, v7, v6, vcc
    v_cmp_gt_u32 vcc, 64, v3
    s_nop 1
    v_cndmask_b32 v22, v7, v6, vcc
    s_mov_b32 s46, 0
    s_mov_b32 s61, s60
    s_mov_b32 s92, 0
    s_mov_b32 s93, s60
    s_add_u32 m0, s92, s54
    s_nop 0
    buffer_load_dwordx4 v16, s[64:67], s43 offen lds
    buffer_load_dwordx4 v17, s[68:71], s43 offen offset:1024 lds
    buffer_load_dwordx4 v18, s[72:75], s43 offen offset:2048 lds
    buffer_load_dwordx4 v19, s[76:79], s43 offen offset:3072 lds
    s_add_u32 m0, s92, s55
    s_nop 0
    buffer_load_dwordx4 v20, s[80:83], s44 offen lds
    buffer_load_dwordx4 v21, s[80:83], s44 offen offset:1024 lds
    buffer_load_dwordx4 v22, s[80:83], s44 offen offset:2048 lds
    s_add_u32 s43, s43, 128
    s_add_u32 s44, s44, 458752
    s_add_u32 s92, s92, 28672
    s_cmp_ge_u32 s92, 86016
    s_cselect_b32 s92, 0, s92
    s_sub_u32 s93, s93, 1
    s_cmp_lt_i32 s93, 1
    s_cselect_b32 s66, 0, s66
    s_cselect_b32 s70, 0, s70
    s_cselect_b32 s74, 0, s74
    s_cselect_b32 s78, 0, s78
    s_cselect_b32 s82, 0, s82
    s_add_u32 m0, s92, s54
    s_nop 0
    buffer_load_dwordx4 v16, s[64:67], s43 offen lds
    buffer_load_dwordx4 v17, s[68:71], s43 offen offset:1024 lds
    buffer_load_dwordx4 v18, s[72:75], s43 offen offset:2048 lds
    buffer_load_dwordx4 v19, s[76:79], s43 offen offset:3072 lds
    s_add_u32 m0, s92, s55
    s_nop 0
    buffer_load_dwordx4 v20, s[80:83], s44 offen lds
    buffer_load_dwordx4 v21, s[80:83], s44 offen offset:1024 lds
    buffer_load_dwordx4 v22, s[80:83], s44 offen offset:2048 lds
    s_add_u32 s43, s43, 128
    s_add_u32 s44, s44, 458752
    s_add_u32 s92, s92, 28672
    s_cmp_ge_u32 s92, 86016
    s_cselect_b32 s92, 0, s92
    s_sub_u32 s93, s93, 1
    s_cmp_lt_i32 s93, 1
    s_cselect_b32 s66, 0, s66
    s_cselect_b32 s70, 0, s70
    s_cselect_b32 s74, 0, s74
    s_cselect_b32 s78, 0, s78
    s_cselect_b32 s82, 0, s82
    s_add_u32 m0, s92, s54
    s_nop 0
    buffer_load_dwordx4 v16, s[64:67], s43 offen lds
    buffer_load_dwordx4 v17, s[68:71], s43 offen offset:1024 lds
    buffer_load_dwordx4 v18, s[72:75], s43 offen offset:2048 lds
    buffer_load_dwordx4 v19, s[76:79], s43 offen offset:3072 lds
    s_add_u32 m0, s92, s55
    s_nop 0
    buffer_load_dwordx4 v20, s[80:83], s44 offen lds
    buffer_load_dwordx4 v21, s[80:83], s44 offen offset:1024 lds
    buffer_load_dwordx4 v22, s[80:83], s44 offen offset:2048 lds
    s_add_u32 s43, s43, 128
    s_add_u32 s44, s44, 458752
    s_add_u32 s92, s92, 28672
    s_cmp_ge_u32 s92, 86016
    s_cselect_b32 s92, 0, s92
    s_sub_u32 s93, s93, 1
    s_cmp_lt_i32 s93, 1
    s_cselect_b32 s66, 0, s66
    s_cselect_b32 s70, 0, s70
    s_cselect_b32 s74, 0, s74
    s_cselect_b32 s78, 0, s78
    s_cselect_b32 s82, 0, s82
    s_waitcnt vmcnt(21)
    s_barrier
    v_mov_b32 v2, 155680
    ds_read_b32 v2, v2
    s_waitcnt lgkmcnt(0)
    v_readfirstlane_b32 s95, v2
    s_nop 3
    s_cmp_lg_u32 s3, 0
    s_cbranch_scc1 g1m_nf
    s_lshl_b32 s37, s2, 2
    v_mov_b32 v2, 0
    v_mov_b32 v3, s95
    s_mov_b64 exec, 1
    buffer_store_dword v3, v2, s[96:99], s37 offen sc1
    s_mov_b64 exec, -1
g1m_nf:
    s_lshr_b32 s49, s40, 1
    v_and_b32 v2, 31, v1
    v_lshl_add_u32 v2, v2, 2, s49
    v_mov_b32 v4, 155700
    s_cmp_lg_u32 s3, 0
    s_cbranch_scc1 lw_g1m
    s_mov_b32 s51, 200000
poll_g1m:
    buffer_load_dword v3, v2, s[96:99], 0 offen sc1
    s_waitcnt vmcnt(0)
    v_cmp_ne_u32 vcc, s95, v3
    s_cbranch_vccz polld_g1m
    s_sleep 1
    s_sub_u32 s51, s51, 1
    s_cmp_lg_u32 s51, 0
    s_cbranch_scc1 poll_g1m
polld_g1m:
    v_mov_b32 v3, 1
    ds_write_b32 v4, v3
    s_branch lwd_g1m
lw_g1m:
    s_mov_b32 s51, 4000000
lwl_g1m:
    ds_read_b32 v3, v4
    s_waitcnt lgkmcnt(0)
    v_cmp_ne_u32 vcc, 1, v3
    s_cbranch_vccz lwd_g1m
    s_sleep 1
    s_sub_u32 s51, s51, 1
    s_cmp_lg_u32 s51, 0
    s_cbranch_scc1 lwl_g1m
lwd_g1m:
    s_add_u32 m0, s46, s52
    s_nop 0
    buffer_load_dwordx4 v8, s[8:11], s42 offen sc1 lds
    buffer_load_dwordx4 v9, s[8:11], s42 offen offset:1024 sc1 lds
    buffer_load_dwordx4 v10, s[8:11], s42 offen offset:2048 sc1 lds
    buffer_load_dwordx4 v11, s[8:11], s42 offen offset:3072 sc1 lds
    s_add_u32 m0, s46, s53
    s_nop 0
    buffer_load_dwordx4 v12, s[8:11], s42 offen sc1 lds
    buffer_load_dwordx4 v13, s[8:11], s42 offen offset:1024 sc1 lds
    buffer_load_dwordx4 v14, s[8:11], s42 offen offset:2048 sc1 lds
    buffer_load_dwordx4 v15, s[8:11], s42 offen offset:3072 sc1 lds
    s_add_u32 s42, s42, 128
    s_add_u32 s46, s46, 32768
    s_cmp_ge_u32 s46, 65536
    s_cselect_b32 s46, 0, s46
    s_sub_u32 s61, s61, 1
    s_cmp_lt_i32 s61, 1
    s_cselect_b32 s10, 0, s10
    s_add_u32 m0, s46, s52
    s_nop 0
    buffer_load_dwordx4 v8, s[8:11], s42 offen sc1 lds
    buffer_load_dwordx4 v9, s[8:11], s42 offen offset:1024 sc1 lds
    buffer_load_dwordx4 v10, s[8:11], s42 offen offset:2048 sc1 lds
    buffer_load_dwordx4 v11, s[8:11], s42 offen offset:3072 sc1 lds
    s_add_u32 m0, s46, s53
    s_nop 0
    buffer_load_dwordx4 v12, s[8:11], s42 offen sc1 lds
    buffer_load_dwordx4 v13, s[8:11], s42 offen offset:1024 sc1 lds
    buffer_load_dwordx4 v14, s[8:11], s42 offen offset:2048 sc1 lds
    buffer_load_dwordx4 v15, s[8:11], s42 offen offset:3072 sc1 lds
    s_add_u32 s42, s42, 128
    s_add_u32 s46, s46, 32768
    s_cmp_ge_u32 s46, 65536
    s_cselect_b32 s46, 0, s46
    s_sub_u32 s61, s61, 1
    s_cmp_lt_i32 s61, 1
    s_cselect_b32 s10, 0, s10
    s_waitcnt vmcnt(8)
    s_barrier
    s_mov_b32 s45, s60
    s_waitcnt vmcnt(0)
    s_branch g1m_lmid
g1m_lloop:
    s_waitcnt vmcnt(7)
g1m_lmid:
    s_barrier
    s_add_u32 m0, s46, s52
    s_nop 0
    buffer_load_dwordx4 v8, s[8:11], s42 offen sc1 lds
    buffer_load_dwordx4 v9, s[8:11], s42 offen offset:1024 sc1 lds
    buffer_load_dwordx4 v10, s[8:11], s42 offen offset:2048 sc1 lds
    buffer_load_dwordx4 v11, s[8:11], s42 offen offset:3072 sc1 lds
    s_add_u32 m0, s46, s53
    s_nop 0
    buffer_load_dwordx4 v12, s[8:11], s42 offen sc1 lds
    buffer_load_dwordx4 v13, s[8:11], s42 offen offset:1024 sc1 lds
    buffer_load_dwordx4 v14, s[8:11], s42 offen offset:2048 sc1 lds
    buffer_load_dwordx4 v15, s[8:11], s42 offen offset:3072 sc1 lds
    s_add_u32 m0, s92, s54
    s_nop 0
    buffer_load_dwordx4 v16, s[64:67], s43 offen lds
    buffer_load_dwordx4 v17, s[68:71], s43 offen offset:1024 lds
    buffer_load_dwordx4 v18, s[72:75], s43 offen offset:2048 lds
    buffer_load_dwordx4 v19, s[76:79], s43 offen offset:3072 lds
    s_add_u32 m0, s92, s55
    s_nop 0
    buffer_load_dwordx4 v20, s[80:83], s44 offen lds
    buffer_load_dwordx4 v21, s[80:83], s44 offen offset:1024 lds
    buffer_load_dwordx4 v22, s[80:83], s44 offen offset:2048 lds
    s_add_u32 s42, s42, 128
    s_add_u32 s46, s46, 32768
    s_cmp_ge_u32 s46, 65536
    s_cselect_b32 s46, 0, s46
    s_sub_u32 s61, s61, 1
    s_cmp_lt_i32 s61, 1
    s_cselect_b32 s10, 0, s10
    s_add_u32 s43, s43, 128
    s_add_u32 s44, s44, 458752
    s_add_u32 s92, s92, 28672
    s_cmp_ge_u32 s92, 86016
    s_cselect_b32 s92, 0, s92
    s_sub_u32 s93, s93, 1
    s_cmp_lt_i32 s93, 1
    s_cselect_b32 s66, 0, s66
    s_cselect_b32 s70, 0, s70
    s_cselect_b32 s74, 0, s74
    s_cselect_b32 s78, 0, s78
    s_cselect_b32 s82, 0, s82
    s_sub_u32 s45, s45, 1
    s_cmp_lg_u32 s45, 0
    s_cbranch_scc1 g1m_lloop
    s_branch g2_loader
g1m_comp:
    s_waitcnt vmcnt(0)
    s_barrier
    v_mov_b32 v4, 155680
    ds_read_b32 v4, v4
    s_waitcnt lgkmcnt(0)
    v_readfirstlane_b32 s95, v4
    s_nop 3
    s_mov_b32 m0, 155904
    s_lshr_b32 s34, s2, 3
    s_cmp_ge_u32 s34, 3
    s_cbranch_scc1 g1m_w1
    s_lshl_b32 s34, s34, 2
    s_add_u32 s34, s34, s3
    s_lshl_b32 s34, s34, 13
    v_lshlrev_b32 v4, 7, v1
    v_add_u32 v4, s34, v4
    v_min_u32 v4, k_done-recurrent_scan__spectral_fnet__dense_activation_gelu__prompt_kernel, v4
    s_getpc_b64 s[34:35]
g1m_pc:
    s_sub_u32 s34, s34, g1m_pc-recurrent_scan__spectral_fnet__dense_activation_gelu__prompt_kernel
    s_subb_u32 s35, s35, 0
    global_load_lds_dword v4, s[34:35]
g1m_w1:
    s_load_dwordx4 s[64:67], s[0:1], 8
    s_load_dwordx2 s[68:69], s[0:1], 64
    s_load_dwordx2 s[70:71], s[0:1], 80
    v_lshlrev_b32 v4, 21, v1
    s_waitcnt lgkmcnt(0)
    s_cmp_eq_u32 s3, 0
    s_cselect_b32 s72, s28, s64
    s_cselect_b32 s73, s29, s65
    s_mov_b32 s74, 8388608
    s_cselect_b32 s74, 67108864, s74
    s_cmp_eq_u32 s3, 2
    s_cselect_b32 s72, s66, s72
    s_cselect_b32 s73, s67, s73
    s_cmp_eq_u32 s3, 3
    s_cselect_b32 s72, s68, s72
    s_cselect_b32 s73, s69, s73
    s_cselect_b32 s74, 7340032, s74
    s_mov_b32 s75, 0x20000
    buffer_load_dword v4, s[72:75], 0 offen lds
    s_mov_b32 s72, s70
    s_mov_b32 s73, s71
    s_mov_b32 s74, 4194304
    s_mov_b32 s75, 0x20000
    buffer_load_dword v4, s[72:75], 0 offen lds
    s_load_dwordx2 s[64:65], s[0:1], 8
    s_load_dwordx2 s[68:69], s[0:1], 16
    s_load_dwordx2 s[70:71], s[0:1], 64
    s_mov_b32 m0, 155904
    s_lshl_b32 s74, s2, 2
    s_add_u32 s74, s74, s3
    s_lshl_b32 s74, s74, 13
    s_mov_b32 s94, s74
    s_mov_b32 s66, 8388608
    s_mov_b32 s67, 0x20000
    s_mov_b32 s72, 8388608
    s_mov_b32 s73, 7340032
    v_cmp_gt_u32 vcc, 16, v1
    v_lshlrev_b32 v30, 7, v1
    v_mov_b32 v31, 0x7ff00000
    v_cndmask_b32 v30, v31, v30, vcc
    s_waitcnt lgkmcnt(0)
    v_mov_b32 v20, v1
    s_mul_i32 s49, s3, 8192
    s_mov_b32 s50, 0
    v_and_b32 v4, 15, v20
    v_lshrrev_b32 v5, 4, v20
    v_lshrrev_b32 v6, 3, v4
    v_lshrrev_b32 v7, 2, v4
    v_and_b32 v7, 1, v7
    v_xor_b32 v7, v7, v6
    v_lshl_add_u32 v7, v7, 1, v6
    v_xor_b32 v7, v7, v5
    v_lshlrev_b32 v7, 4, v7
    v_lshl_add_u32 v15, v4, 6, v7
    v_lshl_add_u32 v7, v6, 10, v7
    v_and_b32 v6, 7, v4
    v_lshl_add_u32 v6, v6, 6, v7
    v_lshrrev_b32 v8, 2, v20
    v_and_b32 v8, 3, v8
    v_and_b32 v9, 3, v20
    s_mul_i32 s51, s50, 22528
    s_add_u32 s51, s51, 65536
    v_add_u32 v10, s51, v6
    v_lshl_add_u32 v12, v5, 3, v8
    v_mul_u32_u24 v12, 160, v12
    v_lshl_add_u32 v12, v5, 7, v12
    v_lshl_add_u32 v12, v9, 3, v12
    v_add_u32 v12, 81920, v12
    v_mov_b32 v1, v10
    v_mov_b32 v2, v12
    v_add_u32 v0, s49, v6
    v_mov_b32 v80, 0
    v_mov_b32 v81, 0
    v_mov_b32 v82, 0
    v_mov_b32 v83, 0
    v_mov_b32 v84, 0
    v_mov_b32 v85, 0
    v_mov_b32 v86, 0
    v_mov_b32 v87, 0
    v_mov_b32 v88, 0
    v_mov_b32 v89, 0
    v_mov_b32 v90, 0
    v_mov_b32 v91, 0
    v_mov_b32 v92, 0
    v_mov_b32 v93, 0
    v_mov_b32 v94, 0
    v_mov_b32 v95, 0
    v_mov_b32 v96, 0
    v_mov_b32 v97, 0
    v_mov_b32 v98, 0
    v_mov_b32 v99, 0
    v_mov_b32 v100, 0
    v_mov_b32 v101, 0
    v_mov_b32 v102, 0
    v_mov_b32 v103, 0
    v_mov_b32 v104, 0
    v_mov_b32 v105, 0
    v_mov_b32 v106, 0
    v_mov_b32 v107, 0
    v_mov_b32 v108, 0
    v_mov_b32 v109, 0
    v_mov_b32 v110, 0
    v_mov_b32 v111, 0
    v_mov_b32 v112, 0
    v_mov_b32 v113, 0
    v_mov_b32 v114, 0
    v_mov_b32 v115, 0
    v_mov_b32 v116, 0
    v_mov_b32 v117, 0
    v_mov_b32 v118, 0
    v_mov_b32 v119, 0
    v_mov_b32 v120, 0
    v_mov_b32 v121, 0
    v_mov_b32 v122, 0
    v_mov_b32 v123, 0
    v_mov_b32 v124, 0
    v_mov_b32 v125, 0
    v_mov_b32 v126, 0
    v_mov_b32 v127, 0
    v_mov_b32 v128, 0
    v_mov_b32 v129, 0
    v_mov_b32 v130, 0
    v_mov_b32 v131, 0
    v_mov_b32 v132, 0
    v_mov_b32 v133, 0
    v_mov_b32 v134, 0
    v_mov_b32 v135, 0
    v_mov_b32 v136, 0
    v_mov_b32 v137, 0
    v_mov_b32 v138, 0
    v_mov_b32 v139, 0
    v_mov_b32 v140, 0
    v_mov_b32 v141, 0
    v_mov_b32 v142, 0
    v_mov_b32 v143, 0
    v_mov_b32 v144, 0
    v_mov_b32 v145, 0
    v_mov_b32 v146, 0
    v_mov_b32 v147, 0
    v_mov_b32 v148, 0
    v_mov_b32 v149, 0
    v_mov_b32 v150, 0
    v_mov_b32 v151, 0
    v_mov_b32 v152, 0
    v_mov_b32 v153, 0
    v_mov_b32 v154, 0
    v_mov_b32 v155, 0
    v_mov_b32 v156, 0
    v_mov_b32 v157, 0
    v_mov_b32 v158, 0
    v_mov_b32 v159, 0
    v_mov_b32 v160, 0
    v_mov_b32 v161, 0
    v_mov_b32 v162, 0
    v_mov_b32 v163, 0
    v_mov_b32 v164, 0
    v_mov_b32 v165, 0
    v_mov_b32 v166, 0
    v_mov_b32 v167, 0
    v_mov_b32 v168, 0
    v_mov_b32 v169, 0
    v_mov_b32 v170, 0
    v_mov_b32 v171, 0
    v_mov_b32 v172, 0
    v_mov_b32 v173, 0
    v_mov_b32 v174, 0
    v_mov_b32 v175, 0
    v_mov_b32 v176, 0
    v_mov_b32 v177, 0
    v_mov_b32 v178, 0
    v_mov_b32 v179, 0
    v_mov_b32 v180, 0
    v_mov_b32 v181, 0
    v_mov_b32 v182, 0
    v_mov_b32 v183, 0
    v_mov_b32 v184, 0
    v_mov_b32 v185, 0
    v_mov_b32 v186, 0
    v_mov_b32 v187, 0
    v_mov_b32 v188, 0
    v_mov_b32 v189, 0
    v_mov_b32 v190, 0
    v_mov_b32 v191, 0
    v_mov_b32 v192, 0
    v_mov_b32 v193, 0
    v_mov_b32 v194, 0
    v_mov_b32 v195, 0
    v_mov_b32 v196, 0
    v_mov_b32 v197, 0
    v_mov_b32 v198, 0
    v_mov_b32 v199, 0
    v_mov_b32 v200, 0
    v_mov_b32 v201, 0
    v_mov_b32 v202, 0
    v_mov_b32 v203, 0
    v_mov_b32 v204, 0
    v_mov_b32 v205, 0
    v_mov_b32 v206, 0
    v_mov_b32 v207, 0
    v_mov_b32 v208, 0
    v_mov_b32 v209, 0
    v_mov_b32 v210, 0
    v_mov_b32 v211, 0
    v_mov_b32 v212, 0
    v_mov_b32 v213, 0
    v_mov_b32 v214, 0
    v_mov_b32 v215, 0
    v_mov_b32 v216, 0
    v_mov_b32 v217, 0
    v_mov_b32 v218, 0
    v_mov_b32 v219, 0
    v_mov_b32 v220, 0
    v_mov_b32 v221, 0
    v_mov_b32 v222, 0
    v_mov_b32 v223, 0
    v_mov_b32 v224, 0
    v_mov_b32 v225, 0
    v_mov_b32 v226, 0
    v_mov_b32 v227, 0
    v_mov_b32 v228, 0
    v_mov_b32 v229, 0
    v_mov_b32 v230, 0
    v_mov_b32 v231, 0
    v_mov_b32 v232, 0
    v_mov_b32 v233, 0
    v_mov_b32 v234, 0
    v_mov_b32 v235, 0
    v_mov_b32 v236, 0
    v_mov_b32 v237, 0
    v_mov_b32 v238, 0
    v_mov_b32 v239, 0
    v_mov_b32 v240, 0
    v_mov_b32 v241, 0
    v_mov_b32 v242, 0
    v_mov_b32 v243, 0
    v_mov_b32 v244, 0
    v_mov_b32 v245, 0
    v_mov_b32 v246, 0
    v_mov_b32 v247, 0
    v_mov_b32 v248, 0
    v_mov_b32 v249, 0
    v_mov_b32 v250, 0
    v_mov_b32 v251, 0
    v_mov_b32 v252, 0
    v_mov_b32 v253, 0
    v_mov_b32 v254, 0
    v_mov_b32 v255, 0
    v_mov_b32 v3, v30
    s_mov_b32 s47, 0
    s_mov_b32 s88, 28672
    s_mov_b32 s48, 28672
    s_barrier
    ds_read_b128 v[4:7], v0 offset:0
    ds_read_b128 v[8:11], v0 offset:2048
    ds_read_b128 v[12:15], v0 offset:4096
    ds_read_b128 v[16:19], v0 offset:6144
    ds_read_b128 v[36:39], v1 offset:0
    ds_read_b128 v[40:43], v1 offset:2048
    ds_read_b128 v[44:47], v1 offset:4096
    ds_read_b128 v[48:51], v1 offset:6144
    ds_read_b128 v[52:55], v1 offset:8192
    ds_read_b128 v[56:59], v1 offset:10240
    ds_read_b128 v[60:63], v1 offset:12288
    ds_read_b64_tr_b16 v[64:65], v2 offset:0
    ds_read_b64_tr_b16 v[66:67], v2 offset:640
    ds_read_b64_tr_b16 v[68:69], v2 offset:32
    ds_read_b64_tr_b16 v[70:71], v2 offset:672
    ds_read_b64_tr_b16 v[72:73], v2 offset:64
    ds_read_b64_tr_b16 v[74:75], v2 offset:704
    ds_read_b64_tr_b16 v[76:77], v2 offset:96
    ds_read_b64_tr_b16 v[78:79], v2 offset:736
    s_mov_b32 s45, s60
    s_waitcnt lgkmcnt(0)
    s_branch g1m_mid
.p2align 6
g1m_top:
    v_mfma_f32_16x16x32_bf16 v[180:183], v[28:31], v[48:51], v[180:183]
    ds_read_b128 v[12:15], v0 offset:4096
    v_mfma_f32_16x16x32_bf16 v[224:227], v[32:35], v[48:51], v[224:227]
    ds_read_b128 v[16:19], v0 offset:6144
    v_mfma_f32_16x16x32_bf16 v[96:99], v[20:23], v[52:55], v[96:99]
    ds_read_b128 v[36:39], v1 offset:0
    v_mfma_f32_16x16x32_bf16 v[140:143], v[24:27], v[52:55], v[140:143]
    ds_read_b128 v[40:43], v1 offset:2048
    v_mfma_f32_16x16x32_bf16 v[184:187], v[28:31], v[52:55], v[184:187]
    ds_read_b128 v[44:47], v1 offset:4096
    v_mfma_f32_16x16x32_bf16 v[228:231], v[32:35], v[52:55], v[228:231]
    ds_read_b128 v[48:51], v1 offset:6144
    v_mfma_f32_16x16x32_bf16 v[100:103], v[20:23], v[56:59], v[100:103]
    ds_read_b128 v[52:55], v1 offset:8192
    v_mfma_f32_16x16x32_bf16 v[144:147], v[24:27], v[56:59], v[144:147]
    v_mfma_f32_16x16x32_bf16 v[188:191], v[28:31], v[56:59], v[188:191]
    v_mfma_f32_16x16x32_bf16 v[232:235], v[32:35], v[56:59], v[232:235]
    ds_read_b128 v[56:59], v1 offset:10240
    v_mfma_f32_16x16x32_bf16 v[104:107], v[20:23], v[60:63], v[104:107]
    v_mfma_f32_16x16x32_bf16 v[148:151], v[24:27], v[60:63], v[148:151]
    v_mfma_f32_16x16x32_bf16 v[192:195], v[28:31], v[60:63], v[192:195]
    v_mfma_f32_16x16x32_bf16 v[236:239], v[32:35], v[60:63], v[236:239]
    ds_read_b128 v[60:63], v1 offset:12288
    v_mfma_f32_16x16x32_bf16 v[108:111], v[64:67], v[20:23], v[108:111]
    v_mfma_f32_16x16x32_bf16 v[152:155], v[64:67], v[24:27], v[152:155]
    v_mfma_f32_16x16x32_bf16 v[196:199], v[64:67], v[28:31], v[196:199]
    v_mfma_f32_16x16x32_bf16 v[240:243], v[64:67], v[32:35], v[240:243]
    ds_read_b64_tr_b16 v[64:65], v2 offset:0
    v_mfma_f32_16x16x32_bf16 v[112:115], v[68:71], v[20:23], v[112:115]
    ds_read_b64_tr_b16 v[66:67], v2 offset:640
    v_mfma_f32_16x16x32_bf16 v[156:159], v[68:71], v[24:27], v[156:159]
    v_mfma_f32_16x16x32_bf16 v[200:203], v[68:71], v[28:31], v[200:203]
    v_mfma_f32_16x16x32_bf16 v[244:247], v[68:71], v[32:35], v[244:247]
    ds_read_b64_tr_b16 v[68:69], v2 offset:32
    v_mfma_f32_16x16x32_bf16 v[116:119], v[72:75], v[20:23], v[116:119]
    ds_read_b64_tr_b16 v[70:71], v2 offset:672
    v_mfma_f32_16x16x32_bf16 v[160:163], v[72:75], v[24:27], v[160:163]
    v_mfma_f32_16x16x32_bf16 v[204:207], v[72:75], v[28:31], v[204:207]
    v_mfma_f32_16x16x32_bf16 v[248:251], v[72:75], v[32:35], v[248:251]
    ds_read_b64_tr_b16 v[72:73], v2 offset:64
    v_mfma_f32_16x16x32_bf16 v[120:123], v[76:79], v[20:23], v[120:123]
    ds_read_b64_tr_b16 v[74:75], v2 offset:704
    v_mfma_f32_16x16x32_bf16 v[164:167], v[76:79], v[24:27], v[164:167]
    v_mfma_f32_16x16x32_bf16 v[208:211], v[76:79], v[28:31], v[208:211]
    v_mfma_f32_16x16x32_bf16 v[252:255], v[76:79], v[32:35], v[252:255]
g1m_mid:
    ds_read_b64_tr_b16 v[76:77], v2 offset:96
    s_waitcnt lgkmcnt(13)
    v_mfma_f32_16x16x32_bf16 v[80:83], v[4:7], v[36:39], v[80:83]
    ds_read_b64_tr_b16 v[78:79], v2 offset:736
    v_mfma_f32_16x16x32_bf16 v[124:127], v[8:11], v[36:39], v[124:127]
    ds_read_b128 v[20:23], v0 offset:512
    v_mfma_f32_16x16x32_bf16 v[168:171], v[12:15], v[36:39], v[168:171]
    ds_read_b128 v[24:27], v0 offset:2560
    v_mfma_f32_16x16x32_bf16 v[212:215], v[16:19], v[36:39], v[212:215]
    ds_read_b128 v[28:31], v0 offset:4608
    s_waitcnt lgkmcnt(15)
    v_mfma_f32_16x16x32_bf16 v[84:87], v[4:7], v[40:43], v[84:87]
    ds_read_b128 v[32:35], v0 offset:6656
    v_mfma_f32_16x16x32_bf16 v[128:131], v[8:11], v[40:43], v[128:131]
    ds_read_b128 v[36:39], v1 offset:512
    v_mfma_f32_16x16x32_bf16 v[172:175], v[12:15], v[40:43], v[172:175]
    s_add_u32 s47, s47, 28672
    s_cmp_ge_u32 s47, 86016
    v_mfma_f32_16x16x32_bf16 v[216:219], v[16:19], v[40:43], v[216:219]
    ds_read_b128 v[40:43], v1 offset:2560
    s_waitcnt lgkmcnt(15)
    v_mfma_f32_16x16x32_bf16 v[88:91], v[4:7], v[44:47], v[88:91]
    s_cselect_b32 s47, 0, s47
    s_cselect_b32 s48, 4294909952, s88
    v_mfma_f32_16x16x32_bf16 v[132:135], v[8:11], v[44:47], v[132:135]
    v_mfma_f32_16x16x32_bf16 v[176:179], v[12:15], v[44:47], v[176:179]
    v_mfma_f32_16x16x32_bf16 v[220:223], v[16:19], v[44:47], v[220:223]
    ds_read_b128 v[44:47], v1 offset:4608
    s_waitcnt lgkmcnt(15)
    v_mfma_f32_16x16x32_bf16 v[92:95], v[4:7], v[48:51], v[92:95]
    v_mfma_f32_16x16x32_bf16 v[136:139], v[8:11], v[48:51], v[136:139]
    buffer_load_dword v3, s[64:67], s94 offen lds
    v_mfma_f32_16x16x32_bf16 v[180:183], v[12:15], v[48:51], v[180:183]
    v_mfma_f32_16x16x32_bf16 v[224:227], v[16:19], v[48:51], v[224:227]
    ds_read_b128 v[48:51], v1 offset:6656
    s_waitcnt lgkmcnt(15)
    v_mfma_f32_16x16x32_bf16 v[96:99], v[4:7], v[52:55], v[96:99]
    s_add_u32 s94, s94, 2048
    s_and_b32 s49, s45, 3
    v_mfma_f32_16x16x32_bf16 v[140:143], v[8:11], v[52:55], v[140:143]
    s_cmp_eq_u32 s49, 1
    s_cselect_b64 s[64:65], s[68:69], s[64:65]
    v_mfma_f32_16x16x32_bf16 v[184:187], v[12:15], v[52:55], v[184:187]
    s_cselect_b64 s[68:69], s[70:71], s[68:69]
    s_cselect_b32 s66, s72, s66
    v_mfma_f32_16x16x32_bf16 v[228:231], v[16:19], v[52:55], v[228:231]
    ds_read_b128 v[52:55], v1 offset:8704
    s_waitcnt lgkmcnt(15)
    v_mfma_f32_16x16x32_bf16 v[100:103], v[4:7], v[56:59], v[100:103]
    s_cselect_b32 s72, s73, s72
    s_cselect_b32 s73, 0, s73
    v_mfma_f32_16x16x32_bf16 v[144:147], v[8:11], v[56:59], v[144:147]
    s_cselect_b32 s94, s74, s94
    v_mfma_f32_16x16x32_bf16 v[188:191], v[12:15], v[56:59], v[188:191]
    v_mfma_f32_16x16x32_bf16 v[232:235], v[16:19], v[56:59], v[232:235]
    ds_read_b128 v[56:59], v1 offset:10752
    s_waitcnt lgkmcnt(15)
    v_mfma_f32_16x16x32_bf16 v[104:107], v[4:7], v[60:63], v[104:107]
    v_mfma_f32_16x16x32_bf16 v[148:151], v[8:11], v[60:63], v[148:151]
    v_mfma_f32_16x16x32_bf16 v[192:195], v[12:15], v[60:63], v[192:195]
    v_mfma_f32_16x16x32_bf16 v[236:239], v[16:19], v[60:63], v[236:239]
    ds_read_b128 v[60:63], v1 offset:12800
    s_waitcnt lgkmcnt(15)
    v_mfma_f32_16x16x32_bf16 v[108:111], v[64:67], v[4:7], v[108:111]
    v_mfma_f32_16x16x32_bf16 v[152:155], v[64:67], v[8:11], v[152:155]
    v_mfma_f32_16x16x32_bf16 v[196:199], v[64:67], v[12:15], v[196:199]
    v_mfma_f32_16x16x32_bf16 v[240:243], v[64:67], v[16:19], v[240:243]
    ds_read_b64_tr_b16 v[64:65], v2 offset:5632
    s_waitcnt lgkmcnt(15)
    v_mfma_f32_16x16x32_bf16 v[112:115], v[68:71], v[4:7], v[112:115]
    ds_read_b64_tr_b16 v[66:67], v2 offset:6272
    v_mfma_f32_16x16x32_bf16 v[156:159], v[68:71], v[8:11], v[156:159]
    v_mfma_f32_16x16x32_bf16 v[200:203], v[68:71], v[12:15], v[200:203]
    v_mfma_f32_16x16x32_bf16 v[244:247], v[68:71], v[16:19], v[244:247]
    ds_read_b64_tr_b16 v[68:69], v2 offset:5664
    s_waitcnt lgkmcnt(15)
    v_mfma_f32_16x16x32_bf16 v[116:119], v[72:75], v[4:7], v[116:119]
    ds_read_b64_tr_b16 v[70:71], v2 offset:6304
    v_mfma_f32_16x16x32_bf16 v[160:163], v[72:75], v[8:11], v[160:163]
    v_mfma_f32_16x16x32_bf16 v[204:207], v[72:75], v[12:15], v[204:207]
    v_mfma_f32_16x16x32_bf16 v[248:251], v[72:75], v[16:19], v[248:251]
    ds_read_b64_tr_b16 v[72:73], v2 offset:5696
    s_waitcnt lgkmcnt(15)
    v_mfma_f32_16x16x32_bf16 v[120:123], v[76:79], v[4:7], v[120:123]
    ds_read_b64_tr_b16 v[74:75], v2 offset:6336
    v_mfma_f32_16x16x32_bf16 v[164:167], v[76:79], v[8:11], v[164:167]
    v_mfma_f32_16x16x32_bf16 v[208:211], v[76:79], v[12:15], v[208:211]
    v_mfma_f32_16x16x32_bf16 v[252:255], v[76:79], v[16:19], v[252:255]
    ds_read_b64_tr_b16 v[76:77], v2 offset:5728
    s_waitcnt lgkmcnt(13)
    v_mfma_f32_16x16x32_bf16 v[80:83], v[20:23], v[36:39], v[80:83]
    ds_read_b64_tr_b16 v[78:79], v2 offset:6368
    v_mfma_f32_16x16x32_bf16 v[124:127], v[24:27], v[36:39], v[124:127]
    v_mfma_f32_16x16x32_bf16 v[168:171], v[28:31], v[36:39], v[168:171]
    v_mfma_f32_16x16x32_bf16 v[212:215], v[32:35], v[36:39], v[212:215]
    s_waitcnt lgkmcnt(13)
    v_mfma_f32_16x16x32_bf16 v[84:87], v[20:23], v[40:43], v[84:87]
    v_mfma_f32_16x16x32_bf16 v[128:131], v[24:27], v[40:43], v[128:131]
    v_mfma_f32_16x16x32_bf16 v[172:175], v[28:31], v[40:43], v[172:175]
    v_mfma_f32_16x16x32_bf16 v[216:219], v[32:35], v[40:43], v[216:219]
    s_waitcnt lgkmcnt(0)
    s_barrier
    v_mfma_f32_16x16x32_bf16 v[88:91], v[20:23], v[44:47], v[88:91]
    v_xor_b32 v0, 0x8000, v0
    v_add_u32 v1, s48, v1
    v_mfma_f32_16x16x32_bf16 v[132:135], v[24:27], v[44:47], v[132:135]
    v_add_u32 v2, s48, v2
    v_mfma_f32_16x16x32_bf16 v[176:179], v[28:31], v[44:47], v[176:179]
    ds_read_b128 v[4:7], v0 offset:0
    v_mfma_f32_16x16x32_bf16 v[220:223], v[32:35], v[44:47], v[220:223]
    ds_read_b128 v[8:11], v0 offset:2048
    v_mfma_f32_16x16x32_bf16 v[92:95], v[20:23], v[48:51], v[92:95]
    s_sub_u32 s45, s45, 1
    s_cmp_lg_u32 s45, 0
    v_mfma_f32_16x16x32_bf16 v[136:139], v[24:27], v[48:51], v[136:139]
    s_cbranch_scc1 g1m_top
    v_mfma_f32_16x16x32_bf16 v[180:183], v[28:31], v[48:51], v[180:183]
    v_mfma_f32_16x16x32_bf16 v[224:227], v[32:35], v[48:51], v[224:227]
    v_mfma_f32_16x16x32_bf16 v[96:99], v[20:23], v[52:55], v[96:99]
    v_mfma_f32_16x16x32_bf16 v[140:143], v[24:27], v[52:55], v[140:143]
    v_mfma_f32_16x16x32_bf16 v[184:187], v[28:31], v[52:55], v[184:187]
    v_mfma_f32_16x16x32_bf16 v[228:231], v[32:35], v[52:55], v[228:231]
    v_mfma_f32_16x16x32_bf16 v[100:103], v[20:23], v[56:59], v[100:103]
    v_mfma_f32_16x16x32_bf16 v[144:147], v[24:27], v[56:59], v[144:147]
    v_mfma_f32_16x16x32_bf16 v[188:191], v[28:31], v[56:59], v[188:191]
    v_mfma_f32_16x16x32_bf16 v[232:235], v[32:35], v[56:59], v[232:235]
    v_mfma_f32_16x16x32_bf16 v[104:107], v[20:23], v[60:63], v[104:107]
    v_mfma_f32_16x16x32_bf16 v[148:151], v[24:27], v[60:63], v[148:151]
    v_mfma_f32_16x16x32_bf16 v[192:195], v[28:31], v[60:63], v[192:195]
    v_mfma_f32_16x16x32_bf16 v[236:239], v[32:35], v[60:63], v[236:239]
    v_mfma_f32_16x16x32_bf16 v[108:111], v[64:67], v[20:23], v[108:111]
    v_mfma_f32_16x16x32_bf16 v[152:155], v[64:67], v[24:27], v[152:155]
    v_mfma_f32_16x16x32_bf16 v[196:199], v[64:67], v[28:31], v[196:199]
    v_mfma_f32_16x16x32_bf16 v[240:243], v[64:67], v[32:35], v[240:243]
    v_mfma_f32_16x16x32_bf16 v[112:115], v[68:71], v[20:23], v[112:115]
    v_mfma_f32_16x16x32_bf16 v[156:159], v[68:71], v[24:27], v[156:159]
    v_mfma_f32_16x16x32_bf16 v[200:203], v[68:71], v[28:31], v[200:203]
    v_mfma_f32_16x16x32_bf16 v[244:247], v[68:71], v[32:35], v[244:247]
    v_mfma_f32_16x16x32_bf16 v[116:119], v[72:75], v[20:23], v[116:119]
    v_mfma_f32_16x16x32_bf16 v[160:163], v[72:75], v[24:27], v[160:163]
    v_mfma_f32_16x16x32_bf16 v[204:207], v[72:75], v[28:31], v[204:207]
    v_mfma_f32_16x16x32_bf16 v[248:251], v[72:75], v[32:35], v[248:251]
    v_mfma_f32_16x16x32_bf16 v[120:123], v[76:79], v[20:23], v[120:123]
    v_mfma_f32_16x16x32_bf16 v[164:167], v[76:79], v[24:27], v[164:167]
    v_mfma_f32_16x16x32_bf16 v[208:211], v[76:79], v[28:31], v[208:211]
    v_mfma_f32_16x16x32_bf16 v[252:255], v[76:79], v[32:35], v[252:255]
    s_waitcnt lgkmcnt(0)
    s_nop 7
    s_nop 7
    v_mbcnt_lo_u32_b32 v1, -1, 0
    v_mbcnt_hi_u32_b32 v1, -1, v1
    v_and_b32 v2, 15, v1
    v_lshrrev_b32 v3, 4, v1
    v_and_b32 v4, 1, v3
    v_lshlrev_b32 v4, 5, v4
    v_lshrrev_b32 v5, 1, v3
    v_lshl_add_u32 v4, v5, 4, v4
    v_lshl_add_u32 v4, v2, 6, v4
    s_lshl_b32 s49, s3, 6
    s_add_u32 s49, s49, s40
    s_lshr_b32 s36, s40, 6
    s_lshl_b32 s34, s41, 7
    s_add_u32 s34, s34, s36
    s_add_u32 s34, s34, 1024
    s_lshr_b32 s35, s40, 1
    s_lshl_b32 s37, s41, 2
    s_add_u32 s35, s35, s37
    s_add_u32 s35, s35, 4096
    s_add_u32 s12, s28, 5242880
    s_addc_u32 s13, s29, 0
    s_mov_b32 s14, 8650752
    s_mov_b32 s15, 0x20000
    s_mul_i32 s50, s41, 743424
    s_lshl_b32 s51, s49, 5
    s_add_u32 s50, s50, s51
    v_add_u32 v6, s50, v4
    s_mul_i32 s50, s41, 11
    s_add_u32 s51, s50, 0
    s_cmp_lt_u32 s51, 64
    s_cselect_b32 s48, 0, 0x80008000
    s_mov_b32 s51, 0
    v_cvt_pk_bf16_f32 v16, v80, v81
    v_cvt_pk_bf16_f32 v17, v82, v83
    v_cvt_pk_bf16_f32 v18, v124, v125
    v_cvt_pk_bf16_f32 v19, v126, v127
    v_cvt_pk_bf16_f32 v20, v168, v169
    v_cvt_pk_bf16_f32 v21, v170, v171
    v_cvt_pk_bf16_f32 v22, v212, v213
    v_cvt_pk_bf16_f32 v23, v214, v215
    v_xor_b32 v16, s48, v16
    v_xor_b32 v17, s48, v17
    v_xor_b32 v18, s48, v18
    v_xor_b32 v19, s48, v19
    v_xor_b32 v20, s48, v20
    v_xor_b32 v21, s48, v21
    v_xor_b32 v22, s48, v22
    v_xor_b32 v23, s48, v23
    s_nop 1
    v_permlane16_swap_b32 v16, v18
    v_permlane16_swap_b32 v17, v19
    v_permlane16_swap_b32 v20, v22
    v_permlane16_swap_b32 v21, v23
    buffer_store_dwordx4 v[16:19], v6, s[12:15], s51 offen sc1
    buffer_store_dwordx4 v[20:23], v6, s[12:15], s51 offen offset:1024 sc1
    s_add_u32 s51, s50, 1
    s_cmp_lt_u32 s51, 64
    s_cselect_b32 s48, 0, 0x80008000
    s_mov_b32 s51, 67584
    v_cvt_pk_bf16_f32 v24, v84, v85
    v_cvt_pk_bf16_f32 v25, v86, v87
    v_cvt_pk_bf16_f32 v26, v128, v129
    v_cvt_pk_bf16_f32 v27, v130, v131
    v_cvt_pk_bf16_f32 v28, v172, v173
    v_cvt_pk_bf16_f32 v29, v174, v175
    v_cvt_pk_bf16_f32 v30, v216, v217
    v_cvt_pk_bf16_f32 v31, v218, v219
    v_xor_b32 v24, s48, v24
    v_xor_b32 v25, s48, v25
    v_xor_b32 v26, s48, v26
    v_xor_b32 v27, s48, v27
    v_xor_b32 v28, s48, v28
    v_xor_b32 v29, s48, v29
    v_xor_b32 v30, s48, v30
    v_xor_b32 v31, s48, v31
    s_nop 1
    v_permlane16_swap_b32 v24, v26
    v_permlane16_swap_b32 v25, v27
    v_permlane16_swap_b32 v28, v30
    v_permlane16_swap_b32 v29, v31
    buffer_store_dwordx4 v[24:27], v6, s[12:15], s51 offen sc1
    buffer_store_dwordx4 v[28:31], v6, s[12:15], s51 offen offset:1024 sc1
    s_add_u32 s51, s50, 2
    s_cmp_lt_u32 s51, 64
    s_cselect_b32 s48, 0, 0x80008000
    s_mov_b32 s51, 135168
    v_cvt_pk_bf16_f32 v32, v88, v89
    v_cvt_pk_bf16_f32 v33, v90, v91
    v_cvt_pk_bf16_f32 v34, v132, v133
    v_cvt_pk_bf16_f32 v35, v134, v135
    v_cvt_pk_bf16_f32 v36, v176, v177
    v_cvt_pk_bf16_f32 v37, v178, v179
    v_cvt_pk_bf16_f32 v38, v220, v221
    v_cvt_pk_bf16_f32 v39, v222, v223
    v_xor_b32 v32, s48, v32
    v_xor_b32 v33, s48, v33
    v_xor_b32 v34, s48, v34
    v_xor_b32 v35, s48, v35
    v_xor_b32 v36, s48, v36
    v_xor_b32 v37, s48, v37
    v_xor_b32 v38, s48, v38
    v_xor_b32 v39, s48, v39
    s_nop 1
    v_permlane16_swap_b32 v32, v34
    v_permlane16_swap_b32 v33, v35
    v_permlane16_swap_b32 v36, v38
    v_permlane16_swap_b32 v37, v39
    buffer_store_dwordx4 v[32:35], v6, s[12:15], s51 offen sc1
    buffer_store_dwordx4 v[36:39], v6, s[12:15], s51 offen offset:1024 sc1
    s_add_u32 s51, s50, 3
    s_cmp_lt_u32 s51, 64
    s_cselect_b32 s48, 0, 0x80008000
    s_mov_b32 s51, 202752
    v_cvt_pk_bf16_f32 v40, v92, v93
    v_cvt_pk_bf16_f32 v41, v94, v95
    v_cvt_pk_bf16_f32 v42, v136, v137
    v_cvt_pk_bf16_f32 v43, v138, v139
    v_cvt_pk_bf16_f32 v44, v180, v181
    v_cvt_pk_bf16_f32 v45, v182, v183
    v_cvt_pk_bf16_f32 v46, v224, v225
    v_cvt_pk_bf16_f32 v47, v226, v227
    v_xor_b32 v40, s48, v40
    v_xor_b32 v41, s48, v41
    v_xor_b32 v42, s48, v42
    v_xor_b32 v43, s48, v43
    v_xor_b32 v44, s48, v44
    v_xor_b32 v45, s48, v45
    v_xor_b32 v46, s48, v46
    v_xor_b32 v47, s48, v47
    s_nop 1
    v_permlane16_swap_b32 v40, v42
    v_permlane16_swap_b32 v41, v43
    v_permlane16_swap_b32 v44, v46
    v_permlane16_swap_b32 v45, v47
    buffer_store_dwordx4 v[40:43], v6, s[12:15], s51 offen sc1
    buffer_store_dwordx4 v[44:47], v6, s[12:15], s51 offen offset:1024 sc1
    s_add_u32 s51, s50, 4
    s_cmp_lt_u32 s51, 64
    s_cselect_b32 s48, 0, 0x80008000
    s_mov_b32 s51, 270336
    v_cvt_pk_bf16_f32 v16, v96, v97
    v_cvt_pk_bf16_f32 v17, v98, v99
    v_cvt_pk_bf16_f32 v18, v140, v141
    v_cvt_pk_bf16_f32 v19, v142, v143
    v_cvt_pk_bf16_f32 v20, v184, v185
    v_cvt_pk_bf16_f32 v21, v186, v187
    v_cvt_pk_bf16_f32 v22, v228, v229
    v_cvt_pk_bf16_f32 v23, v230, v231
    v_xor_b32 v16, s48, v16
    v_xor_b32 v17, s48, v17
    v_xor_b32 v18, s48, v18
    v_xor_b32 v19, s48, v19
    v_xor_b32 v20, s48, v20
    v_xor_b32 v21, s48, v21
    v_xor_b32 v22, s48, v22
    v_xor_b32 v23, s48, v23
    s_nop 1
    v_permlane16_swap_b32 v16, v18
    v_permlane16_swap_b32 v17, v19
    v_permlane16_swap_b32 v20, v22
    v_permlane16_swap_b32 v21, v23
    buffer_store_dwordx4 v[16:19], v6, s[12:15], s51 offen sc1
    buffer_store_dwordx4 v[20:23], v6, s[12:15], s51 offen offset:1024 sc1
    s_add_u32 s51, s50, 5
    s_cmp_lt_u32 s51, 64
    s_cselect_b32 s48, 0, 0x80008000
    s_mov_b32 s51, 337920
    v_cvt_pk_bf16_f32 v24, v100, v101
    v_cvt_pk_bf16_f32 v25, v102, v103
    v_cvt_pk_bf16_f32 v26, v144, v145
    v_cvt_pk_bf16_f32 v27, v146, v147
    v_cvt_pk_bf16_f32 v28, v188, v189
    v_cvt_pk_bf16_f32 v29, v190, v191
    v_cvt_pk_bf16_f32 v30, v232, v233
    v_cvt_pk_bf16_f32 v31, v234, v235
    v_xor_b32 v24, s48, v24
    v_xor_b32 v25, s48, v25
    v_xor_b32 v26, s48, v26
    v_xor_b32 v27, s48, v27
    v_xor_b32 v28, s48, v28
    v_xor_b32 v29, s48, v29
    v_xor_b32 v30, s48, v30
    v_xor_b32 v31, s48, v31
    s_nop 1
    v_permlane16_swap_b32 v24, v26
    v_permlane16_swap_b32 v25, v27
    v_permlane16_swap_b32 v28, v30
    v_permlane16_swap_b32 v29, v31
    buffer_store_dwordx4 v[24:27], v6, s[12:15], s51 offen sc1
    buffer_store_dwordx4 v[28:31], v6, s[12:15], s51 offen offset:1024 sc1
    s_add_u32 s51, s50, 6
    s_cmp_lt_u32 s51, 64
    s_cselect_b32 s48, 0, 0x80008000
    s_mov_b32 s51, 405504
    v_cvt_pk_bf16_f32 v32, v104, v105
    v_cvt_pk_bf16_f32 v33, v106, v107
    v_cvt_pk_bf16_f32 v34, v148, v149
    v_cvt_pk_bf16_f32 v35, v150, v151
    v_cvt_pk_bf16_f32 v36, v192, v193
    v_cvt_pk_bf16_f32 v37, v194, v195
    v_cvt_pk_bf16_f32 v38, v236, v237
    v_cvt_pk_bf16_f32 v39, v238, v239
    v_xor_b32 v32, s48, v32
    v_xor_b32 v33, s48, v33
    v_xor_b32 v34, s48, v34
    v_xor_b32 v35, s48, v35
    v_xor_b32 v36, s48, v36
    v_xor_b32 v37, s48, v37
    v_xor_b32 v38, s48, v38
    v_xor_b32 v39, s48, v39
    s_nop 1
    v_permlane16_swap_b32 v32, v34
    v_permlane16_swap_b32 v33, v35
    v_permlane16_swap_b32 v36, v38
    v_permlane16_swap_b32 v37, v39
    buffer_store_dwordx4 v[32:35], v6, s[12:15], s51 offen sc1
    buffer_store_dwordx4 v[36:39], v6, s[12:15], s51 offen offset:1024 sc1
    s_add_u32 s12, s28, 14680064
    s_addc_u32 s13, s29, 0
    s_mov_b32 s14, 15990784
    s_mov_b32 s15, 0x20000
    s_mov_b32 s16, s26
    s_mov_b32 s17, s27
    s_mov_b32 s18, 7168
    s_mov_b32 s19, 0x20000
    s_mul_i32 s50, s41, 352
    s_sub_u32 s50, s50, 3872
    v_lshlrev_b32 v7, 3, v3
    v_add_u32 v7, s50, v7
    buffer_load_dwordx2 v[64:65], v7, s[16:19], 0 offen offset:0
    buffer_load_dwordx2 v[66:67], v7, s[16:19], 0 offen offset:32
    buffer_load_dwordx2 v[68:69], v7, s[16:19], 0 offen offset:64
    buffer_load_dwordx2 v[70:71], v7, s[16:19], 0 offen offset:96
    s_lshr_b32 s51, s49, 4
    s_mul_i32 s51, s51, 124928
    v_add_u32 v6, s51, v4
    v_mov_b32 v10, 0xc0135761
    v_mov_b32 v11, 0xc0135761
    v_mov_b32 v12, 0xbdd2d3e8
    v_mov_b32 v13, 0xbdd2d3e8
    v_mov_b32 v14, 1.0
    v_mov_b32 v15, 1.0
    s_waitcnt vmcnt(0)
    v_lshlrev_b32 v48, 16, v64
    v_and_b32 v49, 0xffff0000, v64
    v_lshlrev_b32 v50, 16, v65
    v_and_b32 v51, 0xffff0000, v65
    v_lshlrev_b32 v52, 16, v66
    v_and_b32 v53, 0xffff0000, v66
    v_lshlrev_b32 v54, 16, v67
    v_and_b32 v55, 0xffff0000, v67
    v_lshlrev_b32 v56, 16, v68
    v_and_b32 v57, 0xffff0000, v68
    v_lshlrev_b32 v58, 16, v69
    v_and_b32 v59, 0xffff0000, v69
    v_lshlrev_b32 v60, 16, v70
    v_and_b32 v61, 0xffff0000, v70
    v_lshlrev_b32 v62, 16, v71
    v_and_b32 v63, 0xffff0000, v71
    v_pk_add_f32 v[108:109], v[108:109], v[48:49]
    v_pk_add_f32 v[110:111], v[110:111], v[50:51]
    v_pk_add_f32 v[112:113], v[112:113], v[52:53]
    v_pk_add_f32 v[114:115], v[114:115], v[54:55]
    v_pk_add_f32 v[116:117], v[116:117], v[56:57]
    v_pk_add_f32 v[118:119], v[118:119], v[58:59]
    v_pk_add_f32 v[120:121], v[120:121], v[60:61]
    v_pk_add_f32 v[122:123], v[122:123], v[62:63]
    v_pk_mul_f32 v[16:17], v[108:109], v[108:109]
    v_pk_mul_f32 v[18:19], v[110:111], v[110:111]
    v_pk_mul_f32 v[20:21], v[112:113], v[112:113]
    v_pk_mul_f32 v[22:23], v[114:115], v[114:115]
    v_pk_mul_f32 v[24:25], v[116:117], v[116:117]
    v_pk_mul_f32 v[26:27], v[118:119], v[118:119]
    v_pk_mul_f32 v[28:29], v[120:121], v[120:121]
    v_pk_mul_f32 v[30:31], v[122:123], v[122:123]
    v_pk_fma_f32 v[16:17], v[16:17], v[12:13], v[10:11]
    v_pk_fma_f32 v[18:19], v[18:19], v[12:13], v[10:11]
    v_pk_fma_f32 v[20:21], v[20:21], v[12:13], v[10:11]
    v_pk_fma_f32 v[22:23], v[22:23], v[12:13], v[10:11]
    v_pk_fma_f32 v[24:25], v[24:25], v[12:13], v[10:11]
    v_pk_fma_f32 v[26:27], v[26:27], v[12:13], v[10:11]
    v_pk_fma_f32 v[28:29], v[28:29], v[12:13], v[10:11]
    v_pk_fma_f32 v[30:31], v[30:31], v[12:13], v[10:11]
    v_pk_mul_f32 v[16:17], v[16:17], v[108:109]
    v_pk_mul_f32 v[18:19], v[18:19], v[110:111]
    v_pk_mul_f32 v[20:21], v[20:21], v[112:113]
    v_pk_mul_f32 v[22:23], v[22:23], v[114:115]
    v_pk_mul_f32 v[24:25], v[24:25], v[116:117]
    v_pk_mul_f32 v[26:27], v[26:27], v[118:119]
    v_pk_mul_f32 v[28:29], v[28:29], v[120:121]
    v_pk_mul_f32 v[30:31], v[30:31], v[122:123]
    v_exp_f32 v16, v16
    v_exp_f32 v17, v17
    v_exp_f32 v18, v18
    v_exp_f32 v19, v19
    v_exp_f32 v20, v20
    v_exp_f32 v21, v21
    v_exp_f32 v22, v22
    v_exp_f32 v23, v23
    v_exp_f32 v24, v24
    v_exp_f32 v25, v25
    v_exp_f32 v26, v26
    v_exp_f32 v27, v27
    v_exp_f32 v28, v28
    v_exp_f32 v29, v29
    v_exp_f32 v30, v30
    v_exp_f32 v31, v31
    v_pk_add_f32 v[16:17], v[16:17], v[14:15]
    v_pk_add_f32 v[18:19], v[18:19], v[14:15]
    v_pk_add_f32 v[20:21], v[20:21], v[14:15]
    v_pk_add_f32 v[22:23], v[22:23], v[14:15]
    v_pk_add_f32 v[24:25], v[24:25], v[14:15]
    v_pk_add_f32 v[26:27], v[26:27], v[14:15]
    v_pk_add_f32 v[28:29], v[28:29], v[14:15]
    v_pk_add_f32 v[30:31], v[30:31], v[14:15]
    v_rcp_f32 v16, v16
    v_rcp_f32 v17, v17
    v_rcp_f32 v18, v18
    v_rcp_f32 v19, v19
    v_rcp_f32 v20, v20
    v_rcp_f32 v21, v21
    v_rcp_f32 v22, v22
    v_rcp_f32 v23, v23
    v_rcp_f32 v24, v24
    v_rcp_f32 v25, v25
    v_rcp_f32 v26, v26
    v_rcp_f32 v27, v27
    v_rcp_f32 v28, v28
    v_rcp_f32 v29, v29
    v_rcp_f32 v30, v30
    v_rcp_f32 v31, v31
    v_pk_mul_f32 v[108:109], v[108:109], v[16:17]
    v_pk_mul_f32 v[110:111], v[110:111], v[18:19]
    v_pk_mul_f32 v[112:113], v[112:113], v[20:21]
    v_pk_mul_f32 v[114:115], v[114:115], v[22:23]
    v_pk_mul_f32 v[116:117], v[116:117], v[24:25]
    v_pk_mul_f32 v[118:119], v[118:119], v[26:27]
    v_pk_mul_f32 v[120:121], v[120:121], v[28:29]
    v_pk_mul_f32 v[122:123], v[122:123], v[30:31]
    v_cvt_pk_bf16_f32 v16, v108, v109
    v_cvt_pk_bf16_f32 v17, v110, v111
    v_cvt_pk_bf16_f32 v18, v112, v113
    v_cvt_pk_bf16_f32 v19, v114, v115
    v_cvt_pk_bf16_f32 v20, v116, v117
    v_cvt_pk_bf16_f32 v21, v118, v119
    v_cvt_pk_bf16_f32 v22, v120, v121
    v_cvt_pk_bf16_f32 v23, v122, v123
    s_mov_b32 s51, 0
    s_nop 0
    v_permlane16_swap_b32 v16, v18
    v_permlane16_swap_b32 v17, v19
    v_permlane16_swap_b32 v20, v22
    v_permlane16_swap_b32 v21, v23
    buffer_store_dwordx4 v[16:19], v6, s[12:15], s51 offen sc1
    buffer_store_dwordx4 v[20:23], v6, s[12:15], s51 offen offset:1024 sc1
    v_pk_add_f32 v[152:153], v[152:153], v[48:49]
    v_pk_add_f32 v[154:155], v[154:155], v[50:51]
    v_pk_add_f32 v[156:157], v[156:157], v[52:53]
    v_pk_add_f32 v[158:159], v[158:159], v[54:55]
    v_pk_add_f32 v[160:161], v[160:161], v[56:57]
    v_pk_add_f32 v[162:163], v[162:163], v[58:59]
    v_pk_add_f32 v[164:165], v[164:165], v[60:61]
    v_pk_add_f32 v[166:167], v[166:167], v[62:63]
    v_pk_mul_f32 v[32:33], v[152:153], v[152:153]
    v_pk_mul_f32 v[34:35], v[154:155], v[154:155]
    v_pk_mul_f32 v[36:37], v[156:157], v[156:157]
    v_pk_mul_f32 v[38:39], v[158:159], v[158:159]
    v_pk_mul_f32 v[40:41], v[160:161], v[160:161]
    v_pk_mul_f32 v[42:43], v[162:163], v[162:163]
    v_pk_mul_f32 v[44:45], v[164:165], v[164:165]
    v_pk_mul_f32 v[46:47], v[166:167], v[166:167]
    v_pk_fma_f32 v[32:33], v[32:33], v[12:13], v[10:11]
    v_pk_fma_f32 v[34:35], v[34:35], v[12:13], v[10:11]
    v_pk_fma_f32 v[36:37], v[36:37], v[12:13], v[10:11]
    v_pk_fma_f32 v[38:39], v[38:39], v[12:13], v[10:11]
    v_pk_fma_f32 v[40:41], v[40:41], v[12:13], v[10:11]
    v_pk_fma_f32 v[42:43], v[42:43], v[12:13], v[10:11]
    v_pk_fma_f32 v[44:45], v[44:45], v[12:13], v[10:11]
    v_pk_fma_f32 v[46:47], v[46:47], v[12:13], v[10:11]
    v_pk_mul_f32 v[32:33], v[32:33], v[152:153]
    v_pk_mul_f32 v[34:35], v[34:35], v[154:155]
    v_pk_mul_f32 v[36:37], v[36:37], v[156:157]
    v_pk_mul_f32 v[38:39], v[38:39], v[158:159]
    v_pk_mul_f32 v[40:41], v[40:41], v[160:161]
    v_pk_mul_f32 v[42:43], v[42:43], v[162:163]
    v_pk_mul_f32 v[44:45], v[44:45], v[164:165]
    v_pk_mul_f32 v[46:47], v[46:47], v[166:167]
    v_exp_f32 v32, v32
    v_exp_f32 v33, v33
    v_exp_f32 v34, v34
    v_exp_f32 v35, v35
    v_exp_f32 v36, v36
    v_exp_f32 v37, v37
    v_exp_f32 v38, v38
    v_exp_f32 v39, v39
    v_exp_f32 v40, v40
    v_exp_f32 v41, v41
    v_exp_f32 v42, v42
    v_exp_f32 v43, v43
    v_exp_f32 v44, v44
    v_exp_f32 v45, v45
    v_exp_f32 v46, v46
    v_exp_f32 v47, v47
    v_pk_add_f32 v[32:33], v[32:33], v[14:15]
    v_pk_add_f32 v[34:35], v[34:35], v[14:15]
    v_pk_add_f32 v[36:37], v[36:37], v[14:15]
    v_pk_add_f32 v[38:39], v[38:39], v[14:15]
    v_pk_add_f32 v[40:41], v[40:41], v[14:15]
    v_pk_add_f32 v[42:43], v[42:43], v[14:15]
    v_pk_add_f32 v[44:45], v[44:45], v[14:15]
    v_pk_add_f32 v[46:47], v[46:47], v[14:15]
    v_rcp_f32 v32, v32
    v_rcp_f32 v33, v33
    v_rcp_f32 v34, v34
    v_rcp_f32 v35, v35
    v_rcp_f32 v36, v36
    v_rcp_f32 v37, v37
    v_rcp_f32 v38, v38
    v_rcp_f32 v39, v39
    v_rcp_f32 v40, v40
    v_rcp_f32 v41, v41
    v_rcp_f32 v42, v42
    v_rcp_f32 v43, v43
    v_rcp_f32 v44, v44
    v_rcp_f32 v45, v45
    v_rcp_f32 v46, v46
    v_rcp_f32 v47, v47
    v_pk_mul_f32 v[152:153], v[152:153], v[32:33]
    v_pk_mul_f32 v[154:155], v[154:155], v[34:35]
    v_pk_mul_f32 v[156:157], v[156:157], v[36:37]
    v_pk_mul_f32 v[158:159], v[158:159], v[38:39]
    v_pk_mul_f32 v[160:161], v[160:161], v[40:41]
    v_pk_mul_f32 v[162:163], v[162:163], v[42:43]
    v_pk_mul_f32 v[164:165], v[164:165], v[44:45]
    v_pk_mul_f32 v[166:167], v[166:167], v[46:47]
    v_cvt_pk_bf16_f32 v32, v152, v153
    v_cvt_pk_bf16_f32 v33, v154, v155
    v_cvt_pk_bf16_f32 v34, v156, v157
    v_cvt_pk_bf16_f32 v35, v158, v159
    v_cvt_pk_bf16_f32 v36, v160, v161
    v_cvt_pk_bf16_f32 v37, v162, v163
    v_cvt_pk_bf16_f32 v38, v164, v165
    v_cvt_pk_bf16_f32 v39, v166, v167
    s_mov_b32 s51, 124928
    s_nop 0
    v_permlane16_swap_b32 v32, v34
    v_permlane16_swap_b32 v33, v35
    v_permlane16_swap_b32 v36, v38
    v_permlane16_swap_b32 v37, v39
    buffer_store_dwordx4 v[32:35], v6, s[12:15], s51 offen sc1
    buffer_store_dwordx4 v[36:39], v6, s[12:15], s51 offen offset:1024 sc1
    v_pk_add_f32 v[196:197], v[196:197], v[48:49]
    v_pk_add_f32 v[198:199], v[198:199], v[50:51]
    v_pk_add_f32 v[200:201], v[200:201], v[52:53]
    v_pk_add_f32 v[202:203], v[202:203], v[54:55]
    v_pk_add_f32 v[204:205], v[204:205], v[56:57]
    v_pk_add_f32 v[206:207], v[206:207], v[58:59]
    v_pk_add_f32 v[208:209], v[208:209], v[60:61]
    v_pk_add_f32 v[210:211], v[210:211], v[62:63]
    v_pk_mul_f32 v[16:17], v[196:197], v[196:197]
    v_pk_mul_f32 v[18:19], v[198:199], v[198:199]
    v_pk_mul_f32 v[20:21], v[200:201], v[200:201]
    v_pk_mul_f32 v[22:23], v[202:203], v[202:203]
    v_pk_mul_f32 v[24:25], v[204:205], v[204:205]
    v_pk_mul_f32 v[26:27], v[206:207], v[206:207]
    v_pk_mul_f32 v[28:29], v[208:209], v[208:209]
    v_pk_mul_f32 v[30:31], v[210:211], v[210:211]
    v_pk_fma_f32 v[16:17], v[16:17], v[12:13], v[10:11]
    v_pk_fma_f32 v[18:19], v[18:19], v[12:13], v[10:11]
    v_pk_fma_f32 v[20:21], v[20:21], v[12:13], v[10:11]
    v_pk_fma_f32 v[22:23], v[22:23], v[12:13], v[10:11]
    v_pk_fma_f32 v[24:25], v[24:25], v[12:13], v[10:11]
    v_pk_fma_f32 v[26:27], v[26:27], v[12:13], v[10:11]
    v_pk_fma_f32 v[28:29], v[28:29], v[12:13], v[10:11]
    v_pk_fma_f32 v[30:31], v[30:31], v[12:13], v[10:11]
    v_pk_mul_f32 v[16:17], v[16:17], v[196:197]
    v_pk_mul_f32 v[18:19], v[18:19], v[198:199]
    v_pk_mul_f32 v[20:21], v[20:21], v[200:201]
    v_pk_mul_f32 v[22:23], v[22:23], v[202:203]
    v_pk_mul_f32 v[24:25], v[24:25], v[204:205]
    v_pk_mul_f32 v[26:27], v[26:27], v[206:207]
    v_pk_mul_f32 v[28:29], v[28:29], v[208:209]
    v_pk_mul_f32 v[30:31], v[30:31], v[210:211]
    v_exp_f32 v16, v16
    v_exp_f32 v17, v17
    v_exp_f32 v18, v18
    v_exp_f32 v19, v19
    v_exp_f32 v20, v20
    v_exp_f32 v21, v21
    v_exp_f32 v22, v22
    v_exp_f32 v23, v23
    v_exp_f32 v24, v24
    v_exp_f32 v25, v25
    v_exp_f32 v26, v26
    v_exp_f32 v27, v27
    v_exp_f32 v28, v28
    v_exp_f32 v29, v29
    v_exp_f32 v30, v30
    v_exp_f32 v31, v31
    v_pk_add_f32 v[16:17], v[16:17], v[14:15]
    v_pk_add_f32 v[18:19], v[18:19], v[14:15]
    v_pk_add_f32 v[20:21], v[20:21], v[14:15]
    v_pk_add_f32 v[22:23], v[22:23], v[14:15]
    v_pk_add_f32 v[24:25], v[24:25], v[14:15]
    v_pk_add_f32 v[26:27], v[26:27], v[14:15]
    v_pk_add_f32 v[28:29], v[28:29], v[14:15]
    v_pk_add_f32 v[30:31], v[30:31], v[14:15]
    v_rcp_f32 v16, v16
    v_rcp_f32 v17, v17
    v_rcp_f32 v18, v18
    v_rcp_f32 v19, v19
    v_rcp_f32 v20, v20
    v_rcp_f32 v21, v21
    v_rcp_f32 v22, v22
    v_rcp_f32 v23, v23
    v_rcp_f32 v24, v24
    v_rcp_f32 v25, v25
    v_rcp_f32 v26, v26
    v_rcp_f32 v27, v27
    v_rcp_f32 v28, v28
    v_rcp_f32 v29, v29
    v_rcp_f32 v30, v30
    v_rcp_f32 v31, v31
    v_pk_mul_f32 v[196:197], v[196:197], v[16:17]
    v_pk_mul_f32 v[198:199], v[198:199], v[18:19]
    v_pk_mul_f32 v[200:201], v[200:201], v[20:21]
    v_pk_mul_f32 v[202:203], v[202:203], v[22:23]
    v_pk_mul_f32 v[204:205], v[204:205], v[24:25]
    v_pk_mul_f32 v[206:207], v[206:207], v[26:27]
    v_pk_mul_f32 v[208:209], v[208:209], v[28:29]
    v_pk_mul_f32 v[210:211], v[210:211], v[30:31]
    v_cvt_pk_bf16_f32 v16, v196, v197
    v_cvt_pk_bf16_f32 v17, v198, v199
    v_cvt_pk_bf16_f32 v18, v200, v201
    v_cvt_pk_bf16_f32 v19, v202, v203
    v_cvt_pk_bf16_f32 v20, v204, v205
    v_cvt_pk_bf16_f32 v21, v206, v207
    v_cvt_pk_bf16_f32 v22, v208, v209
    v_cvt_pk_bf16_f32 v23, v210, v211
    s_mov_b32 s51, 249856
    s_nop 0
    v_permlane16_swap_b32 v16, v18
    v_permlane16_swap_b32 v17, v19
    v_permlane16_swap_b32 v20, v22
    v_permlane16_swap_b32 v21, v23
    buffer_store_dwordx4 v[16:19], v6, s[12:15], s51 offen sc1
    buffer_store_dwordx4 v[20:23], v6, s[12:15], s51 offen offset:1024 sc1
    v_pk_add_f32 v[240:241], v[240:241], v[48:49]
    v_pk_add_f32 v[242:243], v[242:243], v[50:51]
    v_pk_add_f32 v[244:245], v[244:245], v[52:53]
    v_pk_add_f32 v[246:247], v[246:247], v[54:55]
    v_pk_add_f32 v[248:249], v[248:249], v[56:57]
    v_pk_add_f32 v[250:251], v[250:251], v[58:59]
    v_pk_add_f32 v[252:253], v[252:253], v[60:61]
    v_pk_add_f32 v[254:255], v[254:255], v[62:63]
    v_pk_mul_f32 v[32:33], v[240:241], v[240:241]
    v_pk_mul_f32 v[34:35], v[242:243], v[242:243]
    v_pk_mul_f32 v[36:37], v[244:245], v[244:245]
    v_pk_mul_f32 v[38:39], v[246:247], v[246:247]
    v_pk_mul_f32 v[40:41], v[248:249], v[248:249]
    v_pk_mul_f32 v[42:43], v[250:251], v[250:251]
    v_pk_mul_f32 v[44:45], v[252:253], v[252:253]
    v_pk_mul_f32 v[46:47], v[254:255], v[254:255]
    v_pk_fma_f32 v[32:33], v[32:33], v[12:13], v[10:11]
    v_pk_fma_f32 v[34:35], v[34:35], v[12:13], v[10:11]
    v_pk_fma_f32 v[36:37], v[36:37], v[12:13], v[10:11]
    v_pk_fma_f32 v[38:39], v[38:39], v[12:13], v[10:11]
    v_pk_fma_f32 v[40:41], v[40:41], v[12:13], v[10:11]
    v_pk_fma_f32 v[42:43], v[42:43], v[12:13], v[10:11]
    v_pk_fma_f32 v[44:45], v[44:45], v[12:13], v[10:11]
    v_pk_fma_f32 v[46:47], v[46:47], v[12:13], v[10:11]
    v_pk_mul_f32 v[32:33], v[32:33], v[240:241]
    v_pk_mul_f32 v[34:35], v[34:35], v[242:243]
    v_pk_mul_f32 v[36:37], v[36:37], v[244:245]
    v_pk_mul_f32 v[38:39], v[38:39], v[246:247]
    v_pk_mul_f32 v[40:41], v[40:41], v[248:249]
    v_pk_mul_f32 v[42:43], v[42:43], v[250:251]
    v_pk_mul_f32 v[44:45], v[44:45], v[252:253]
    v_pk_mul_f32 v[46:47], v[46:47], v[254:255]
    v_exp_f32 v32, v32
    v_exp_f32 v33, v33
    v_exp_f32 v34, v34
    v_exp_f32 v35, v35
    v_exp_f32 v36, v36
    v_exp_f32 v37, v37
    v_exp_f32 v38, v38
    v_exp_f32 v39, v39
    v_exp_f32 v40, v40
    v_exp_f32 v41, v41
    v_exp_f32 v42, v42
    v_exp_f32 v43, v43
    v_exp_f32 v44, v44
    v_exp_f32 v45, v45
    v_exp_f32 v46, v46
    v_exp_f32 v47, v47
    v_pk_add_f32 v[32:33], v[32:33], v[14:15]
    v_pk_add_f32 v[34:35], v[34:35], v[14:15]
    v_pk_add_f32 v[36:37], v[36:37], v[14:15]
    v_pk_add_f32 v[38:39], v[38:39], v[14:15]
    v_pk_add_f32 v[40:41], v[40:41], v[14:15]
    v_pk_add_f32 v[42:43], v[42:43], v[14:15]
    v_pk_add_f32 v[44:45], v[44:45], v[14:15]
    v_pk_add_f32 v[46:47], v[46:47], v[14:15]
    v_rcp_f32 v32, v32
    v_rcp_f32 v33, v33
    v_rcp_f32 v34, v34
    v_rcp_f32 v35, v35
    v_rcp_f32 v36, v36
    v_rcp_f32 v37, v37
    v_rcp_f32 v38, v38
    v_rcp_f32 v39, v39
    v_rcp_f32 v40, v40
    v_rcp_f32 v41, v41
    v_rcp_f32 v42, v42
    v_rcp_f32 v43, v43
    v_rcp_f32 v44, v44
    v_rcp_f32 v45, v45
    v_rcp_f32 v46, v46
    v_rcp_f32 v47, v47
    v_pk_mul_f32 v[240:241], v[240:241], v[32:33]
    v_pk_mul_f32 v[242:243], v[242:243], v[34:35]
    v_pk_mul_f32 v[244:245], v[244:245], v[36:37]
    v_pk_mul_f32 v[246:247], v[246:247], v[38:39]
    v_pk_mul_f32 v[248:249], v[248:249], v[40:41]
    v_pk_mul_f32 v[250:251], v[250:251], v[42:43]
    v_pk_mul_f32 v[252:253], v[252:253], v[44:45]
    v_pk_mul_f32 v[254:255], v[254:255], v[46:47]
    v_cvt_pk_bf16_f32 v32, v240, v241
    v_cvt_pk_bf16_f32 v33, v242, v243
    v_cvt_pk_bf16_f32 v34, v244, v245
    v_cvt_pk_bf16_f32 v35, v246, v247
    v_cvt_pk_bf16_f32 v36, v248, v249
    v_cvt_pk_bf16_f32 v37, v250, v251
    v_cvt_pk_bf16_f32 v38, v252, v253
    v_cvt_pk_bf16_f32 v39, v254, v255
    s_mov_b32 s51, 374784
    s_nop 0
    v_permlane16_swap_b32 v32, v34
    v_permlane16_swap_b32 v33, v35
    v_permlane16_swap_b32 v36, v38
    v_permlane16_swap_b32 v37, v39
    buffer_store_dwordx4 v[32:35], v6, s[12:15], s51 offen sc1
    buffer_store_dwordx4 v[36:39], v6, s[12:15], s51 offen offset:1024 sc1
    s_mov_b32 s94, 99
    s_waitcnt vmcnt(0)
    v_mov_b32 v0, 155656
    v_mov_b32 v1, 1
    s_mov_b64 exec, 1
    ds_add_rtn_u32 v1, v0, v1
    s_waitcnt lgkmcnt(0)
    v_cmp_eq_u32 vcc, 3, v1
    s_cbranch_vccz sig_g1m
    v_mov_b32 v0, 0
    v_mov_b32 v1, s95
    buffer_store_dword v1, v0, s[96:99], s34 offen sc1
    buffer_store_dword v1, v0, s[96:99], s35 offen sc1
sig_g1m:
    s_mov_b64 exec, -1
    s_branch g2_comp
g1f_start:
    s_cmp_ge_u32 s39, 4
    s_cbranch_scc0 g1f_comp
    s_lshl_b32 s49, s3, 6
    s_add_u32 s49, s49, s40
    v_lshrrev_b32 v2, 2, v1
    v_and_b32 v2, 7, v2
    s_mov_b32 s50, 2176
    v_mul_lo_u32 v2, v2, s50
    v_lshrrev_b32 v3, 5, v1
    v_lshl_add_u32 v2, v3, 6, v2
    v_lshrrev_b32 v3, 3, v1
    v_and_b32 v3, 2, v3
    v_and_b32 v4, 3, v1
    v_xor_b32 v3, v3, v4
    v_lshlrev_b32 v3, 4, v3
    v_xor_b32 v4, 48, v3
    v_add_u32 v3, v3, v2
    v_add_u32 v4, v4, v2
    s_mul_i32 s49, s49, 2176
    s_add_u32 s50, s49, 0
    v_add_u32 v8, s50, v3
    s_add_u32 s50, s49, 16384
    v_add_u32 v9, s50, v4
    s_add_u32 s50, s49, 32768
    v_add_u32 v10, s50, v3
    s_add_u32 s50, s49, 49152
    v_add_u32 v11, s50, v4
    s_add_u32 s50, s49, 69632
    v_add_u32 v12, s50, v3
    s_add_u32 s50, s49, 86016
    v_add_u32 v13, s50, v4
    s_add_u32 s50, s49, 102400
    v_add_u32 v14, s50, v3
    s_add_u32 s50, s49, 118784
    v_add_u32 v15, s50, v4
    s_lshl_b32 s52, s3, 13
    s_add_u32 s53, s52, 4096
    s_mul_i32 s54, s3, 6144
    s_add_u32 s54, s54, 65536
    s_add_u32 s55, s54, 4096
    s_mov_b32 s64, s24
    s_mov_b32 s65, s25
    s_mov_b32 s66, 7340032
    s_mov_b32 s67, 0x20000
    s_mul_i32 s49, s41, 352
    s_sub_u32 s49, s49, 4096
    s_mul_i32 s50, s3, 384
    v_add_u32 v2, s50, v1
    v_mul_u32_u24 v3, 1425, v2
    v_lshrrev_b32 v3, 18, v3
    v_mul_u32_u24 v4, 184, v3
    v_sub_u32 v2, v2, v4
    v_mul_u32_u24 v4, 187, v2
    v_lshrrev_b32 v4, 12, v4
    v_mul_u32_u24 v5, 22, v4
    v_sub_u32 v5, v2, v5
    v_lshl_add_u32 v3, v3, 3, v4
    v_mul_u32_u24 v6, 7168, v3
    v_lshl_add_u32 v6, v5, 4, v6
    v_add_u32 v6, s49, v6
    v_cmp_gt_u32 vcc, 8, v4
    v_mov_b32 v7, 0x7ff00000
    s_nop 0
    v_cndmask_b32 v6, v7, v6, vcc
    v_cmp_gt_u32 vcc, 22, v5
    s_nop 1
    v_cndmask_b32 v6, v7, v6, vcc
    v_cmp_gt_u32 vcc, 64, v3
    s_nop 1
    v_cndmask_b32 v16, v7, v6, vcc
    v_add_u32 v2, s50, v1
    v_add_u32 v2, 64, v2
    v_mul_u32_u24 v3, 1425, v2
    v_lshrrev_b32 v3, 18, v3
    v_mul_u32_u24 v4, 184, v3
    v_sub_u32 v2, v2, v4
    v_mul_u32_u24 v4, 187, v2
    v_lshrrev_b32 v4, 12, v4
    v_mul_u32_u24 v5, 22, v4
    v_sub_u32 v5, v2, v5
    v_lshl_add_u32 v3, v3, 3, v4
    v_mul_u32_u24 v6, 7168, v3
    v_lshl_add_u32 v6, v5, 4, v6
    v_add_u32 v6, s49, v6
    v_subrev_u32 v6, 1024, v6
    v_cmp_gt_u32 vcc, 8, v4
    v_mov_b32 v7, 0x7ff00000
    s_nop 0
    v_cndmask_b32 v6, v7, v6, vcc
    v_cmp_gt_u32 vcc, 22, v5
    s_nop 1
    v_cndmask_b32 v6, v7, v6, vcc
    v_cmp_gt_u32 vcc, 64, v3
    s_nop 1
    v_cndmask_b32 v17, v7, v6, vcc
    v_add_u32 v2, s50, v1
    v_add_u32 v2, 128, v2
    v_mul_u32_u24 v3, 1425, v2
    v_lshrrev_b32 v3, 18, v3
    v_mul_u32_u24 v4, 184, v3
    v_sub_u32 v2, v2, v4
    v_mul_u32_u24 v4, 187, v2
    v_lshrrev_b32 v4, 12, v4
    v_mul_u32_u24 v5, 22, v4
    v_sub_u32 v5, v2, v5
    v_lshl_add_u32 v3, v3, 3, v4
    v_mul_u32_u24 v6, 7168, v3
    v_lshl_add_u32 v6, v5, 4, v6
    v_add_u32 v6, s49, v6
    v_subrev_u32 v6, 2048, v6
    v_cmp_gt_u32 vcc, 8, v4
    v_mov_b32 v7, 0x7ff00000
    s_nop 0
    v_cndmask_b32 v6, v7, v6, vcc
    v_cmp_gt_u32 vcc, 22, v5
    s_nop 1
    v_cndmask_b32 v6, v7, v6, vcc
    v_cmp_gt_u32 vcc, 64, v3
    s_nop 1
    v_cndmask_b32 v18, v7, v6, vcc
    v_add_u32 v2, s50, v1
    v_add_u32 v2, 192, v2
    v_mul_u32_u24 v3, 1425, v2
    v_lshrrev_b32 v3, 18, v3
    v_mul_u32_u24 v4, 184, v3
    v_sub_u32 v2, v2, v4
    v_mul_u32_u24 v4, 187, v2
    v_lshrrev_b32 v4, 12, v4
    v_mul_u32_u24 v5, 22, v4
    v_sub_u32 v5, v2, v5
    v_lshl_add_u32 v3, v3, 3, v4
    v_mul_u32_u24 v6, 7168, v3
    v_lshl_add_u32 v6, v5, 4, v6
    v_add_u32 v6, s49, v6
    v_subrev_u32 v6, 3072, v6
    v_cmp_gt_u32 vcc, 8, v4
    v_mov_b32 v7, 0x7ff00000
    s_nop 0
    v_cndmask_b32 v6, v7, v6, vcc
    v_cmp_gt_u32 vcc, 22, v5
    s_nop 1
    v_cndmask_b32 v6, v7, v6, vcc
    v_cmp_gt_u32 vcc, 64, v3
    s_nop 1
    v_cndmask_b32 v19, v7, v6, vcc
    v_add_u32 v2, s50, v1
    v_add_u32 v2, 256, v2
    v_mul_u32_u24 v3, 1425, v2
    v_lshrrev_b32 v3, 18, v3
    v_mul_u32_u24 v4, 184, v3
    v_sub_u32 v2, v2, v4
    v_mul_u32_u24 v4, 187, v2
    v_lshrrev_b32 v4, 12, v4
    v_mul_u32_u24 v5, 22, v4
    v_sub_u32 v5, v2, v5
    v_lshl_add_u32 v3, v3, 3, v4
    v_mul_u32_u24 v6, 7168, v3
    v_lshl_add_u32 v6, v5, 4, v6
    v_add_u32 v6, s49, v6
    v_cmp_gt_u32 vcc, 8, v4
    v_mov_b32 v7, 0x7ff00000
    s_nop 0
    v_cndmask_b32 v6, v7, v6, vcc
    v_cmp_gt_u32 vcc, 22, v5
    s_nop 1
    v_cndmask_b32 v6, v7, v6, vcc
    v_cmp_gt_u32 vcc, 64, v3
    s_nop 1
    v_cndmask_b32 v20, v7, v6, vcc
    v_add_u32 v2, s50, v1
    v_add_u32 v2, 320, v2
    v_mul_u32_u24 v3, 1425, v2
    v_lshrrev_b32 v3, 18, v3
    v_mul_u32_u24 v4, 184, v3
    v_sub_u32 v2, v2, v4
    v_mul_u32_u24 v4, 187, v2
    v_lshrrev_b32 v4, 12, v4
    v_mul_u32_u24 v5, 22, v4
    v_sub_u32 v5, v2, v5
    v_lshl_add_u32 v3, v3, 3, v4
    v_mul_u32_u24 v6, 7168, v3
    v_lshl_add_u32 v6, v5, 4, v6
    v_add_u32 v6, s49, v6
    v_subrev_u32 v6, 1024, v6
    v_cmp_gt_u32 vcc, 8, v4
    v_mov_b32 v7, 0x7ff00000
    s_nop 0
    v_cndmask_b32 v6, v7, v6, vcc
    v_cmp_gt_u32 vcc, 22, v5
    s_nop 1
    v_cndmask_b32 v6, v7, v6, vcc
    v_cmp_gt_u32 vcc, 64, v3
    s_nop 1
    v_cndmask_b32 v21, v7, v6, vcc
    s_mov_b32 s46, 0
    s_mov_b32 s61, s60
    s_mov_b32 s92, 0
    s_mov_b32 s93, s60
    s_add_u32 m0, s92, s54
    s_nop 0
    buffer_load_dwordx4 v16, s[64:67], s44 offen lds
    buffer_load_dwordx4 v17, s[64:67], s44 offen offset:1024 lds
    buffer_load_dwordx4 v18, s[64:67], s44 offen offset:2048 lds
    buffer_load_dwordx4 v19, s[64:67], s44 offen offset:3072 lds
    s_add_u32 m0, s92, s55
    s_nop 0
    buffer_load_dwordx4 v20, s[64:67], s44 offen lds
    buffer_load_dwordx4 v21, s[64:67], s44 offen offset:1024 lds
    s_add_u32 s44, s44, 458752
    s_add_u32 s92, s92, 24576
    s_cmp_ge_u32 s92, 73728
    s_cselect_b32 s92, 0, s92
    s_sub_u32 s93, s93, 1
    s_cmp_lt_i32 s93, 1
    s_cselect_b32 s66, 0, s66
    s_add_u32 m0, s92, s54
    s_nop 0
    buffer_load_dwordx4 v16, s[64:67], s44 offen lds
    buffer_load_dwordx4 v17, s[64:67], s44 offen offset:1024 lds
    buffer_load_dwordx4 v18, s[64:67], s44 offen offset:2048 lds
    buffer_load_dwordx4 v19, s[64:67], s44 offen offset:3072 lds
    s_add_u32 m0, s92, s55
    s_nop 0
    buffer_load_dwordx4 v20, s[64:67], s44 offen lds
    buffer_load_dwordx4 v21, s[64:67], s44 offen offset:1024 lds
    s_add_u32 s44, s44, 458752
    s_add_u32 s92, s92, 24576
    s_cmp_ge_u32 s92, 73728
    s_cselect_b32 s92, 0, s92
    s_sub_u32 s93, s93, 1
    s_cmp_lt_i32 s93, 1
    s_cselect_b32 s66, 0, s66
    s_add_u32 m0, s92, s54
    s_nop 0
    buffer_load_dwordx4 v16, s[64:67], s44 offen lds
    buffer_load_dwordx4 v17, s[64:67], s44 offen offset:1024 lds
    buffer_load_dwordx4 v18, s[64:67], s44 offen offset:2048 lds
    buffer_load_dwordx4 v19, s[64:67], s44 offen offset:3072 lds
    s_add_u32 m0, s92, s55
    s_nop 0
    buffer_load_dwordx4 v20, s[64:67], s44 offen lds
    buffer_load_dwordx4 v21, s[64:67], s44 offen offset:1024 lds
    s_add_u32 s44, s44, 458752
    s_add_u32 s92, s92, 24576
    s_cmp_ge_u32 s92, 73728
    s_cselect_b32 s92, 0, s92
    s_sub_u32 s93, s93, 1
    s_cmp_lt_i32 s93, 1
    s_cselect_b32 s66, 0, s66
    s_waitcnt vmcnt(18)
    s_barrier
    v_mov_b32 v2, 155680
    ds_read_b32 v2, v2
    s_waitcnt lgkmcnt(0)
    v_readfirstlane_b32 s95, v2
    s_nop 3
    s_cmp_lg_u32 s3, 0
    s_cbranch_scc1 g1f_nf
    s_lshl_b32 s37, s2, 2
    v_mov_b32 v2, 0
    v_mov_b32 v3, s95
    s_mov_b64 exec, 1
    buffer_store_dword v3, v2, s[96:99], s37 offen sc1
    s_mov_b64 exec, -1
g1f_nf:
    s_lshr_b32 s49, s40, 1
    v_and_b32 v2, 31, v1
    v_lshl_add_u32 v2, v2, 2, s49
    v_mov_b32 v4, 155700
    s_cmp_lg_u32 s3, 0
    s_cbranch_scc1 lw_g1f
    s_mov_b32 s51, 200000
poll_g1f:
    buffer_load_dword v3, v2, s[96:99], 0 offen sc1
    s_waitcnt vmcnt(0)
    v_cmp_ne_u32 vcc, s95, v3
    s_cbranch_vccz polld_g1f
    s_sleep 1
    s_sub_u32 s51, s51, 1
    s_cmp_lg_u32 s51, 0
    s_cbranch_scc1 poll_g1f
polld_g1f:
    v_mov_b32 v3, 1
    ds_write_b32 v4, v3
    s_branch lwd_g1f
lw_g1f:
    s_mov_b32 s51, 4000000
lwl_g1f:
    ds_read_b32 v3, v4
    s_waitcnt lgkmcnt(0)
    v_cmp_ne_u32 vcc, 1, v3
    s_cbranch_vccz lwd_g1f
    s_sleep 1
    s_sub_u32 s51, s51, 1
    s_cmp_lg_u32 s51, 0
    s_cbranch_scc1 lwl_g1f
lwd_g1f:
    s_add_u32 m0, s46, s52
    s_nop 0
    buffer_load_dwordx4 v8, s[8:11], s42 offen sc1 lds
    buffer_load_dwordx4 v9, s[8:11], s42 offen offset:1024 sc1 lds
    buffer_load_dwordx4 v10, s[8:11], s42 offen offset:2048 sc1 lds
    buffer_load_dwordx4 v11, s[8:11], s42 offen offset:3072 sc1 lds
    s_add_u32 m0, s46, s53
    s_nop 0
    buffer_load_dwordx4 v12, s[8:11], s42 offen sc1 lds
    buffer_load_dwordx4 v13, s[8:11], s42 offen offset:1024 sc1 lds
    buffer_load_dwordx4 v14, s[8:11], s42 offen offset:2048 sc1 lds
    buffer_load_dwordx4 v15, s[8:11], s42 offen offset:3072 sc1 lds
    s_add_u32 s42, s42, 128
    s_add_u32 s46, s46, 32768
    s_cmp_ge_u32 s46, 65536
    s_cselect_b32 s46, 0, s46
    s_sub_u32 s61, s61, 1
    s_cmp_lt_i32 s61, 1
    s_cselect_b32 s10, 0, s10
    s_add_u32 m0, s46, s52
    s_nop 0
    buffer_load_dwordx4 v8, s[8:11], s42 offen sc1 lds
    buffer_load_dwordx4 v9, s[8:11], s42 offen offset:1024 sc1 lds
    buffer_load_dwordx4 v10, s[8:11], s42 offen offset:2048 sc1 lds
    buffer_load_dwordx4 v11, s[8:11], s42 offen offset:3072 sc1 lds
    s_add_u32 m0, s46, s53
    s_nop 0
    buffer_load_dwordx4 v12, s[8:11], s42 offen sc1 lds
    buffer_load_dwordx4 v13, s[8:11], s42 offen offset:1024 sc1 lds
    buffer_load_dwordx4 v14, s[8:11], s42 offen offset:2048 sc1 lds
    buffer_load_dwordx4 v15, s[8:11], s42 offen offset:3072 sc1 lds
    s_add_u32 s42, s42, 128
    s_add_u32 s46, s46, 32768
    s_cmp_ge_u32 s46, 65536
    s_cselect_b32 s46, 0, s46
    s_sub_u32 s61, s61, 1
    s_cmp_lt_i32 s61, 1
    s_cselect_b32 s10, 0, s10
    s_waitcnt vmcnt(8)
    s_barrier
    s_mov_b32 s45, s60
    s_waitcnt vmcnt(0)
    s_branch g1f_lmid
g1f_lloop:
    s_waitcnt vmcnt(6)
g1f_lmid:
    s_barrier
    s_add_u32 m0, s46, s52
    s_nop 0
    buffer_load_dwordx4 v8, s[8:11], s42 offen sc1 lds
    buffer_load_dwordx4 v9, s[8:11], s42 offen offset:1024 sc1 lds
    buffer_load_dwordx4 v10, s[8:11], s42 offen offset:2048 sc1 lds
    buffer_load_dwordx4 v11, s[8:11], s42 offen offset:3072 sc1 lds
    s_add_u32 m0, s46, s53
    s_nop 0
    buffer_load_dwordx4 v12, s[8:11], s42 offen sc1 lds
    buffer_load_dwordx4 v13, s[8:11], s42 offen offset:1024 sc1 lds
    buffer_load_dwordx4 v14, s[8:11], s42 offen offset:2048 sc1 lds
    buffer_load_dwordx4 v15, s[8:11], s42 offen offset:3072 sc1 lds
    s_add_u32 m0, s92, s54
    s_nop 0
    buffer_load_dwordx4 v16, s[64:67], s44 offen lds
    buffer_load_dwordx4 v17, s[64:67], s44 offen offset:1024 lds
    buffer_load_dwordx4 v18, s[64:67], s44 offen offset:2048 lds
    buffer_load_dwordx4 v19, s[64:67], s44 offen offset:3072 lds
    s_add_u32 m0, s92, s55
    s_nop 0
    buffer_load_dwordx4 v20, s[64:67], s44 offen lds
    buffer_load_dwordx4 v21, s[64:67], s44 offen offset:1024 lds
    s_add_u32 s42, s42, 128
    s_add_u32 s46, s46, 32768
    s_cmp_ge_u32 s46, 65536
    s_cselect_b32 s46, 0, s46
    s_sub_u32 s61, s61, 1
    s_cmp_lt_i32 s61, 1
    s_cselect_b32 s10, 0, s10
    s_add_u32 s44, s44, 458752
    s_add_u32 s92, s92, 24576
    s_cmp_ge_u32 s92, 73728
    s_cselect_b32 s92, 0, s92
    s_sub_u32 s93, s93, 1
    s_cmp_lt_i32 s93, 1
    s_cselect_b32 s66, 0, s66
    s_sub_u32 s45, s45, 1
    s_cmp_lg_u32 s45, 0
    s_cbranch_scc1 g1f_lloop
    s_branch g2_loader
g1f_comp:
    s_waitcnt vmcnt(0)
    s_barrier
    v_mov_b32 v4, 155680
    ds_read_b32 v4, v4
    s_waitcnt lgkmcnt(0)
    v_readfirstlane_b32 s95, v4
    s_nop 3
    s_mov_b32 m0, 155904
    s_lshr_b32 s34, s2, 3
    s_cmp_ge_u32 s34, 3
    s_cbranch_scc1 g1f_w1
    s_lshl_b32 s34, s34, 2
    s_add_u32 s34, s34, s3
    s_lshl_b32 s34, s34, 13
    v_lshlrev_b32 v4, 7, v1
    v_add_u32 v4, s34, v4
    v_min_u32 v4, k_done-recurrent_scan__spectral_fnet__dense_activation_gelu__prompt_kernel, v4
    s_getpc_b64 s[34:35]
g1f_pc:
    s_sub_u32 s34, s34, g1f_pc-recurrent_scan__spectral_fnet__dense_activation_gelu__prompt_kernel
    s_subb_u32 s35, s35, 0
    global_load_lds_dword v4, s[34:35]
g1f_w1:
    s_load_dwordx4 s[64:67], s[0:1], 8
    s_load_dwordx2 s[68:69], s[0:1], 64
    s_load_dwordx2 s[70:71], s[0:1], 80
    v_lshlrev_b32 v4, 21, v1
    s_waitcnt lgkmcnt(0)
    s_cmp_eq_u32 s3, 0
    s_cselect_b32 s72, s28, s64
    s_cselect_b32 s73, s29, s65
    s_mov_b32 s74, 8388608
    s_cselect_b32 s74, 67108864, s74
    s_cmp_eq_u32 s3, 2
    s_cselect_b32 s72, s66, s72
    s_cselect_b32 s73, s67, s73
    s_cmp_eq_u32 s3, 3
    s_cselect_b32 s72, s68, s72
    s_cselect_b32 s73, s69, s73
    s_cselect_b32 s74, 7340032, s74
    s_mov_b32 s75, 0x20000
    buffer_load_dword v4, s[72:75], 0 offen lds
    s_mov_b32 s72, s70
    s_mov_b32 s73, s71
    s_mov_b32 s74, 4194304
    s_mov_b32 s75, 0x20000
    buffer_load_dword v4, s[72:75], 0 offen lds
    s_load_dwordx2 s[64:65], s[0:1], 8
    s_load_dwordx2 s[68:69], s[0:1], 16
    s_load_dwordx2 s[70:71], s[0:1], 64
    s_mov_b32 m0, 155904
    s_lshl_b32 s74, s2, 2
    s_add_u32 s74, s74, s3
    s_lshl_b32 s74, s74, 13
    s_mov_b32 s94, s74
    s_mov_b32 s66, 8388608
    s_mov_b32 s67, 0x20000
    s_mov_b32 s72, 8388608
    s_mov_b32 s73, 7340032
    v_cmp_gt_u32 vcc, 16, v1
    v_lshlrev_b32 v30, 7, v1
    v_mov_b32 v31, 0x7ff00000
    v_cndmask_b32 v30, v31, v30, vcc
    s_waitcnt lgkmcnt(0)
    v_mov_b32 v20, v1
    s_mul_i32 s49, s3, 8192
    s_mov_b32 s50, 0
    v_and_b32 v4, 15, v20
    v_lshrrev_b32 v5, 4, v20
    v_lshrrev_b32 v6, 3, v4
    v_lshrrev_b32 v7, 2, v4
    v_and_b32 v7, 1, v7
    v_xor_b32 v7, v7, v6
    v_lshl_add_u32 v7, v7, 1, v6
    v_xor_b32 v7, v7, v5
    v_lshlrev_b32 v7, 4, v7
    v_lshl_add_u32 v15, v4, 6, v7
    v_lshl_add_u32 v7, v6, 10, v7
    v_and_b32 v6, 7, v4
    v_lshl_add_u32 v6, v6, 6, v7
    v_lshrrev_b32 v8, 2, v20
    v_and_b32 v8, 3, v8
    v_and_b32 v9, 3, v20
    v_lshl_add_u32 v10, v5, 3, v8
    v_mul_u32_u24 v10, 352, v10
    v_lshl_add_u32 v10, v5, 7, v10
    v_lshl_add_u32 v10, v9, 3, v10
    v_add_u32 v10, 65536, v10
    v_mov_b32 v1, v10
    v_add_u32 v0, s49, v6
    v_mov_b32 v80, 0
    v_mov_b32 v81, 0
    v_mov_b32 v82, 0
    v_mov_b32 v83, 0
    v_mov_b32 v84, 0
    v_mov_b32 v85, 0
    v_mov_b32 v86, 0
    v_mov_b32 v87, 0
    v_mov_b32 v88, 0
    v_mov_b32 v89, 0
    v_mov_b32 v90, 0
    v_mov_b32 v91, 0
    v_mov_b32 v92, 0
    v_mov_b32 v93, 0
    v_mov_b32 v94, 0
    v_mov_b32 v95, 0
    v_mov_b32 v96, 0
    v_mov_b32 v97, 0
    v_mov_b32 v98, 0
    v_mov_b32 v99, 0
    v_mov_b32 v100, 0
    v_mov_b32 v101, 0
    v_mov_b32 v102, 0
    v_mov_b32 v103, 0
    v_mov_b32 v104, 0
    v_mov_b32 v105, 0
    v_mov_b32 v106, 0
    v_mov_b32 v107, 0
    v_mov_b32 v108, 0
    v_mov_b32 v109, 0
    v_mov_b32 v110, 0
    v_mov_b32 v111, 0
    v_mov_b32 v112, 0
    v_mov_b32 v113, 0
    v_mov_b32 v114, 0
    v_mov_b32 v115, 0
    v_mov_b32 v116, 0
    v_mov_b32 v117, 0
    v_mov_b32 v118, 0
    v_mov_b32 v119, 0
    v_mov_b32 v120, 0
    v_mov_b32 v121, 0
    v_mov_b32 v122, 0
    v_mov_b32 v123, 0
    v_mov_b32 v124, 0
    v_mov_b32 v125, 0
    v_mov_b32 v126, 0
    v_mov_b32 v127, 0
    v_mov_b32 v128, 0
    v_mov_b32 v129, 0
    v_mov_b32 v130, 0
    v_mov_b32 v131, 0
    v_mov_b32 v132, 0
    v_mov_b32 v133, 0
    v_mov_b32 v134, 0
    v_mov_b32 v135, 0
    v_mov_b32 v136, 0
    v_mov_b32 v137, 0
    v_mov_b32 v138, 0
    v_mov_b32 v139, 0
    v_mov_b32 v140, 0
    v_mov_b32 v141, 0
    v_mov_b32 v142, 0
    v_mov_b32 v143, 0
    v_mov_b32 v144, 0
    v_mov_b32 v145, 0
    v_mov_b32 v146, 0
    v_mov_b32 v147, 0
    v_mov_b32 v148, 0
    v_mov_b32 v149, 0
    v_mov_b32 v150, 0
    v_mov_b32 v151, 0
    v_mov_b32 v152, 0
    v_mov_b32 v153, 0
    v_mov_b32 v154, 0
    v_mov_b32 v155, 0
    v_mov_b32 v156, 0
    v_mov_b32 v157, 0
    v_mov_b32 v158, 0
    v_mov_b32 v159, 0
    v_mov_b32 v160, 0
    v_mov_b32 v161, 0
    v_mov_b32 v162, 0
    v_mov_b32 v163, 0
    v_mov_b32 v164, 0
    v_mov_b32 v165, 0
    v_mov_b32 v166, 0
    v_mov_b32 v167, 0
    v_mov_b32 v168, 0
    v_mov_b32 v169, 0
    v_mov_b32 v170, 0
    v_mov_b32 v171, 0
    v_mov_b32 v172, 0
    v_mov_b32 v173, 0
    v_mov_b32 v174, 0
    v_mov_b32 v175, 0
    v_mov_b32 v176, 0
    v_mov_b32 v177, 0
    v_mov_b32 v178, 0
    v_mov_b32 v179, 0
    v_mov_b32 v180, 0
    v_mov_b32 v181, 0
    v_mov_b32 v182, 0
    v_mov_b32 v183, 0
    v_mov_b32 v184, 0
    v_mov_b32 v185, 0
    v_mov_b32 v186, 0
    v_mov_b32 v187, 0
    v_mov_b32 v188, 0
    v_mov_b32 v189, 0
    v_mov_b32 v190, 0
    v_mov_b32 v191, 0
    v_mov_b32 v192, 0
    v_mov_b32 v193, 0
    v_mov_b32 v194, 0
    v_mov_b32 v195, 0
    v_mov_b32 v196, 0
    v_mov_b32 v197, 0
    v_mov_b32 v198, 0
    v_mov_b32 v199, 0
    v_mov_b32 v200, 0
    v_mov_b32 v201, 0
    v_mov_b32 v202, 0
    v_mov_b32 v203, 0
    v_mov_b32 v204, 0
    v_mov_b32 v205, 0
    v_mov_b32 v206, 0
    v_mov_b32 v207, 0
    v_mov_b32 v208, 0
    v_mov_b32 v209, 0
    v_mov_b32 v210, 0
    v_mov_b32 v211, 0
    v_mov_b32 v212, 0
    v_mov_b32 v213, 0
    v_mov_b32 v214, 0
    v_mov_b32 v215, 0
    v_mov_b32 v216, 0
    v_mov_b32 v217, 0
    v_mov_b32 v218, 0
    v_mov_b32 v219, 0
    v_mov_b32 v220, 0
    v_mov_b32 v221, 0
    v_mov_b32 v222, 0
    v_mov_b32 v223, 0
    v_mov_b32 v224, 0
    v_mov_b32 v225, 0
    v_mov_b32 v226, 0
    v_mov_b32 v227, 0
    v_mov_b32 v228, 0
    v_mov_b32 v229, 0
    v_mov_b32 v230, 0
    v_mov_b32 v231, 0
    v_mov_b32 v232, 0
    v_mov_b32 v233, 0
    v_mov_b32 v234, 0
    v_mov_b32 v235, 0
    v_mov_b32 v236, 0
    v_mov_b32 v237, 0
    v_mov_b32 v238, 0
    v_mov_b32 v239, 0
    v_mov_b32 v240, 0
    v_mov_b32 v241, 0
    v_mov_b32 v242, 0
    v_mov_b32 v243, 0
    v_mov_b32 v244, 0
    v_mov_b32 v245, 0
    v_mov_b32 v246, 0
    v_mov_b32 v247, 0
    v_mov_b32 v248, 0
    v_mov_b32 v249, 0
    v_mov_b32 v250, 0
    v_mov_b32 v251, 0
    v_mov_b32 v252, 0
    v_mov_b32 v253, 0
    v_mov_b32 v254, 0
    v_mov_b32 v255, 0
    v_mov_b32 v3, v30
    s_mov_b32 s47, 0
    s_mov_b32 s88, 24576
    s_mov_b32 s48, 24576
    s_barrier
    ds_read_b128 v[4:7], v0 offset:0
    ds_read_b128 v[8:11], v0 offset:2048
    ds_read_b128 v[12:15], v0 offset:4096
    ds_read_b128 v[16:19], v0 offset:6144
    ds_read_b64_tr_b16 v[36:37], v1 offset:0
    ds_read_b64_tr_b16 v[38:39], v1 offset:1408
    ds_read_b64_tr_b16 v[40:41], v1 offset:32
    ds_read_b64_tr_b16 v[42:43], v1 offset:1440
    ds_read_b64_tr_b16 v[44:45], v1 offset:64
    ds_read_b64_tr_b16 v[46:47], v1 offset:1472
    ds_read_b64_tr_b16 v[48:49], v1 offset:96
    ds_read_b64_tr_b16 v[50:51], v1 offset:1504
    ds_read_b64_tr_b16 v[52:53], v1 offset:128
    ds_read_b64_tr_b16 v[54:55], v1 offset:1536
    ds_read_b64_tr_b16 v[56:57], v1 offset:160
    ds_read_b64_tr_b16 v[58:59], v1 offset:1568
    ds_read_b64_tr_b16 v[60:61], v1 offset:192
    ds_read_b64_tr_b16 v[62:63], v1 offset:1600
    ds_read_b64_tr_b16 v[64:65], v1 offset:224
    ds_read_b64_tr_b16 v[66:67], v1 offset:1632
    ds_read_b64_tr_b16 v[68:69], v1 offset:256
    ds_read_b64_tr_b16 v[70:71], v1 offset:1664
    ds_read_b64_tr_b16 v[72:73], v1 offset:288
    ds_read_b64_tr_b16 v[74:75], v1 offset:1696
    ds_read_b64_tr_b16 v[76:77], v1 offset:320
    ds_read_b64_tr_b16 v[78:79], v1 offset:1728
    s_mov_b32 s45, s60
    s_waitcnt lgkmcnt(0)
    s_branch g1f_mid
.p2align 6
g1f_top:
    v_mfma_f32_16x16x32_bf16 v[180:183], v[48:51], v[28:31], v[180:183]
    ds_read_b128 v[16:19], v0 offset:6144
    v_mfma_f32_16x16x32_bf16 v[224:227], v[48:51], v[32:35], v[224:227]
    ds_read_b64_tr_b16 v[36:37], v1 offset:0
    v_mfma_f32_16x16x32_bf16 v[96:99], v[52:55], v[20:23], v[96:99]
    ds_read_b64_tr_b16 v[38:39], v1 offset:1408
    v_mfma_f32_16x16x32_bf16 v[140:143], v[52:55], v[24:27], v[140:143]
    ds_read_b64_tr_b16 v[40:41], v1 offset:32
    v_mfma_f32_16x16x32_bf16 v[184:187], v[52:55], v[28:31], v[184:187]
    ds_read_b64_tr_b16 v[42:43], v1 offset:1440
    v_mfma_f32_16x16x32_bf16 v[228:231], v[52:55], v[32:35], v[228:231]
    ds_read_b64_tr_b16 v[44:45], v1 offset:64
    v_mfma_f32_16x16x32_bf16 v[100:103], v[56:59], v[20:23], v[100:103]
    ds_read_b64_tr_b16 v[46:47], v1 offset:1472
    v_mfma_f32_16x16x32_bf16 v[144:147], v[56:59], v[24:27], v[144:147]
    ds_read_b64_tr_b16 v[48:49], v1 offset:96
    v_mfma_f32_16x16x32_bf16 v[188:191], v[56:59], v[28:31], v[188:191]
    ds_read_b64_tr_b16 v[50:51], v1 offset:1504
    v_mfma_f32_16x16x32_bf16 v[232:235], v[56:59], v[32:35], v[232:235]
    ds_read_b64_tr_b16 v[52:53], v1 offset:128
    v_mfma_f32_16x16x32_bf16 v[104:107], v[60:63], v[20:23], v[104:107]
    ds_read_b64_tr_b16 v[54:55], v1 offset:1536
    v_mfma_f32_16x16x32_bf16 v[148:151], v[60:63], v[24:27], v[148:151]
    ds_read_b64_tr_b16 v[56:57], v1 offset:160
    v_mfma_f32_16x16x32_bf16 v[192:195], v[60:63], v[28:31], v[192:195]
    ds_read_b64_tr_b16 v[58:59], v1 offset:1568
    v_mfma_f32_16x16x32_bf16 v[236:239], v[60:63], v[32:35], v[236:239]
    ds_read_b64_tr_b16 v[60:61], v1 offset:192
    v_mfma_f32_16x16x32_bf16 v[108:111], v[64:67], v[20:23], v[108:111]
    ds_read_b64_tr_b16 v[62:63], v1 offset:1600
    v_mfma_f32_16x16x32_bf16 v[152:155], v[64:67], v[24:27], v[152:155]
    v_mfma_f32_16x16x32_bf16 v[196:199], v[64:67], v[28:31], v[196:199]
    v_mfma_f32_16x16x32_bf16 v[240:243], v[64:67], v[32:35], v[240:243]
    ds_read_b64_tr_b16 v[64:65], v1 offset:224
    v_mfma_f32_16x16x32_bf16 v[112:115], v[68:71], v[20:23], v[112:115]
    ds_read_b64_tr_b16 v[66:67], v1 offset:1632
    v_mfma_f32_16x16x32_bf16 v[156:159], v[68:71], v[24:27], v[156:159]
    v_mfma_f32_16x16x32_bf16 v[200:203], v[68:71], v[28:31], v[200:203]
    v_mfma_f32_16x16x32_bf16 v[244:247], v[68:71], v[32:35], v[244:247]
    ds_read_b64_tr_b16 v[68:69], v1 offset:256
    v_mfma_f32_16x16x32_bf16 v[116:119], v[72:75], v[20:23], v[116:119]
    ds_read_b64_tr_b16 v[70:71], v1 offset:1664
    v_mfma_f32_16x16x32_bf16 v[160:163], v[72:75], v[24:27], v[160:163]
    v_mfma_f32_16x16x32_bf16 v[204:207], v[72:75], v[28:31], v[204:207]
    v_mfma_f32_16x16x32_bf16 v[248:251], v[72:75], v[32:35], v[248:251]
    ds_read_b64_tr_b16 v[72:73], v1 offset:288
    v_mfma_f32_16x16x32_bf16 v[120:123], v[76:79], v[20:23], v[120:123]
    ds_read_b64_tr_b16 v[74:75], v1 offset:1696
    v_mfma_f32_16x16x32_bf16 v[164:167], v[76:79], v[24:27], v[164:167]
    v_mfma_f32_16x16x32_bf16 v[208:211], v[76:79], v[28:31], v[208:211]
    v_mfma_f32_16x16x32_bf16 v[252:255], v[76:79], v[32:35], v[252:255]
g1f_mid:
    ds_read_b64_tr_b16 v[76:77], v1 offset:320
    s_waitcnt lgkmcnt(15)
    v_mfma_f32_16x16x32_bf16 v[80:83], v[36:39], v[4:7], v[80:83]
    ds_read_b64_tr_b16 v[78:79], v1 offset:1728
    v_mfma_f32_16x16x32_bf16 v[124:127], v[36:39], v[8:11], v[124:127]
    ds_read_b128 v[20:23], v0 offset:512
    v_mfma_f32_16x16x32_bf16 v[168:171], v[36:39], v[12:15], v[168:171]
    ds_read_b128 v[24:27], v0 offset:2560
    v_mfma_f32_16x16x32_bf16 v[212:215], v[36:39], v[16:19], v[212:215]
    ds_read_b128 v[28:31], v0 offset:4608
    s_waitcnt lgkmcnt(15)
    v_mfma_f32_16x16x32_bf16 v[84:87], v[40:43], v[4:7], v[84:87]
    ds_read_b128 v[32:35], v0 offset:6656
    v_mfma_f32_16x16x32_bf16 v[128:131], v[40:43], v[8:11], v[128:131]
    ds_read_b64_tr_b16 v[36:37], v1 offset:11776
    v_mfma_f32_16x16x32_bf16 v[172:175], v[40:43], v[12:15], v[172:175]
    ds_read_b64_tr_b16 v[38:39], v1 offset:13184
    v_mfma_f32_16x16x32_bf16 v[216:219], v[40:43], v[16:19], v[216:219]
    ds_read_b64_tr_b16 v[40:41], v1 offset:11808
    s_waitcnt lgkmcnt(15)
    v_mfma_f32_16x16x32_bf16 v[88:91], v[44:47], v[4:7], v[88:91]
    ds_read_b64_tr_b16 v[42:43], v1 offset:13216
    v_mfma_f32_16x16x32_bf16 v[132:135], v[44:47], v[8:11], v[132:135]
    s_add_u32 s47, s47, 24576
    s_cmp_ge_u32 s47, 73728
    v_mfma_f32_16x16x32_bf16 v[176:179], v[44:47], v[12:15], v[176:179]
    s_cselect_b32 s47, 0, s47
    s_cselect_b32 s48, 4294918144, s88
    v_mfma_f32_16x16x32_bf16 v[220:223], v[44:47], v[16:19], v[220:223]
    ds_read_b64_tr_b16 v[44:45], v1 offset:11840
    s_waitcnt lgkmcnt(15)
    v_mfma_f32_16x16x32_bf16 v[92:95], v[48:51], v[4:7], v[92:95]
    ds_read_b64_tr_b16 v[46:47], v1 offset:13248
    v_mfma_f32_16x16x32_bf16 v[136:139], v[48:51], v[8:11], v[136:139]
    buffer_load_dword v3, s[64:67], s94 offen lds
    v_mfma_f32_16x16x32_bf16 v[180:183], v[48:51], v[12:15], v[180:183]
    v_mfma_f32_16x16x32_bf16 v[224:227], v[48:51], v[16:19], v[224:227]
    ds_read_b64_tr_b16 v[48:49], v1 offset:11872
    s_waitcnt lgkmcnt(15)
    v_mfma_f32_16x16x32_bf16 v[96:99], v[52:55], v[4:7], v[96:99]
    ds_read_b64_tr_b16 v[50:51], v1 offset:13280
    v_mfma_f32_16x16x32_bf16 v[140:143], v[52:55], v[8:11], v[140:143]
    s_add_u32 s94, s94, 2048
    s_and_b32 s49, s45, 3
    v_mfma_f32_16x16x32_bf16 v[184:187], v[52:55], v[12:15], v[184:187]
    s_cmp_eq_u32 s49, 1
    s_cselect_b64 s[64:65], s[68:69], s[64:65]
    v_mfma_f32_16x16x32_bf16 v[228:231], v[52:55], v[16:19], v[228:231]
    ds_read_b64_tr_b16 v[52:53], v1 offset:11904
    s_waitcnt lgkmcnt(15)
    v_mfma_f32_16x16x32_bf16 v[100:103], v[56:59], v[4:7], v[100:103]
    ds_read_b64_tr_b16 v[54:55], v1 offset:13312
    v_mfma_f32_16x16x32_bf16 v[144:147], v[56:59], v[8:11], v[144:147]
    s_cselect_b64 s[68:69], s[70:71], s[68:69]
    s_cselect_b32 s66, s72, s66
    v_mfma_f32_16x16x32_bf16 v[188:191], v[56:59], v[12:15], v[188:191]
    s_cselect_b32 s72, s73, s72
    s_cselect_b32 s73, 0, s73
    v_mfma_f32_16x16x32_bf16 v[232:235], v[56:59], v[16:19], v[232:235]
    ds_read_b64_tr_b16 v[56:57], v1 offset:11936
    s_waitcnt lgkmcnt(15)
    v_mfma_f32_16x16x32_bf16 v[104:107], v[60:63], v[4:7], v[104:107]
    ds_read_b64_tr_b16 v[58:59], v1 offset:13344
    v_mfma_f32_16x16x32_bf16 v[148:151], v[60:63], v[8:11], v[148:151]
    s_cselect_b32 s94, s74, s94
    v_mfma_f32_16x16x32_bf16 v[192:195], v[60:63], v[12:15], v[192:195]
    v_mfma_f32_16x16x32_bf16 v[236:239], v[60:63], v[16:19], v[236:239]
    ds_read_b64_tr_b16 v[60:61], v1 offset:11968
    s_waitcnt lgkmcnt(15)
    v_mfma_f32_16x16x32_bf16 v[108:111], v[64:67], v[4:7], v[108:111]
    ds_read_b64_tr_b16 v[62:63], v1 offset:13376
    v_mfma_f32_16x16x32_bf16 v[152:155], v[64:67], v[8:11], v[152:155]
    v_mfma_f32_16x16x32_bf16 v[196:199], v[64:67], v[12:15], v[196:199]
    v_mfma_f32_16x16x32_bf16 v[240:243], v[64:67], v[16:19], v[240:243]
    ds_read_b64_tr_b16 v[64:65], v1 offset:12000
    s_waitcnt lgkmcnt(15)
    v_mfma_f32_16x16x32_bf16 v[112:115], v[68:71], v[4:7], v[112:115]
    ds_read_b64_tr_b16 v[66:67], v1 offset:13408
    v_mfma_f32_16x16x32_bf16 v[156:159], v[68:71], v[8:11], v[156:159]
    v_mfma_f32_16x16x32_bf16 v[200:203], v[68:71], v[12:15], v[200:203]
    v_mfma_f32_16x16x32_bf16 v[244:247], v[68:71], v[16:19], v[244:247]
    ds_read_b64_tr_b16 v[68:69], v1 offset:12032
    s_waitcnt lgkmcnt(15)
    v_mfma_f32_16x16x32_bf16 v[116:119], v[72:75], v[4:7], v[116:119]
    ds_read_b64_tr_b16 v[70:71], v1 offset:13440
    v_mfma_f32_16x16x32_bf16 v[160:163], v[72:75], v[8:11], v[160:163]
    v_mfma_f32_16x16x32_bf16 v[204:207], v[72:75], v[12:15], v[204:207]
    v_mfma_f32_16x16x32_bf16 v[248:251], v[72:75], v[16:19], v[248:251]
    ds_read_b64_tr_b16 v[72:73], v1 offset:12064
    s_waitcnt lgkmcnt(15)
    v_mfma_f32_16x16x32_bf16 v[120:123], v[76:79], v[4:7], v[120:123]
    ds_read_b64_tr_b16 v[74:75], v1 offset:13472
    v_mfma_f32_16x16x32_bf16 v[164:167], v[76:79], v[8:11], v[164:167]
    v_mfma_f32_16x16x32_bf16 v[208:211], v[76:79], v[12:15], v[208:211]
    v_mfma_f32_16x16x32_bf16 v[252:255], v[76:79], v[16:19], v[252:255]
    ds_read_b64_tr_b16 v[76:77], v1 offset:12096
    s_waitcnt lgkmcnt(15)
    v_mfma_f32_16x16x32_bf16 v[80:83], v[36:39], v[20:23], v[80:83]
    ds_read_b64_tr_b16 v[78:79], v1 offset:13504
    v_mfma_f32_16x16x32_bf16 v[124:127], v[36:39], v[24:27], v[124:127]
    v_mfma_f32_16x16x32_bf16 v[168:171], v[36:39], v[28:31], v[168:171]
    v_mfma_f32_16x16x32_bf16 v[212:215], v[36:39], v[32:35], v[212:215]
    s_waitcnt lgkmcnt(15)
    v_mfma_f32_16x16x32_bf16 v[84:87], v[40:43], v[20:23], v[84:87]
    v_mfma_f32_16x16x32_bf16 v[128:131], v[40:43], v[24:27], v[128:131]
    v_mfma_f32_16x16x32_bf16 v[172:175], v[40:43], v[28:31], v[172:175]
    v_mfma_f32_16x16x32_bf16 v[216:219], v[40:43], v[32:35], v[216:219]
    s_waitcnt lgkmcnt(0)
    s_barrier
    v_mfma_f32_16x16x32_bf16 v[88:91], v[44:47], v[20:23], v[88:91]
    v_xor_b32 v0, 0x8000, v0
    v_add_u32 v1, s48, v1
    v_mfma_f32_16x16x32_bf16 v[132:135], v[44:47], v[24:27], v[132:135]
    ds_read_b128 v[4:7], v0 offset:0
    v_mfma_f32_16x16x32_bf16 v[176:179], v[44:47], v[28:31], v[176:179]
    ds_read_b128 v[8:11], v0 offset:2048
    v_mfma_f32_16x16x32_bf16 v[220:223], v[44:47], v[32:35], v[220:223]
    ds_read_b128 v[12:15], v0 offset:4096
    v_mfma_f32_16x16x32_bf16 v[92:95], v[48:51], v[20:23], v[92:95]
    s_sub_u32 s45, s45, 1
    s_cmp_lg_u32 s45, 0
    v_mfma_f32_16x16x32_bf16 v[136:139], v[48:51], v[24:27], v[136:139]
    s_cbranch_scc1 g1f_top
    v_mfma_f32_16x16x32_bf16 v[180:183], v[48:51], v[28:31], v[180:183]
    v_mfma_f32_16x16x32_bf16 v[224:227], v[48:51], v[32:35], v[224:227]
    v_mfma_f32_16x16x32_bf16 v[96:99], v[52:55], v[20:23], v[96:99]
    v_mfma_f32_16x16x32_bf16 v[140:143], v[52:55], v[24:27], v[140:143]
    v_mfma_f32_16x16x32_bf16 v[184:187], v[52:55], v[28:31], v[184:187]
    v_mfma_f32_16x16x32_bf16 v[228:231], v[52:55], v[32:35], v[228:231]
    v_mfma_f32_16x16x32_bf16 v[100:103], v[56:59], v[20:23], v[100:103]
    v_mfma_f32_16x16x32_bf16 v[144:147], v[56:59], v[24:27], v[144:147]
    v_mfma_f32_16x16x32_bf16 v[188:191], v[56:59], v[28:31], v[188:191]
    v_mfma_f32_16x16x32_bf16 v[232:235], v[56:59], v[32:35], v[232:235]
    v_mfma_f32_16x16x32_bf16 v[104:107], v[60:63], v[20:23], v[104:107]
    v_mfma_f32_16x16x32_bf16 v[148:151], v[60:63], v[24:27], v[148:151]
    v_mfma_f32_16x16x32_bf16 v[192:195], v[60:63], v[28:31], v[192:195]
    v_mfma_f32_16x16x32_bf16 v[236:239], v[60:63], v[32:35], v[236:239]
    v_mfma_f32_16x16x32_bf16 v[108:111], v[64:67], v[20:23], v[108:111]
    v_mfma_f32_16x16x32_bf16 v[152:155], v[64:67], v[24:27], v[152:155]
    v_mfma_f32_16x16x32_bf16 v[196:199], v[64:67], v[28:31], v[196:199]
    v_mfma_f32_16x16x32_bf16 v[240:243], v[64:67], v[32:35], v[240:243]
    v_mfma_f32_16x16x32_bf16 v[112:115], v[68:71], v[20:23], v[112:115]
    v_mfma_f32_16x16x32_bf16 v[156:159], v[68:71], v[24:27], v[156:159]
    v_mfma_f32_16x16x32_bf16 v[200:203], v[68:71], v[28:31], v[200:203]
    v_mfma_f32_16x16x32_bf16 v[244:247], v[68:71], v[32:35], v[244:247]
    v_mfma_f32_16x16x32_bf16 v[116:119], v[72:75], v[20:23], v[116:119]
    v_mfma_f32_16x16x32_bf16 v[160:163], v[72:75], v[24:27], v[160:163]
    v_mfma_f32_16x16x32_bf16 v[204:207], v[72:75], v[28:31], v[204:207]
    v_mfma_f32_16x16x32_bf16 v[248:251], v[72:75], v[32:35], v[248:251]
    v_mfma_f32_16x16x32_bf16 v[120:123], v[76:79], v[20:23], v[120:123]
    v_mfma_f32_16x16x32_bf16 v[164:167], v[76:79], v[24:27], v[164:167]
    v_mfma_f32_16x16x32_bf16 v[208:211], v[76:79], v[28:31], v[208:211]
    v_mfma_f32_16x16x32_bf16 v[252:255], v[76:79], v[32:35], v[252:255]
    s_waitcnt lgkmcnt(0)
    s_nop 7
    s_nop 7
    v_mbcnt_lo_u32_b32 v1, -1, 0
    v_mbcnt_hi_u32_b32 v1, -1, v1
    v_and_b32 v2, 15, v1
    v_lshrrev_b32 v3, 4, v1
    v_and_b32 v4, 1, v3
    v_lshlrev_b32 v4, 5, v4
    v_lshrrev_b32 v5, 1, v3
    v_lshl_add_u32 v4, v5, 4, v4
    v_lshl_add_u32 v4, v2, 6, v4
    s_lshl_b32 s49, s3, 6
    s_add_u32 s49, s49, s40
    s_lshr_b32 s36, s40, 6
    s_lshl_b32 s34, s41, 7
    s_add_u32 s34, s34, s36
    s_add_u32 s34, s34, 1024
    s_lshr_b32 s35, s40, 1
    s_lshl_b32 s37, s41, 2
    s_add_u32 s35, s35, s37
    s_add_u32 s35, s35, 4096
    s_add_u32 s12, s28, 14680064
    s_addc_u32 s13, s29, 0
    s_mov_b32 s14, 15990784
    s_mov_b32 s15, 0x20000
    s_mov_b32 s16, s26
    s_mov_b32 s17, s27
    s_mov_b32 s18, 7168
    s_mov_b32 s19, 0x20000
    s_mul_i32 s50, s41, 352
    s_sub_u32 s50, s50, 4096
    v_lshlrev_b32 v7, 3, v3
    v_add_u32 v7, s50, v7
    buffer_load_dwordx2 v[64:65], v7, s[16:19], 0 offen offset:0
    buffer_load_dwordx2 v[66:67], v7, s[16:19], 0 offen offset:32
    buffer_load_dwordx2 v[68:69], v7, s[16:19], 0 offen offset:64
    buffer_load_dwordx2 v[70:71], v7, s[16:19], 0 offen offset:96
    buffer_load_dwordx2 v[72:73], v7, s[16:19], 0 offen offset:128
    buffer_load_dwordx2 v[74:75], v7, s[16:19], 0 offen offset:160
    buffer_load_dwordx2 v[76:77], v7, s[16:19], 0 offen offset:192
    buffer_load_dwordx2 v[78:79], v7, s[16:19], 0 offen offset:224
    s_lshr_b32 s51, s49, 4
    s_mul_i32 s51, s51, 124928
    s_mul_i32 s47, s41, 6144
    s_sub_u32 s47, s47, 71680
    s_add_u32 s51, s51, s47
    v_add_u32 v6, s51, v4
    v_mov_b32 v10, 0xc0135761
    v_mov_b32 v11, 0xc0135761
    v_mov_b32 v12, 0xbdd2d3e8
    v_mov_b32 v13, 0xbdd2d3e8
    v_mov_b32 v14, 1.0
    v_mov_b32 v15, 1.0
    s_waitcnt vmcnt(4)
    v_lshlrev_b32 v48, 16, v64
    v_and_b32 v49, 0xffff0000, v64
    v_lshlrev_b32 v50, 16, v65
    v_and_b32 v51, 0xffff0000, v65
    v_lshlrev_b32 v52, 16, v66
    v_and_b32 v53, 0xffff0000, v66
    v_lshlrev_b32 v54, 16, v67
    v_and_b32 v55, 0xffff0000, v67
    v_lshlrev_b32 v56, 16, v68
    v_and_b32 v57, 0xffff0000, v68
    v_lshlrev_b32 v58, 16, v69
    v_and_b32 v59, 0xffff0000, v69
    v_lshlrev_b32 v60, 16, v70
    v_and_b32 v61, 0xffff0000, v70
    v_lshlrev_b32 v62, 16, v71
    v_and_b32 v63, 0xffff0000, v71
    buffer_load_dwordx2 v[64:65], v7, s[16:19], 0 offen offset:256
    buffer_load_dwordx2 v[66:67], v7, s[16:19], 0 offen offset:288
    buffer_load_dwordx2 v[68:69], v7, s[16:19], 0 offen offset:320
    v_pk_add_f32 v[80:81], v[80:81], v[48:49]
    v_pk_add_f32 v[82:83], v[82:83], v[50:51]
    v_pk_add_f32 v[84:85], v[84:85], v[52:53]
    v_pk_add_f32 v[86:87], v[86:87], v[54:55]
    v_pk_add_f32 v[88:89], v[88:89], v[56:57]
    v_pk_add_f32 v[90:91], v[90:91], v[58:59]
    v_pk_add_f32 v[92:93], v[92:93], v[60:61]
    v_pk_add_f32 v[94:95], v[94:95], v[62:63]
    v_pk_mul_f32 v[16:17], v[80:81], v[80:81]
    v_pk_mul_f32 v[18:19], v[82:83], v[82:83]
    v_pk_mul_f32 v[20:21], v[84:85], v[84:85]
    v_pk_mul_f32 v[22:23], v[86:87], v[86:87]
    v_pk_mul_f32 v[24:25], v[88:89], v[88:89]
    v_pk_mul_f32 v[26:27], v[90:91], v[90:91]
    v_pk_mul_f32 v[28:29], v[92:93], v[92:93]
    v_pk_mul_f32 v[30:31], v[94:95], v[94:95]
    v_pk_fma_f32 v[16:17], v[16:17], v[12:13], v[10:11]
    v_pk_fma_f32 v[18:19], v[18:19], v[12:13], v[10:11]
    v_pk_fma_f32 v[20:21], v[20:21], v[12:13], v[10:11]
    v_pk_fma_f32 v[22:23], v[22:23], v[12:13], v[10:11]
    v_pk_fma_f32 v[24:25], v[24:25], v[12:13], v[10:11]
    v_pk_fma_f32 v[26:27], v[26:27], v[12:13], v[10:11]
    v_pk_fma_f32 v[28:29], v[28:29], v[12:13], v[10:11]
    v_pk_fma_f32 v[30:31], v[30:31], v[12:13], v[10:11]
    v_pk_mul_f32 v[16:17], v[16:17], v[80:81]
    v_pk_mul_f32 v[18:19], v[18:19], v[82:83]
    v_pk_mul_f32 v[20:21], v[20:21], v[84:85]
    v_pk_mul_f32 v[22:23], v[22:23], v[86:87]
    v_pk_mul_f32 v[24:25], v[24:25], v[88:89]
    v_pk_mul_f32 v[26:27], v[26:27], v[90:91]
    v_pk_mul_f32 v[28:29], v[28:29], v[92:93]
    v_pk_mul_f32 v[30:31], v[30:31], v[94:95]
    v_exp_f32 v16, v16
    v_exp_f32 v17, v17
    v_exp_f32 v18, v18
    v_exp_f32 v19, v19
    v_exp_f32 v20, v20
    v_exp_f32 v21, v21
    v_exp_f32 v22, v22
    v_exp_f32 v23, v23
    v_exp_f32 v24, v24
    v_exp_f32 v25, v25
    v_exp_f32 v26, v26
    v_exp_f32 v27, v27
    v_exp_f32 v28, v28
    v_exp_f32 v29, v29
    v_exp_f32 v30, v30
    v_exp_f32 v31, v31
    v_pk_add_f32 v[16:17], v[16:17], v[14:15]
    v_pk_add_f32 v[18:19], v[18:19], v[14:15]
    v_pk_add_f32 v[20:21], v[20:21], v[14:15]
    v_pk_add_f32 v[22:23], v[22:23], v[14:15]
    v_pk_add_f32 v[24:25], v[24:25], v[14:15]
    v_pk_add_f32 v[26:27], v[26:27], v[14:15]
    v_pk_add_f32 v[28:29], v[28:29], v[14:15]
    v_pk_add_f32 v[30:31], v[30:31], v[14:15]
    v_rcp_f32 v16, v16
    v_rcp_f32 v17, v17
    v_rcp_f32 v18, v18
    v_rcp_f32 v19, v19
    v_rcp_f32 v20, v20
    v_rcp_f32 v21, v21
    v_rcp_f32 v22, v22
    v_rcp_f32 v23, v23
    v_rcp_f32 v24, v24
    v_rcp_f32 v25, v25
    v_rcp_f32 v26, v26
    v_rcp_f32 v27, v27
    v_rcp_f32 v28, v28
    v_rcp_f32 v29, v29
    v_rcp_f32 v30, v30
    v_rcp_f32 v31, v31
    v_pk_mul_f32 v[80:81], v[80:81], v[16:17]
    v_pk_mul_f32 v[82:83], v[82:83], v[18:19]
    v_pk_mul_f32 v[84:85], v[84:85], v[20:21]
    v_pk_mul_f32 v[86:87], v[86:87], v[22:23]
    v_pk_mul_f32 v[88:89], v[88:89], v[24:25]
    v_pk_mul_f32 v[90:91], v[90:91], v[26:27]
    v_pk_mul_f32 v[92:93], v[92:93], v[28:29]
    v_pk_mul_f32 v[94:95], v[94:95], v[30:31]
    v_cvt_pk_bf16_f32 v16, v80, v81
    v_cvt_pk_bf16_f32 v17, v82, v83
    v_cvt_pk_bf16_f32 v18, v84, v85
    v_cvt_pk_bf16_f32 v19, v86, v87
    v_cvt_pk_bf16_f32 v20, v88, v89
    v_cvt_pk_bf16_f32 v21, v90, v91
    v_cvt_pk_bf16_f32 v22, v92, v93
    v_cvt_pk_bf16_f32 v23, v94, v95
    s_mov_b32 s51, 0
    s_nop 0
    v_permlane16_swap_b32 v16, v18
    v_permlane16_swap_b32 v17, v19
    v_permlane16_swap_b32 v20, v22
    v_permlane16_swap_b32 v21, v23
    buffer_store_dwordx4 v[16:19], v6, s[12:15], s51 offen sc1
    buffer_store_dwordx4 v[20:23], v6, s[12:15], s51 offen offset:1024 sc1
    v_pk_add_f32 v[124:125], v[124:125], v[48:49]
    v_pk_add_f32 v[126:127], v[126:127], v[50:51]
    v_pk_add_f32 v[128:129], v[128:129], v[52:53]
    v_pk_add_f32 v[130:131], v[130:131], v[54:55]
    v_pk_add_f32 v[132:133], v[132:133], v[56:57]
    v_pk_add_f32 v[134:135], v[134:135], v[58:59]
    v_pk_add_f32 v[136:137], v[136:137], v[60:61]
    v_pk_add_f32 v[138:139], v[138:139], v[62:63]
    v_pk_mul_f32 v[32:33], v[124:125], v[124:125]
    v_pk_mul_f32 v[34:35], v[126:127], v[126:127]
    v_pk_mul_f32 v[36:37], v[128:129], v[128:129]
    v_pk_mul_f32 v[38:39], v[130:131], v[130:131]
    v_pk_mul_f32 v[40:41], v[132:133], v[132:133]
    v_pk_mul_f32 v[42:43], v[134:135], v[134:135]
    v_pk_mul_f32 v[44:45], v[136:137], v[136:137]
    v_pk_mul_f32 v[46:47], v[138:139], v[138:139]
    v_pk_fma_f32 v[32:33], v[32:33], v[12:13], v[10:11]
    v_pk_fma_f32 v[34:35], v[34:35], v[12:13], v[10:11]
    v_pk_fma_f32 v[36:37], v[36:37], v[12:13], v[10:11]
    v_pk_fma_f32 v[38:39], v[38:39], v[12:13], v[10:11]
    v_pk_fma_f32 v[40:41], v[40:41], v[12:13], v[10:11]
    v_pk_fma_f32 v[42:43], v[42:43], v[12:13], v[10:11]
    v_pk_fma_f32 v[44:45], v[44:45], v[12:13], v[10:11]
    v_pk_fma_f32 v[46:47], v[46:47], v[12:13], v[10:11]
    v_pk_mul_f32 v[32:33], v[32:33], v[124:125]
    v_pk_mul_f32 v[34:35], v[34:35], v[126:127]
    v_pk_mul_f32 v[36:37], v[36:37], v[128:129]
    v_pk_mul_f32 v[38:39], v[38:39], v[130:131]
    v_pk_mul_f32 v[40:41], v[40:41], v[132:133]
    v_pk_mul_f32 v[42:43], v[42:43], v[134:135]
    v_pk_mul_f32 v[44:45], v[44:45], v[136:137]
    v_pk_mul_f32 v[46:47], v[46:47], v[138:139]
    v_exp_f32 v32, v32
    v_exp_f32 v33, v33
    v_exp_f32 v34, v34
    v_exp_f32 v35, v35
    v_exp_f32 v36, v36
    v_exp_f32 v37, v37
    v_exp_f32 v38, v38
    v_exp_f32 v39, v39
    v_exp_f32 v40, v40
    v_exp_f32 v41, v41
    v_exp_f32 v42, v42
    v_exp_f32 v43, v43
    v_exp_f32 v44, v44
    v_exp_f32 v45, v45
    v_exp_f32 v46, v46
    v_exp_f32 v47, v47
    v_pk_add_f32 v[32:33], v[32:33], v[14:15]
    v_pk_add_f32 v[34:35], v[34:35], v[14:15]
    v_pk_add_f32 v[36:37], v[36:37], v[14:15]
    v_pk_add_f32 v[38:39], v[38:39], v[14:15]
    v_pk_add_f32 v[40:41], v[40:41], v[14:15]
    v_pk_add_f32 v[42:43], v[42:43], v[14:15]
    v_pk_add_f32 v[44:45], v[44:45], v[14:15]
    v_pk_add_f32 v[46:47], v[46:47], v[14:15]
    v_rcp_f32 v32, v32
    v_rcp_f32 v33, v33
    v_rcp_f32 v34, v34
    v_rcp_f32 v35, v35
    v_rcp_f32 v36, v36
    v_rcp_f32 v37, v37
    v_rcp_f32 v38, v38
    v_rcp_f32 v39, v39
    v_rcp_f32 v40, v40
    v_rcp_f32 v41, v41
    v_rcp_f32 v42, v42
    v_rcp_f32 v43, v43
    v_rcp_f32 v44, v44
    v_rcp_f32 v45, v45
    v_rcp_f32 v46, v46
    v_rcp_f32 v47, v47
    v_pk_mul_f32 v[124:125], v[124:125], v[32:33]
    v_pk_mul_f32 v[126:127], v[126:127], v[34:35]
    v_pk_mul_f32 v[128:129], v[128:129], v[36:37]
    v_pk_mul_f32 v[130:131], v[130:131], v[38:39]
    v_pk_mul_f32 v[132:133], v[132:133], v[40:41]
    v_pk_mul_f32 v[134:135], v[134:135], v[42:43]
    v_pk_mul_f32 v[136:137], v[136:137], v[44:45]
    v_pk_mul_f32 v[138:139], v[138:139], v[46:47]
    v_cvt_pk_bf16_f32 v32, v124, v125
    v_cvt_pk_bf16_f32 v33, v126, v127
    v_cvt_pk_bf16_f32 v34, v128, v129
    v_cvt_pk_bf16_f32 v35, v130, v131
    v_cvt_pk_bf16_f32 v36, v132, v133
    v_cvt_pk_bf16_f32 v37, v134, v135
    v_cvt_pk_bf16_f32 v38, v136, v137
    v_cvt_pk_bf16_f32 v39, v138, v139
    s_mov_b32 s51, 124928
    s_nop 0
    v_permlane16_swap_b32 v32, v34
    v_permlane16_swap_b32 v33, v35
    v_permlane16_swap_b32 v36, v38
    v_permlane16_swap_b32 v37, v39
    buffer_store_dwordx4 v[32:35], v6, s[12:15], s51 offen sc1
    buffer_store_dwordx4 v[36:39], v6, s[12:15], s51 offen offset:1024 sc1
    v_pk_add_f32 v[168:169], v[168:169], v[48:49]
    v_pk_add_f32 v[170:171], v[170:171], v[50:51]
    v_pk_add_f32 v[172:173], v[172:173], v[52:53]
    v_pk_add_f32 v[174:175], v[174:175], v[54:55]
    v_pk_add_f32 v[176:177], v[176:177], v[56:57]
    v_pk_add_f32 v[178:179], v[178:179], v[58:59]
    v_pk_add_f32 v[180:181], v[180:181], v[60:61]
    v_pk_add_f32 v[182:183], v[182:183], v[62:63]
    v_pk_mul_f32 v[16:17], v[168:169], v[168:169]
    v_pk_mul_f32 v[18:19], v[170:171], v[170:171]
    v_pk_mul_f32 v[20:21], v[172:173], v[172:173]
    v_pk_mul_f32 v[22:23], v[174:175], v[174:175]
    v_pk_mul_f32 v[24:25], v[176:177], v[176:177]
    v_pk_mul_f32 v[26:27], v[178:179], v[178:179]
    v_pk_mul_f32 v[28:29], v[180:181], v[180:181]
    v_pk_mul_f32 v[30:31], v[182:183], v[182:183]
    v_pk_fma_f32 v[16:17], v[16:17], v[12:13], v[10:11]
    v_pk_fma_f32 v[18:19], v[18:19], v[12:13], v[10:11]
    v_pk_fma_f32 v[20:21], v[20:21], v[12:13], v[10:11]
    v_pk_fma_f32 v[22:23], v[22:23], v[12:13], v[10:11]
    v_pk_fma_f32 v[24:25], v[24:25], v[12:13], v[10:11]
    v_pk_fma_f32 v[26:27], v[26:27], v[12:13], v[10:11]
    v_pk_fma_f32 v[28:29], v[28:29], v[12:13], v[10:11]
    v_pk_fma_f32 v[30:31], v[30:31], v[12:13], v[10:11]
    v_pk_mul_f32 v[16:17], v[16:17], v[168:169]
    v_pk_mul_f32 v[18:19], v[18:19], v[170:171]
    v_pk_mul_f32 v[20:21], v[20:21], v[172:173]
    v_pk_mul_f32 v[22:23], v[22:23], v[174:175]
    v_pk_mul_f32 v[24:25], v[24:25], v[176:177]
    v_pk_mul_f32 v[26:27], v[26:27], v[178:179]
    v_pk_mul_f32 v[28:29], v[28:29], v[180:181]
    v_pk_mul_f32 v[30:31], v[30:31], v[182:183]
    v_exp_f32 v16, v16
    v_exp_f32 v17, v17
    v_exp_f32 v18, v18
    v_exp_f32 v19, v19
    v_exp_f32 v20, v20
    v_exp_f32 v21, v21
    v_exp_f32 v22, v22
    v_exp_f32 v23, v23
    v_exp_f32 v24, v24
    v_exp_f32 v25, v25
    v_exp_f32 v26, v26
    v_exp_f32 v27, v27
    v_exp_f32 v28, v28
    v_exp_f32 v29, v29
    v_exp_f32 v30, v30
    v_exp_f32 v31, v31
    v_pk_add_f32 v[16:17], v[16:17], v[14:15]
    v_pk_add_f32 v[18:19], v[18:19], v[14:15]
    v_pk_add_f32 v[20:21], v[20:21], v[14:15]
    v_pk_add_f32 v[22:23], v[22:23], v[14:15]
    v_pk_add_f32 v[24:25], v[24:25], v[14:15]
    v_pk_add_f32 v[26:27], v[26:27], v[14:15]
    v_pk_add_f32 v[28:29], v[28:29], v[14:15]
    v_pk_add_f32 v[30:31], v[30:31], v[14:15]
    v_rcp_f32 v16, v16
    v_rcp_f32 v17, v17
    v_rcp_f32 v18, v18
    v_rcp_f32 v19, v19
    v_rcp_f32 v20, v20
    v_rcp_f32 v21, v21
    v_rcp_f32 v22, v22
    v_rcp_f32 v23, v23
    v_rcp_f32 v24, v24
    v_rcp_f32 v25, v25
    v_rcp_f32 v26, v26
    v_rcp_f32 v27, v27
    v_rcp_f32 v28, v28
    v_rcp_f32 v29, v29
    v_rcp_f32 v30, v30
    v_rcp_f32 v31, v31
    v_pk_mul_f32 v[168:169], v[168:169], v[16:17]
    v_pk_mul_f32 v[170:171], v[170:171], v[18:19]
    v_pk_mul_f32 v[172:173], v[172:173], v[20:21]
    v_pk_mul_f32 v[174:175], v[174:175], v[22:23]
    v_pk_mul_f32 v[176:177], v[176:177], v[24:25]
    v_pk_mul_f32 v[178:179], v[178:179], v[26:27]
    v_pk_mul_f32 v[180:181], v[180:181], v[28:29]
    v_pk_mul_f32 v[182:183], v[182:183], v[30:31]
    v_cvt_pk_bf16_f32 v16, v168, v169
    v_cvt_pk_bf16_f32 v17, v170, v171
    v_cvt_pk_bf16_f32 v18, v172, v173
    v_cvt_pk_bf16_f32 v19, v174, v175
    v_cvt_pk_bf16_f32 v20, v176, v177
    v_cvt_pk_bf16_f32 v21, v178, v179
    v_cvt_pk_bf16_f32 v22, v180, v181
    v_cvt_pk_bf16_f32 v23, v182, v183
    s_mov_b32 s51, 249856
    s_nop 0
    v_permlane16_swap_b32 v16, v18
    v_permlane16_swap_b32 v17, v19
    v_permlane16_swap_b32 v20, v22
    v_permlane16_swap_b32 v21, v23
    buffer_store_dwordx4 v[16:19], v6, s[12:15], s51 offen sc1
    buffer_store_dwordx4 v[20:23], v6, s[12:15], s51 offen offset:1024 sc1
    v_pk_add_f32 v[212:213], v[212:213], v[48:49]
    v_pk_add_f32 v[214:215], v[214:215], v[50:51]
    v_pk_add_f32 v[216:217], v[216:217], v[52:53]
    v_pk_add_f32 v[218:219], v[218:219], v[54:55]
    v_pk_add_f32 v[220:221], v[220:221], v[56:57]
    v_pk_add_f32 v[222:223], v[222:223], v[58:59]
    v_pk_add_f32 v[224:225], v[224:225], v[60:61]
    v_pk_add_f32 v[226:227], v[226:227], v[62:63]
    v_pk_mul_f32 v[32:33], v[212:213], v[212:213]
    v_pk_mul_f32 v[34:35], v[214:215], v[214:215]
    v_pk_mul_f32 v[36:37], v[216:217], v[216:217]
    v_pk_mul_f32 v[38:39], v[218:219], v[218:219]
    v_pk_mul_f32 v[40:41], v[220:221], v[220:221]
    v_pk_mul_f32 v[42:43], v[222:223], v[222:223]
    v_pk_mul_f32 v[44:45], v[224:225], v[224:225]
    v_pk_mul_f32 v[46:47], v[226:227], v[226:227]
    v_pk_fma_f32 v[32:33], v[32:33], v[12:13], v[10:11]
    v_pk_fma_f32 v[34:35], v[34:35], v[12:13], v[10:11]
    v_pk_fma_f32 v[36:37], v[36:37], v[12:13], v[10:11]
    v_pk_fma_f32 v[38:39], v[38:39], v[12:13], v[10:11]
    v_pk_fma_f32 v[40:41], v[40:41], v[12:13], v[10:11]
    v_pk_fma_f32 v[42:43], v[42:43], v[12:13], v[10:11]
    v_pk_fma_f32 v[44:45], v[44:45], v[12:13], v[10:11]
    v_pk_fma_f32 v[46:47], v[46:47], v[12:13], v[10:11]
    v_pk_mul_f32 v[32:33], v[32:33], v[212:213]
    v_pk_mul_f32 v[34:35], v[34:35], v[214:215]
    v_pk_mul_f32 v[36:37], v[36:37], v[216:217]
    v_pk_mul_f32 v[38:39], v[38:39], v[218:219]
    v_pk_mul_f32 v[40:41], v[40:41], v[220:221]
    v_pk_mul_f32 v[42:43], v[42:43], v[222:223]
    v_pk_mul_f32 v[44:45], v[44:45], v[224:225]
    v_pk_mul_f32 v[46:47], v[46:47], v[226:227]
    v_exp_f32 v32, v32
    v_exp_f32 v33, v33
    v_exp_f32 v34, v34
    v_exp_f32 v35, v35
    v_exp_f32 v36, v36
    v_exp_f32 v37, v37
    v_exp_f32 v38, v38
    v_exp_f32 v39, v39
    v_exp_f32 v40, v40
    v_exp_f32 v41, v41
    v_exp_f32 v42, v42
    v_exp_f32 v43, v43
    v_exp_f32 v44, v44
    v_exp_f32 v45, v45
    v_exp_f32 v46, v46
    v_exp_f32 v47, v47
    v_pk_add_f32 v[32:33], v[32:33], v[14:15]
    v_pk_add_f32 v[34:35], v[34:35], v[14:15]
    v_pk_add_f32 v[36:37], v[36:37], v[14:15]
    v_pk_add_f32 v[38:39], v[38:39], v[14:15]
    v_pk_add_f32 v[40:41], v[40:41], v[14:15]
    v_pk_add_f32 v[42:43], v[42:43], v[14:15]
    v_pk_add_f32 v[44:45], v[44:45], v[14:15]
    v_pk_add_f32 v[46:47], v[46:47], v[14:15]
    v_rcp_f32 v32, v32
    v_rcp_f32 v33, v33
    v_rcp_f32 v34, v34
    v_rcp_f32 v35, v35
    v_rcp_f32 v36, v36
    v_rcp_f32 v37, v37
    v_rcp_f32 v38, v38
    v_rcp_f32 v39, v39
    v_rcp_f32 v40, v40
    v_rcp_f32 v41, v41
    v_rcp_f32 v42, v42
    v_rcp_f32 v43, v43
    v_rcp_f32 v44, v44
    v_rcp_f32 v45, v45
    v_rcp_f32 v46, v46
    v_rcp_f32 v47, v47
    v_pk_mul_f32 v[212:213], v[212:213], v[32:33]
    v_pk_mul_f32 v[214:215], v[214:215], v[34:35]
    v_pk_mul_f32 v[216:217], v[216:217], v[36:37]
    v_pk_mul_f32 v[218:219], v[218:219], v[38:39]
    v_pk_mul_f32 v[220:221], v[220:221], v[40:41]
    v_pk_mul_f32 v[222:223], v[222:223], v[42:43]
    v_pk_mul_f32 v[224:225], v[224:225], v[44:45]
    v_pk_mul_f32 v[226:227], v[226:227], v[46:47]
    v_cvt_pk_bf16_f32 v32, v212, v213
    v_cvt_pk_bf16_f32 v33, v214, v215
    v_cvt_pk_bf16_f32 v34, v216, v217
    v_cvt_pk_bf16_f32 v35, v218, v219
    v_cvt_pk_bf16_f32 v36, v220, v221
    v_cvt_pk_bf16_f32 v37, v222, v223
    v_cvt_pk_bf16_f32 v38, v224, v225
    v_cvt_pk_bf16_f32 v39, v226, v227
    s_mov_b32 s51, 374784
    s_nop 0
    v_permlane16_swap_b32 v32, v34
    v_permlane16_swap_b32 v33, v35
    v_permlane16_swap_b32 v36, v38
    v_permlane16_swap_b32 v37, v39
    buffer_store_dwordx4 v[32:35], v6, s[12:15], s51 offen sc1
    buffer_store_dwordx4 v[36:39], v6, s[12:15], s51 offen offset:1024 sc1
    s_waitcnt vmcnt(11)
    v_lshlrev_b32 v48, 16, v72
    v_and_b32 v49, 0xffff0000, v72
    v_lshlrev_b32 v50, 16, v73
    v_and_b32 v51, 0xffff0000, v73
    v_lshlrev_b32 v52, 16, v74
    v_and_b32 v53, 0xffff0000, v74
    v_lshlrev_b32 v54, 16, v75
    v_and_b32 v55, 0xffff0000, v75
    v_lshlrev_b32 v56, 16, v76
    v_and_b32 v57, 0xffff0000, v76
    v_lshlrev_b32 v58, 16, v77
    v_and_b32 v59, 0xffff0000, v77
    v_lshlrev_b32 v60, 16, v78
    v_and_b32 v61, 0xffff0000, v78
    v_lshlrev_b32 v62, 16, v79
    v_and_b32 v63, 0xffff0000, v79
    v_pk_add_f32 v[96:97], v[96:97], v[48:49]
    v_pk_add_f32 v[98:99], v[98:99], v[50:51]
    v_pk_add_f32 v[100:101], v[100:101], v[52:53]
    v_pk_add_f32 v[102:103], v[102:103], v[54:55]
    v_pk_add_f32 v[104:105], v[104:105], v[56:57]
    v_pk_add_f32 v[106:107], v[106:107], v[58:59]
    v_pk_add_f32 v[108:109], v[108:109], v[60:61]
    v_pk_add_f32 v[110:111], v[110:111], v[62:63]
    v_pk_mul_f32 v[16:17], v[96:97], v[96:97]
    v_pk_mul_f32 v[18:19], v[98:99], v[98:99]
    v_pk_mul_f32 v[20:21], v[100:101], v[100:101]
    v_pk_mul_f32 v[22:23], v[102:103], v[102:103]
    v_pk_mul_f32 v[24:25], v[104:105], v[104:105]
    v_pk_mul_f32 v[26:27], v[106:107], v[106:107]
    v_pk_mul_f32 v[28:29], v[108:109], v[108:109]
    v_pk_mul_f32 v[30:31], v[110:111], v[110:111]
    v_pk_fma_f32 v[16:17], v[16:17], v[12:13], v[10:11]
    v_pk_fma_f32 v[18:19], v[18:19], v[12:13], v[10:11]
    v_pk_fma_f32 v[20:21], v[20:21], v[12:13], v[10:11]
    v_pk_fma_f32 v[22:23], v[22:23], v[12:13], v[10:11]
    v_pk_fma_f32 v[24:25], v[24:25], v[12:13], v[10:11]
    v_pk_fma_f32 v[26:27], v[26:27], v[12:13], v[10:11]
    v_pk_fma_f32 v[28:29], v[28:29], v[12:13], v[10:11]
    v_pk_fma_f32 v[30:31], v[30:31], v[12:13], v[10:11]
    v_pk_mul_f32 v[16:17], v[16:17], v[96:97]
    v_pk_mul_f32 v[18:19], v[18:19], v[98:99]
    v_pk_mul_f32 v[20:21], v[20:21], v[100:101]
    v_pk_mul_f32 v[22:23], v[22:23], v[102:103]
    v_pk_mul_f32 v[24:25], v[24:25], v[104:105]
    v_pk_mul_f32 v[26:27], v[26:27], v[106:107]
    v_pk_mul_f32 v[28:29], v[28:29], v[108:109]
    v_pk_mul_f32 v[30:31], v[30:31], v[110:111]
    v_exp_f32 v16, v16
    v_exp_f32 v17, v17
    v_exp_f32 v18, v18
    v_exp_f32 v19, v19
    v_exp_f32 v20, v20
    v_exp_f32 v21, v21
    v_exp_f32 v22, v22
    v_exp_f32 v23, v23
    v_exp_f32 v24, v24
    v_exp_f32 v25, v25
    v_exp_f32 v26, v26
    v_exp_f32 v27, v27
    v_exp_f32 v28, v28
    v_exp_f32 v29, v29
    v_exp_f32 v30, v30
    v_exp_f32 v31, v31
    v_pk_add_f32 v[16:17], v[16:17], v[14:15]
    v_pk_add_f32 v[18:19], v[18:19], v[14:15]
    v_pk_add_f32 v[20:21], v[20:21], v[14:15]
    v_pk_add_f32 v[22:23], v[22:23], v[14:15]
    v_pk_add_f32 v[24:25], v[24:25], v[14:15]
    v_pk_add_f32 v[26:27], v[26:27], v[14:15]
    v_pk_add_f32 v[28:29], v[28:29], v[14:15]
    v_pk_add_f32 v[30:31], v[30:31], v[14:15]
    v_rcp_f32 v16, v16
    v_rcp_f32 v17, v17
    v_rcp_f32 v18, v18
    v_rcp_f32 v19, v19
    v_rcp_f32 v20, v20
    v_rcp_f32 v21, v21
    v_rcp_f32 v22, v22
    v_rcp_f32 v23, v23
    v_rcp_f32 v24, v24
    v_rcp_f32 v25, v25
    v_rcp_f32 v26, v26
    v_rcp_f32 v27, v27
    v_rcp_f32 v28, v28
    v_rcp_f32 v29, v29
    v_rcp_f32 v30, v30
    v_rcp_f32 v31, v31
    v_pk_mul_f32 v[96:97], v[96:97], v[16:17]
    v_pk_mul_f32 v[98:99], v[98:99], v[18:19]
    v_pk_mul_f32 v[100:101], v[100:101], v[20:21]
    v_pk_mul_f32 v[102:103], v[102:103], v[22:23]
    v_pk_mul_f32 v[104:105], v[104:105], v[24:25]
    v_pk_mul_f32 v[106:107], v[106:107], v[26:27]
    v_pk_mul_f32 v[108:109], v[108:109], v[28:29]
    v_pk_mul_f32 v[110:111], v[110:111], v[30:31]
    v_cvt_pk_bf16_f32 v16, v96, v97
    v_cvt_pk_bf16_f32 v17, v98, v99
    v_cvt_pk_bf16_f32 v18, v100, v101
    v_cvt_pk_bf16_f32 v19, v102, v103
    v_cvt_pk_bf16_f32 v20, v104, v105
    v_cvt_pk_bf16_f32 v21, v106, v107
    v_cvt_pk_bf16_f32 v22, v108, v109
    v_cvt_pk_bf16_f32 v23, v110, v111
    s_mov_b32 s51, 2048
    s_nop 0
    v_permlane16_swap_b32 v16, v18
    v_permlane16_swap_b32 v17, v19
    v_permlane16_swap_b32 v20, v22
    v_permlane16_swap_b32 v21, v23
    buffer_store_dwordx4 v[16:19], v6, s[12:15], s51 offen sc1
    buffer_store_dwordx4 v[20:23], v6, s[12:15], s51 offen offset:1024 sc1
    v_pk_add_f32 v[140:141], v[140:141], v[48:49]
    v_pk_add_f32 v[142:143], v[142:143], v[50:51]
    v_pk_add_f32 v[144:145], v[144:145], v[52:53]
    v_pk_add_f32 v[146:147], v[146:147], v[54:55]
    v_pk_add_f32 v[148:149], v[148:149], v[56:57]
    v_pk_add_f32 v[150:151], v[150:151], v[58:59]
    v_pk_add_f32 v[152:153], v[152:153], v[60:61]
    v_pk_add_f32 v[154:155], v[154:155], v[62:63]
    v_pk_mul_f32 v[32:33], v[140:141], v[140:141]
    v_pk_mul_f32 v[34:35], v[142:143], v[142:143]
    v_pk_mul_f32 v[36:37], v[144:145], v[144:145]
    v_pk_mul_f32 v[38:39], v[146:147], v[146:147]
    v_pk_mul_f32 v[40:41], v[148:149], v[148:149]
    v_pk_mul_f32 v[42:43], v[150:151], v[150:151]
    v_pk_mul_f32 v[44:45], v[152:153], v[152:153]
    v_pk_mul_f32 v[46:47], v[154:155], v[154:155]
    v_pk_fma_f32 v[32:33], v[32:33], v[12:13], v[10:11]
    v_pk_fma_f32 v[34:35], v[34:35], v[12:13], v[10:11]
    v_pk_fma_f32 v[36:37], v[36:37], v[12:13], v[10:11]
    v_pk_fma_f32 v[38:39], v[38:39], v[12:13], v[10:11]
    v_pk_fma_f32 v[40:41], v[40:41], v[12:13], v[10:11]
    v_pk_fma_f32 v[42:43], v[42:43], v[12:13], v[10:11]
    v_pk_fma_f32 v[44:45], v[44:45], v[12:13], v[10:11]
    v_pk_fma_f32 v[46:47], v[46:47], v[12:13], v[10:11]
    v_pk_mul_f32 v[32:33], v[32:33], v[140:141]
    v_pk_mul_f32 v[34:35], v[34:35], v[142:143]
    v_pk_mul_f32 v[36:37], v[36:37], v[144:145]
    v_pk_mul_f32 v[38:39], v[38:39], v[146:147]
    v_pk_mul_f32 v[40:41], v[40:41], v[148:149]
    v_pk_mul_f32 v[42:43], v[42:43], v[150:151]
    v_pk_mul_f32 v[44:45], v[44:45], v[152:153]
    v_pk_mul_f32 v[46:47], v[46:47], v[154:155]
    v_exp_f32 v32, v32
    v_exp_f32 v33, v33
    v_exp_f32 v34, v34
    v_exp_f32 v35, v35
    v_exp_f32 v36, v36
    v_exp_f32 v37, v37
    v_exp_f32 v38, v38
    v_exp_f32 v39, v39
    v_exp_f32 v40, v40
    v_exp_f32 v41, v41
    v_exp_f32 v42, v42
    v_exp_f32 v43, v43
    v_exp_f32 v44, v44
    v_exp_f32 v45, v45
    v_exp_f32 v46, v46
    v_exp_f32 v47, v47
    v_pk_add_f32 v[32:33], v[32:33], v[14:15]
    v_pk_add_f32 v[34:35], v[34:35], v[14:15]
    v_pk_add_f32 v[36:37], v[36:37], v[14:15]
    v_pk_add_f32 v[38:39], v[38:39], v[14:15]
    v_pk_add_f32 v[40:41], v[40:41], v[14:15]
    v_pk_add_f32 v[42:43], v[42:43], v[14:15]
    v_pk_add_f32 v[44:45], v[44:45], v[14:15]
    v_pk_add_f32 v[46:47], v[46:47], v[14:15]
    v_rcp_f32 v32, v32
    v_rcp_f32 v33, v33
    v_rcp_f32 v34, v34
    v_rcp_f32 v35, v35
    v_rcp_f32 v36, v36
    v_rcp_f32 v37, v37
    v_rcp_f32 v38, v38
    v_rcp_f32 v39, v39
    v_rcp_f32 v40, v40
    v_rcp_f32 v41, v41
    v_rcp_f32 v42, v42
    v_rcp_f32 v43, v43
    v_rcp_f32 v44, v44
    v_rcp_f32 v45, v45
    v_rcp_f32 v46, v46
    v_rcp_f32 v47, v47
    v_pk_mul_f32 v[140:141], v[140:141], v[32:33]
    v_pk_mul_f32 v[142:143], v[142:143], v[34:35]
    v_pk_mul_f32 v[144:145], v[144:145], v[36:37]
    v_pk_mul_f32 v[146:147], v[146:147], v[38:39]
    v_pk_mul_f32 v[148:149], v[148:149], v[40:41]
    v_pk_mul_f32 v[150:151], v[150:151], v[42:43]
    v_pk_mul_f32 v[152:153], v[152:153], v[44:45]
    v_pk_mul_f32 v[154:155], v[154:155], v[46:47]
    v_cvt_pk_bf16_f32 v32, v140, v141
    v_cvt_pk_bf16_f32 v33, v142, v143
    v_cvt_pk_bf16_f32 v34, v144, v145
    v_cvt_pk_bf16_f32 v35, v146, v147
    v_cvt_pk_bf16_f32 v36, v148, v149
    v_cvt_pk_bf16_f32 v37, v150, v151
    v_cvt_pk_bf16_f32 v38, v152, v153
    v_cvt_pk_bf16_f32 v39, v154, v155
    s_mov_b32 s51, 126976
    s_nop 0
    v_permlane16_swap_b32 v32, v34
    v_permlane16_swap_b32 v33, v35
    v_permlane16_swap_b32 v36, v38
    v_permlane16_swap_b32 v37, v39
    buffer_store_dwordx4 v[32:35], v6, s[12:15], s51 offen sc1
    buffer_store_dwordx4 v[36:39], v6, s[12:15], s51 offen offset:1024 sc1
    v_pk_add_f32 v[184:185], v[184:185], v[48:49]
    v_pk_add_f32 v[186:187], v[186:187], v[50:51]
    v_pk_add_f32 v[188:189], v[188:189], v[52:53]
    v_pk_add_f32 v[190:191], v[190:191], v[54:55]
    v_pk_add_f32 v[192:193], v[192:193], v[56:57]
    v_pk_add_f32 v[194:195], v[194:195], v[58:59]
    v_pk_add_f32 v[196:197], v[196:197], v[60:61]
    v_pk_add_f32 v[198:199], v[198:199], v[62:63]
    v_pk_mul_f32 v[16:17], v[184:185], v[184:185]
    v_pk_mul_f32 v[18:19], v[186:187], v[186:187]
    v_pk_mul_f32 v[20:21], v[188:189], v[188:189]
    v_pk_mul_f32 v[22:23], v[190:191], v[190:191]
    v_pk_mul_f32 v[24:25], v[192:193], v[192:193]
    v_pk_mul_f32 v[26:27], v[194:195], v[194:195]
    v_pk_mul_f32 v[28:29], v[196:197], v[196:197]
    v_pk_mul_f32 v[30:31], v[198:199], v[198:199]
    v_pk_fma_f32 v[16:17], v[16:17], v[12:13], v[10:11]
    v_pk_fma_f32 v[18:19], v[18:19], v[12:13], v[10:11]
    v_pk_fma_f32 v[20:21], v[20:21], v[12:13], v[10:11]
    v_pk_fma_f32 v[22:23], v[22:23], v[12:13], v[10:11]
    v_pk_fma_f32 v[24:25], v[24:25], v[12:13], v[10:11]
    v_pk_fma_f32 v[26:27], v[26:27], v[12:13], v[10:11]
    v_pk_fma_f32 v[28:29], v[28:29], v[12:13], v[10:11]
    v_pk_fma_f32 v[30:31], v[30:31], v[12:13], v[10:11]
    v_pk_mul_f32 v[16:17], v[16:17], v[184:185]
    v_pk_mul_f32 v[18:19], v[18:19], v[186:187]
    v_pk_mul_f32 v[20:21], v[20:21], v[188:189]
    v_pk_mul_f32 v[22:23], v[22:23], v[190:191]
    v_pk_mul_f32 v[24:25], v[24:25], v[192:193]
    v_pk_mul_f32 v[26:27], v[26:27], v[194:195]
    v_pk_mul_f32 v[28:29], v[28:29], v[196:197]
    v_pk_mul_f32 v[30:31], v[30:31], v[198:199]
    v_exp_f32 v16, v16
    v_exp_f32 v17, v17
    v_exp_f32 v18, v18
    v_exp_f32 v19, v19
    v_exp_f32 v20, v20
    v_exp_f32 v21, v21
    v_exp_f32 v22, v22
    v_exp_f32 v23, v23
    v_exp_f32 v24, v24
    v_exp_f32 v25, v25
    v_exp_f32 v26, v26
    v_exp_f32 v27, v27
    v_exp_f32 v28, v28
    v_exp_f32 v29, v29
    v_exp_f32 v30, v30
    v_exp_f32 v31, v31
    v_pk_add_f32 v[16:17], v[16:17], v[14:15]
    v_pk_add_f32 v[18:19], v[18:19], v[14:15]
    v_pk_add_f32 v[20:21], v[20:21], v[14:15]
    v_pk_add_f32 v[22:23], v[22:23], v[14:15]
    v_pk_add_f32 v[24:25], v[24:25], v[14:15]
    v_pk_add_f32 v[26:27], v[26:27], v[14:15]
    v_pk_add_f32 v[28:29], v[28:29], v[14:15]
    v_pk_add_f32 v[30:31], v[30:31], v[14:15]
    v_rcp_f32 v16, v16
    v_rcp_f32 v17, v17
    v_rcp_f32 v18, v18
    v_rcp_f32 v19, v19
    v_rcp_f32 v20, v20
    v_rcp_f32 v21, v21
    v_rcp_f32 v22, v22
    v_rcp_f32 v23, v23
    v_rcp_f32 v24, v24
    v_rcp_f32 v25, v25
    v_rcp_f32 v26, v26
    v_rcp_f32 v27, v27
    v_rcp_f32 v28, v28
    v_rcp_f32 v29, v29
    v_rcp_f32 v30, v30
    v_rcp_f32 v31, v31
    v_pk_mul_f32 v[184:185], v[184:185], v[16:17]
    v_pk_mul_f32 v[186:187], v[186:187], v[18:19]
    v_pk_mul_f32 v[188:189], v[188:189], v[20:21]
    v_pk_mul_f32 v[190:191], v[190:191], v[22:23]
    v_pk_mul_f32 v[192:193], v[192:193], v[24:25]
    v_pk_mul_f32 v[194:195], v[194:195], v[26:27]
    v_pk_mul_f32 v[196:197], v[196:197], v[28:29]
    v_pk_mul_f32 v[198:199], v[198:199], v[30:31]
    v_cvt_pk_bf16_f32 v16, v184, v185
    v_cvt_pk_bf16_f32 v17, v186, v187
    v_cvt_pk_bf16_f32 v18, v188, v189
    v_cvt_pk_bf16_f32 v19, v190, v191
    v_cvt_pk_bf16_f32 v20, v192, v193
    v_cvt_pk_bf16_f32 v21, v194, v195
    v_cvt_pk_bf16_f32 v22, v196, v197
    v_cvt_pk_bf16_f32 v23, v198, v199
    s_mov_b32 s51, 251904
    s_nop 0
    v_permlane16_swap_b32 v16, v18
    v_permlane16_swap_b32 v17, v19
    v_permlane16_swap_b32 v20, v22
    v_permlane16_swap_b32 v21, v23
    buffer_store_dwordx4 v[16:19], v6, s[12:15], s51 offen sc1
    buffer_store_dwordx4 v[20:23], v6, s[12:15], s51 offen offset:1024 sc1
    v_pk_add_f32 v[228:229], v[228:229], v[48:49]
    v_pk_add_f32 v[230:231], v[230:231], v[50:51]
    v_pk_add_f32 v[232:233], v[232:233], v[52:53]
    v_pk_add_f32 v[234:235], v[234:235], v[54:55]
    v_pk_add_f32 v[236:237], v[236:237], v[56:57]
    v_pk_add_f32 v[238:239], v[238:239], v[58:59]
    v_pk_add_f32 v[240:241], v[240:241], v[60:61]
    v_pk_add_f32 v[242:243], v[242:243], v[62:63]
    v_pk_mul_f32 v[32:33], v[228:229], v[228:229]
    v_pk_mul_f32 v[34:35], v[230:231], v[230:231]
    v_pk_mul_f32 v[36:37], v[232:233], v[232:233]
    v_pk_mul_f32 v[38:39], v[234:235], v[234:235]
    v_pk_mul_f32 v[40:41], v[236:237], v[236:237]
    v_pk_mul_f32 v[42:43], v[238:239], v[238:239]
    v_pk_mul_f32 v[44:45], v[240:241], v[240:241]
    v_pk_mul_f32 v[46:47], v[242:243], v[242:243]
    v_pk_fma_f32 v[32:33], v[32:33], v[12:13], v[10:11]
    v_pk_fma_f32 v[34:35], v[34:35], v[12:13], v[10:11]
    v_pk_fma_f32 v[36:37], v[36:37], v[12:13], v[10:11]
    v_pk_fma_f32 v[38:39], v[38:39], v[12:13], v[10:11]
    v_pk_fma_f32 v[40:41], v[40:41], v[12:13], v[10:11]
    v_pk_fma_f32 v[42:43], v[42:43], v[12:13], v[10:11]
    v_pk_fma_f32 v[44:45], v[44:45], v[12:13], v[10:11]
    v_pk_fma_f32 v[46:47], v[46:47], v[12:13], v[10:11]
    v_pk_mul_f32 v[32:33], v[32:33], v[228:229]
    v_pk_mul_f32 v[34:35], v[34:35], v[230:231]
    v_pk_mul_f32 v[36:37], v[36:37], v[232:233]
    v_pk_mul_f32 v[38:39], v[38:39], v[234:235]
    v_pk_mul_f32 v[40:41], v[40:41], v[236:237]
    v_pk_mul_f32 v[42:43], v[42:43], v[238:239]
    v_pk_mul_f32 v[44:45], v[44:45], v[240:241]
    v_pk_mul_f32 v[46:47], v[46:47], v[242:243]
    v_exp_f32 v32, v32
    v_exp_f32 v33, v33
    v_exp_f32 v34, v34
    v_exp_f32 v35, v35
    v_exp_f32 v36, v36
    v_exp_f32 v37, v37
    v_exp_f32 v38, v38
    v_exp_f32 v39, v39
    v_exp_f32 v40, v40
    v_exp_f32 v41, v41
    v_exp_f32 v42, v42
    v_exp_f32 v43, v43
    v_exp_f32 v44, v44
    v_exp_f32 v45, v45
    v_exp_f32 v46, v46
    v_exp_f32 v47, v47
    v_pk_add_f32 v[32:33], v[32:33], v[14:15]
    v_pk_add_f32 v[34:35], v[34:35], v[14:15]
    v_pk_add_f32 v[36:37], v[36:37], v[14:15]
    v_pk_add_f32 v[38:39], v[38:39], v[14:15]
    v_pk_add_f32 v[40:41], v[40:41], v[14:15]
    v_pk_add_f32 v[42:43], v[42:43], v[14:15]
    v_pk_add_f32 v[44:45], v[44:45], v[14:15]
    v_pk_add_f32 v[46:47], v[46:47], v[14:15]
    v_rcp_f32 v32, v32
    v_rcp_f32 v33, v33
    v_rcp_f32 v34, v34
    v_rcp_f32 v35, v35
    v_rcp_f32 v36, v36
    v_rcp_f32 v37, v37
    v_rcp_f32 v38, v38
    v_rcp_f32 v39, v39
    v_rcp_f32 v40, v40
    v_rcp_f32 v41, v41
    v_rcp_f32 v42, v42
    v_rcp_f32 v43, v43
    v_rcp_f32 v44, v44
    v_rcp_f32 v45, v45
    v_rcp_f32 v46, v46
    v_rcp_f32 v47, v47
    v_pk_mul_f32 v[228:229], v[228:229], v[32:33]
    v_pk_mul_f32 v[230:231], v[230:231], v[34:35]
    v_pk_mul_f32 v[232:233], v[232:233], v[36:37]
    v_pk_mul_f32 v[234:235], v[234:235], v[38:39]
    v_pk_mul_f32 v[236:237], v[236:237], v[40:41]
    v_pk_mul_f32 v[238:239], v[238:239], v[42:43]
    v_pk_mul_f32 v[240:241], v[240:241], v[44:45]
    v_pk_mul_f32 v[242:243], v[242:243], v[46:47]
    v_cvt_pk_bf16_f32 v32, v228, v229
    v_cvt_pk_bf16_f32 v33, v230, v231
    v_cvt_pk_bf16_f32 v34, v232, v233
    v_cvt_pk_bf16_f32 v35, v234, v235
    v_cvt_pk_bf16_f32 v36, v236, v237
    v_cvt_pk_bf16_f32 v37, v238, v239
    v_cvt_pk_bf16_f32 v38, v240, v241
    v_cvt_pk_bf16_f32 v39, v242, v243
    s_mov_b32 s51, 376832
    s_nop 0
    v_permlane16_swap_b32 v32, v34
    v_permlane16_swap_b32 v33, v35
    v_permlane16_swap_b32 v36, v38
    v_permlane16_swap_b32 v37, v39
    buffer_store_dwordx4 v[32:35], v6, s[12:15], s51 offen sc1
    buffer_store_dwordx4 v[36:39], v6, s[12:15], s51 offen offset:1024 sc1
    s_waitcnt vmcnt(8)
    v_mov_b32 v0, 155664
    v_mov_b32 v1, 1
    s_mov_b64 exec, 1
    ds_add_rtn_u32 v1, v0, v1
    s_waitcnt lgkmcnt(0)
    v_cmp_eq_u32 vcc, 3, v1
    s_cbranch_vccz sig_g1fq1
    v_mov_b32 v0, 0
    v_mov_b32 v1, s95
    buffer_store_dword v1, v0, s[96:99], s35 offen sc1
sig_g1fq1:
    s_mov_b64 exec, -1
    s_add_u32 s35, s35, 1024
    s_waitcnt vmcnt(16)
    v_lshlrev_b32 v48, 16, v64
    v_and_b32 v49, 0xffff0000, v64
    v_lshlrev_b32 v50, 16, v65
    v_and_b32 v51, 0xffff0000, v65
    v_lshlrev_b32 v52, 16, v66
    v_and_b32 v53, 0xffff0000, v66
    v_lshlrev_b32 v54, 16, v67
    v_and_b32 v55, 0xffff0000, v67
    v_lshlrev_b32 v56, 16, v68
    v_and_b32 v57, 0xffff0000, v68
    v_lshlrev_b32 v58, 16, v69
    v_and_b32 v59, 0xffff0000, v69
    v_pk_add_f32 v[112:113], v[112:113], v[48:49]
    v_pk_add_f32 v[114:115], v[114:115], v[50:51]
    v_pk_add_f32 v[116:117], v[116:117], v[52:53]
    v_pk_add_f32 v[118:119], v[118:119], v[54:55]
    v_pk_add_f32 v[120:121], v[120:121], v[56:57]
    v_pk_add_f32 v[122:123], v[122:123], v[58:59]
    v_pk_mul_f32 v[16:17], v[112:113], v[112:113]
    v_pk_mul_f32 v[18:19], v[114:115], v[114:115]
    v_pk_mul_f32 v[20:21], v[116:117], v[116:117]
    v_pk_mul_f32 v[22:23], v[118:119], v[118:119]
    v_pk_mul_f32 v[24:25], v[120:121], v[120:121]
    v_pk_mul_f32 v[26:27], v[122:123], v[122:123]
    v_pk_fma_f32 v[16:17], v[16:17], v[12:13], v[10:11]
    v_pk_fma_f32 v[18:19], v[18:19], v[12:13], v[10:11]
    v_pk_fma_f32 v[20:21], v[20:21], v[12:13], v[10:11]
    v_pk_fma_f32 v[22:23], v[22:23], v[12:13], v[10:11]
    v_pk_fma_f32 v[24:25], v[24:25], v[12:13], v[10:11]
    v_pk_fma_f32 v[26:27], v[26:27], v[12:13], v[10:11]
    v_pk_mul_f32 v[16:17], v[16:17], v[112:113]
    v_pk_mul_f32 v[18:19], v[18:19], v[114:115]
    v_pk_mul_f32 v[20:21], v[20:21], v[116:117]
    v_pk_mul_f32 v[22:23], v[22:23], v[118:119]
    v_pk_mul_f32 v[24:25], v[24:25], v[120:121]
    v_pk_mul_f32 v[26:27], v[26:27], v[122:123]
    v_exp_f32 v16, v16
    v_exp_f32 v17, v17
    v_exp_f32 v18, v18
    v_exp_f32 v19, v19
    v_exp_f32 v20, v20
    v_exp_f32 v21, v21
    v_exp_f32 v22, v22
    v_exp_f32 v23, v23
    v_exp_f32 v24, v24
    v_exp_f32 v25, v25
    v_exp_f32 v26, v26
    v_exp_f32 v27, v27
    v_pk_add_f32 v[16:17], v[16:17], v[14:15]
    v_pk_add_f32 v[18:19], v[18:19], v[14:15]
    v_pk_add_f32 v[20:21], v[20:21], v[14:15]
    v_pk_add_f32 v[22:23], v[22:23], v[14:15]
    v_pk_add_f32 v[24:25], v[24:25], v[14:15]
    v_pk_add_f32 v[26:27], v[26:27], v[14:15]
    v_rcp_f32 v16, v16
    v_rcp_f32 v17, v17
    v_rcp_f32 v18, v18
    v_rcp_f32 v19, v19
    v_rcp_f32 v20, v20
    v_rcp_f32 v21, v21
    v_rcp_f32 v22, v22
    v_rcp_f32 v23, v23
    v_rcp_f32 v24, v24
    v_rcp_f32 v25, v25
    v_rcp_f32 v26, v26
    v_rcp_f32 v27, v27
    v_pk_mul_f32 v[112:113], v[112:113], v[16:17]
    v_pk_mul_f32 v[114:115], v[114:115], v[18:19]
    v_pk_mul_f32 v[116:117], v[116:117], v[20:21]
    v_pk_mul_f32 v[118:119], v[118:119], v[22:23]
    v_pk_mul_f32 v[120:121], v[120:121], v[24:25]
    v_pk_mul_f32 v[122:123], v[122:123], v[26:27]
    v_cvt_pk_bf16_f32 v16, v112, v113
    v_cvt_pk_bf16_f32 v17, v114, v115
    v_cvt_pk_bf16_f32 v18, v116, v117
    v_cvt_pk_bf16_f32 v19, v118, v119
    v_cvt_pk_bf16_f32 v20, v120, v121
    v_cvt_pk_bf16_f32 v21, v122, v123
    v_mov_b32 v22, 0
    v_mov_b32 v23, 0
    s_mov_b32 s51, 4096
    s_nop 0
    v_permlane16_swap_b32 v16, v18
    v_permlane16_swap_b32 v17, v19
    v_permlane16_swap_b32 v20, v22
    v_permlane16_swap_b32 v21, v23
    buffer_store_dwordx4 v[16:19], v6, s[12:15], s51 offen sc1
    buffer_store_dwordx4 v[20:23], v6, s[12:15], s51 offen offset:1024 sc1
    v_pk_add_f32 v[156:157], v[156:157], v[48:49]
    v_pk_add_f32 v[158:159], v[158:159], v[50:51]
    v_pk_add_f32 v[160:161], v[160:161], v[52:53]
    v_pk_add_f32 v[162:163], v[162:163], v[54:55]
    v_pk_add_f32 v[164:165], v[164:165], v[56:57]
    v_pk_add_f32 v[166:167], v[166:167], v[58:59]
    v_pk_mul_f32 v[32:33], v[156:157], v[156:157]
    v_pk_mul_f32 v[34:35], v[158:159], v[158:159]
    v_pk_mul_f32 v[36:37], v[160:161], v[160:161]
    v_pk_mul_f32 v[38:39], v[162:163], v[162:163]
    v_pk_mul_f32 v[40:41], v[164:165], v[164:165]
    v_pk_mul_f32 v[42:43], v[166:167], v[166:167]
    v_pk_fma_f32 v[32:33], v[32:33], v[12:13], v[10:11]
    v_pk_fma_f32 v[34:35], v[34:35], v[12:13], v[10:11]
    v_pk_fma_f32 v[36:37], v[36:37], v[12:13], v[10:11]
    v_pk_fma_f32 v[38:39], v[38:39], v[12:13], v[10:11]
    v_pk_fma_f32 v[40:41], v[40:41], v[12:13], v[10:11]
    v_pk_fma_f32 v[42:43], v[42:43], v[12:13], v[10:11]
    v_pk_mul_f32 v[32:33], v[32:33], v[156:157]
    v_pk_mul_f32 v[34:35], v[34:35], v[158:159]
    v_pk_mul_f32 v[36:37], v[36:37], v[160:161]
    v_pk_mul_f32 v[38:39], v[38:39], v[162:163]
    v_pk_mul_f32 v[40:41], v[40:41], v[164:165]
    v_pk_mul_f32 v[42:43], v[42:43], v[166:167]
    v_exp_f32 v32, v32
    v_exp_f32 v33, v33
    v_exp_f32 v34, v34
    v_exp_f32 v35, v35
    v_exp_f32 v36, v36
    v_exp_f32 v37, v37
    v_exp_f32 v38, v38
    v_exp_f32 v39, v39
    v_exp_f32 v40, v40
    v_exp_f32 v41, v41
    v_exp_f32 v42, v42
    v_exp_f32 v43, v43
    v_pk_add_f32 v[32:33], v[32:33], v[14:15]
    v_pk_add_f32 v[34:35], v[34:35], v[14:15]
    v_pk_add_f32 v[36:37], v[36:37], v[14:15]
    v_pk_add_f32 v[38:39], v[38:39], v[14:15]
    v_pk_add_f32 v[40:41], v[40:41], v[14:15]
    v_pk_add_f32 v[42:43], v[42:43], v[14:15]
    v_rcp_f32 v32, v32
    v_rcp_f32 v33, v33
    v_rcp_f32 v34, v34
    v_rcp_f32 v35, v35
    v_rcp_f32 v36, v36
    v_rcp_f32 v37, v37
    v_rcp_f32 v38, v38
    v_rcp_f32 v39, v39
    v_rcp_f32 v40, v40
    v_rcp_f32 v41, v41
    v_rcp_f32 v42, v42
    v_rcp_f32 v43, v43
    v_pk_mul_f32 v[156:157], v[156:157], v[32:33]
    v_pk_mul_f32 v[158:159], v[158:159], v[34:35]
    v_pk_mul_f32 v[160:161], v[160:161], v[36:37]
    v_pk_mul_f32 v[162:163], v[162:163], v[38:39]
    v_pk_mul_f32 v[164:165], v[164:165], v[40:41]
    v_pk_mul_f32 v[166:167], v[166:167], v[42:43]
    v_cvt_pk_bf16_f32 v32, v156, v157
    v_cvt_pk_bf16_f32 v33, v158, v159
    v_cvt_pk_bf16_f32 v34, v160, v161
    v_cvt_pk_bf16_f32 v35, v162, v163
    v_cvt_pk_bf16_f32 v36, v164, v165
    v_cvt_pk_bf16_f32 v37, v166, v167
    v_mov_b32 v38, 0
    v_mov_b32 v39, 0
    s_mov_b32 s51, 129024
    s_nop 0
    v_permlane16_swap_b32 v32, v34
    v_permlane16_swap_b32 v33, v35
    v_permlane16_swap_b32 v36, v38
    v_permlane16_swap_b32 v37, v39
    buffer_store_dwordx4 v[32:35], v6, s[12:15], s51 offen sc1
    buffer_store_dwordx4 v[36:39], v6, s[12:15], s51 offen offset:1024 sc1
    v_pk_add_f32 v[200:201], v[200:201], v[48:49]
    v_pk_add_f32 v[202:203], v[202:203], v[50:51]
    v_pk_add_f32 v[204:205], v[204:205], v[52:53]
    v_pk_add_f32 v[206:207], v[206:207], v[54:55]
    v_pk_add_f32 v[208:209], v[208:209], v[56:57]
    v_pk_add_f32 v[210:211], v[210:211], v[58:59]
    v_pk_mul_f32 v[16:17], v[200:201], v[200:201]
    v_pk_mul_f32 v[18:19], v[202:203], v[202:203]
    v_pk_mul_f32 v[20:21], v[204:205], v[204:205]
    v_pk_mul_f32 v[22:23], v[206:207], v[206:207]
    v_pk_mul_f32 v[24:25], v[208:209], v[208:209]
    v_pk_mul_f32 v[26:27], v[210:211], v[210:211]
    v_pk_fma_f32 v[16:17], v[16:17], v[12:13], v[10:11]
    v_pk_fma_f32 v[18:19], v[18:19], v[12:13], v[10:11]
    v_pk_fma_f32 v[20:21], v[20:21], v[12:13], v[10:11]
    v_pk_fma_f32 v[22:23], v[22:23], v[12:13], v[10:11]
    v_pk_fma_f32 v[24:25], v[24:25], v[12:13], v[10:11]
    v_pk_fma_f32 v[26:27], v[26:27], v[12:13], v[10:11]
    v_pk_mul_f32 v[16:17], v[16:17], v[200:201]
    v_pk_mul_f32 v[18:19], v[18:19], v[202:203]
    v_pk_mul_f32 v[20:21], v[20:21], v[204:205]
    v_pk_mul_f32 v[22:23], v[22:23], v[206:207]
    v_pk_mul_f32 v[24:25], v[24:25], v[208:209]
    v_pk_mul_f32 v[26:27], v[26:27], v[210:211]
    v_exp_f32 v16, v16
    v_exp_f32 v17, v17
    v_exp_f32 v18, v18
    v_exp_f32 v19, v19
    v_exp_f32 v20, v20
    v_exp_f32 v21, v21
    v_exp_f32 v22, v22
    v_exp_f32 v23, v23
    v_exp_f32 v24, v24
    v_exp_f32 v25, v25
    v_exp_f32 v26, v26
    v_exp_f32 v27, v27
    v_pk_add_f32 v[16:17], v[16:17], v[14:15]
    v_pk_add_f32 v[18:19], v[18:19], v[14:15]
    v_pk_add_f32 v[20:21], v[20:21], v[14:15]
    v_pk_add_f32 v[22:23], v[22:23], v[14:15]
    v_pk_add_f32 v[24:25], v[24:25], v[14:15]
    v_pk_add_f32 v[26:27], v[26:27], v[14:15]
    v_rcp_f32 v16, v16
    v_rcp_f32 v17, v17
    v_rcp_f32 v18, v18
    v_rcp_f32 v19, v19
    v_rcp_f32 v20, v20
    v_rcp_f32 v21, v21
    v_rcp_f32 v22, v22
    v_rcp_f32 v23, v23
    v_rcp_f32 v24, v24
    v_rcp_f32 v25, v25
    v_rcp_f32 v26, v26
    v_rcp_f32 v27, v27
    v_pk_mul_f32 v[200:201], v[200:201], v[16:17]
    v_pk_mul_f32 v[202:203], v[202:203], v[18:19]
    v_pk_mul_f32 v[204:205], v[204:205], v[20:21]
    v_pk_mul_f32 v[206:207], v[206:207], v[22:23]
    v_pk_mul_f32 v[208:209], v[208:209], v[24:25]
    v_pk_mul_f32 v[210:211], v[210:211], v[26:27]
    v_cvt_pk_bf16_f32 v16, v200, v201
    v_cvt_pk_bf16_f32 v17, v202, v203
    v_cvt_pk_bf16_f32 v18, v204, v205
    v_cvt_pk_bf16_f32 v19, v206, v207
    v_cvt_pk_bf16_f32 v20, v208, v209
    v_cvt_pk_bf16_f32 v21, v210, v211
    v_mov_b32 v22, 0
    v_mov_b32 v23, 0
    s_mov_b32 s51, 253952
    s_nop 0
    v_permlane16_swap_b32 v16, v18
    v_permlane16_swap_b32 v17, v19
    v_permlane16_swap_b32 v20, v22
    v_permlane16_swap_b32 v21, v23
    buffer_store_dwordx4 v[16:19], v6, s[12:15], s51 offen sc1
    buffer_store_dwordx4 v[20:23], v6, s[12:15], s51 offen offset:1024 sc1
    v_pk_add_f32 v[244:245], v[244:245], v[48:49]
    v_pk_add_f32 v[246:247], v[246:247], v[50:51]
    v_pk_add_f32 v[248:249], v[248:249], v[52:53]
    v_pk_add_f32 v[250:251], v[250:251], v[54:55]
    v_pk_add_f32 v[252:253], v[252:253], v[56:57]
    v_pk_add_f32 v[254:255], v[254:255], v[58:59]
    v_pk_mul_f32 v[32:33], v[244:245], v[244:245]
    v_pk_mul_f32 v[34:35], v[246:247], v[246:247]
    v_pk_mul_f32 v[36:37], v[248:249], v[248:249]
    v_pk_mul_f32 v[38:39], v[250:251], v[250:251]
    v_pk_mul_f32 v[40:41], v[252:253], v[252:253]
    v_pk_mul_f32 v[42:43], v[254:255], v[254:255]
    v_pk_fma_f32 v[32:33], v[32:33], v[12:13], v[10:11]
    v_pk_fma_f32 v[34:35], v[34:35], v[12:13], v[10:11]
    v_pk_fma_f32 v[36:37], v[36:37], v[12:13], v[10:11]
    v_pk_fma_f32 v[38:39], v[38:39], v[12:13], v[10:11]
    v_pk_fma_f32 v[40:41], v[40:41], v[12:13], v[10:11]
    v_pk_fma_f32 v[42:43], v[42:43], v[12:13], v[10:11]
    v_pk_mul_f32 v[32:33], v[32:33], v[244:245]
    v_pk_mul_f32 v[34:35], v[34:35], v[246:247]
    v_pk_mul_f32 v[36:37], v[36:37], v[248:249]
    v_pk_mul_f32 v[38:39], v[38:39], v[250:251]
    v_pk_mul_f32 v[40:41], v[40:41], v[252:253]
    v_pk_mul_f32 v[42:43], v[42:43], v[254:255]
    v_exp_f32 v32, v32
    v_exp_f32 v33, v33
    v_exp_f32 v34, v34
    v_exp_f32 v35, v35
    v_exp_f32 v36, v36
    v_exp_f32 v37, v37
    v_exp_f32 v38, v38
    v_exp_f32 v39, v39
    v_exp_f32 v40, v40
    v_exp_f32 v41, v41
    v_exp_f32 v42, v42
    v_exp_f32 v43, v43
    v_pk_add_f32 v[32:33], v[32:33], v[14:15]
    v_pk_add_f32 v[34:35], v[34:35], v[14:15]
    v_pk_add_f32 v[36:37], v[36:37], v[14:15]
    v_pk_add_f32 v[38:39], v[38:39], v[14:15]
    v_pk_add_f32 v[40:41], v[40:41], v[14:15]
    v_pk_add_f32 v[42:43], v[42:43], v[14:15]
    v_rcp_f32 v32, v32
    v_rcp_f32 v33, v33
    v_rcp_f32 v34, v34
    v_rcp_f32 v35, v35
    v_rcp_f32 v36, v36
    v_rcp_f32 v37, v37
    v_rcp_f32 v38, v38
    v_rcp_f32 v39, v39
    v_rcp_f32 v40, v40
    v_rcp_f32 v41, v41
    v_rcp_f32 v42, v42
    v_rcp_f32 v43, v43
    v_pk_mul_f32 v[244:245], v[244:245], v[32:33]
    v_pk_mul_f32 v[246:247], v[246:247], v[34:35]
    v_pk_mul_f32 v[248:249], v[248:249], v[36:37]
    v_pk_mul_f32 v[250:251], v[250:251], v[38:39]
    v_pk_mul_f32 v[252:253], v[252:253], v[40:41]
    v_pk_mul_f32 v[254:255], v[254:255], v[42:43]
    v_cvt_pk_bf16_f32 v32, v244, v245
    v_cvt_pk_bf16_f32 v33, v246, v247
    v_cvt_pk_bf16_f32 v34, v248, v249
    v_cvt_pk_bf16_f32 v35, v250, v251
    v_cvt_pk_bf16_f32 v36, v252, v253
    v_cvt_pk_bf16_f32 v37, v254, v255
    v_mov_b32 v38, 0
    v_mov_b32 v39, 0
    s_mov_b32 s51, 378880
    s_nop 0
    v_permlane16_swap_b32 v32, v34
    v_permlane16_swap_b32 v33, v35
    v_permlane16_swap_b32 v36, v38
    v_permlane16_swap_b32 v37, v39
    buffer_store_dwordx4 v[32:35], v6, s[12:15], s51 offen sc1
    buffer_store_dwordx4 v[36:39], v6, s[12:15], s51 offen offset:1024 sc1
    s_mov_b32 s94, 28
    s_add_u32 s74, s35, 1024
    s_mov_b32 s75, s35
    s_branch g2_comp
g2_loader:
    s_load_dwordx4 s[20:23], s[0:1], 8
    s_load_dwordx2 s[24:25], s[0:1], 64
    v_mbcnt_lo_u32_b32 v1, -1, 0
    v_mbcnt_hi_u32_b32 v1, -1, v1
    s_lshr_b32 s30, s2, 1
    s_and_b32 s30, s30, 2
    s_and_b32 s31, s2, 1
    s_add_u32 s30, s30, s31
    s_and_b32 s31, s2, 2
    s_lshl_b32 s31, s31, 1
    s_lshr_b32 s32, s2, 3
    s_and_b32 s40, s32, 3
    s_add_u32 s40, s40, s31
    s_lshl_b32 s40, s40, 8
    s_lshr_b32 s41, s32, 2
    s_lshl_b32 s41, s41, 7
    s_mov_b32 s43, 0
    s_waitcnt lgkmcnt(0)
    s_cmp_ge_u32 s30, 2
    s_cbranch_scc1 g2o_lstart
g2y_lstart:
    s_mov_b32 s60, 32
    s_mov_b32 s42, 0
    s_cmp_eq_u32 s30, 0
    s_cselect_b32 s8, s20, s22
    s_cselect_b32 s9, s21, s23
    s_mov_b32 s10, 8388608
    s_mov_b32 s11, 0x20000
    s_lshl_b32 s49, s3, 6
    s_add_u32 s49, s49, s40
    v_lshrrev_b32 v2, 2, v1
    v_and_b32 v2, 7, v2
    s_mov_b32 s50, 4096
    v_mul_lo_u32 v2, v2, s50
    v_lshrrev_b32 v3, 5, v1
    v_lshl_add_u32 v2, v3, 6, v2
    v_lshrrev_b32 v3, 3, v1
    v_and_b32 v3, 2, v3
    v_and_b32 v4, 3, v1
    v_xor_b32 v3, v3, v4
    v_lshlrev_b32 v3, 4, v3
    v_xor_b32 v4, 48, v3
    v_add_u32 v3, v3, v2
    v_add_u32 v4, v4, v2
    s_mul_i32 s49, s49, 4096
    s_add_u32 s50, s49, 0
    v_add_u32 v8, s50, v3
    s_add_u32 s50, s49, 31744
    v_add_u32 v9, s50, v4
    s_add_u32 s50, s49, 63488
    v_add_u32 v10, s50, v3
    s_add_u32 s50, s49, 95232
    v_add_u32 v11, s50, v4
    s_add_u32 s50, s49, 131072
    v_add_u32 v12, s50, v3
    s_add_u32 s50, s49, 162816
    v_add_u32 v13, s50, v4
    s_add_u32 s50, s49, 194560
    v_add_u32 v14, s50, v3
    s_add_u32 s50, s49, 226304
    v_add_u32 v15, s50, v4
    s_lshl_b32 s52, s3, 13
    s_add_u32 s53, s52, 4096
    s_mul_i32 s54, s3, 4096
    s_add_u32 s54, s54, 32768
    v_lshrrev_b32 v2, 5, v1
    v_lshrrev_b32 v3, 4, v1
    v_and_b32 v3, 1, v3
    v_xor_b32 v3, v3, v2
    v_lshl_add_u32 v3, v3, 1, v2
    v_xor_b32 v3, v3, v1
    v_lshlrev_b32 v3, 4, v3
    v_mov_b32 v4, v3
    s_add_u32 s64, s28, 5242880
    s_addc_u32 s65, s29, 0
    s_mov_b32 s66, 8650752
    s_mov_b32 s67, 0x20000
    s_lshl_b32 s49, s30, 10
    s_add_u32 s49, s49, s41
    s_lshl_b32 s50, s3, 5
    s_add_u32 s49, s49, s50
    s_add_u32 s49, s49, 0
    s_mul_i32 s49, s49, 4224
    s_add_u32 s49, s49, 0
    v_add_u32 v16, s49, v3
    s_add_u32 s68, s28, 5242880
    s_addc_u32 s69, s29, 0
    s_mov_b32 s70, 8650752
    s_mov_b32 s71, 0x20000
    s_lshl_b32 s49, s30, 10
    s_add_u32 s49, s49, s41
    s_lshl_b32 s50, s3, 5
    s_add_u32 s49, s49, s50
    s_add_u32 s49, s49, 0
    s_mul_i32 s49, s49, 4224
    s_add_u32 s49, s49, 1024
    s_sub_u32 s49, s49, 1024
    v_add_u32 v17, s49, v4
    s_add_u32 s72, s28, 5242880
    s_addc_u32 s73, s29, 0
    s_mov_b32 s74, 8650752
    s_mov_b32 s75, 0x20000
    s_lshl_b32 s49, s30, 10
    s_add_u32 s49, s49, s41
    s_lshl_b32 s50, s3, 5
    s_add_u32 s49, s49, s50
    s_add_u32 s49, s49, 16
    s_mul_i32 s49, s49, 4224
    s_add_u32 s49, s49, 0
    s_sub_u32 s49, s49, 2048
    v_add_u32 v18, s49, v3
    s_add_u32 s76, s28, 5242880
    s_addc_u32 s77, s29, 0
    s_mov_b32 s78, 8650752
    s_mov_b32 s79, 0x20000
    s_lshl_b32 s49, s30, 10
    s_add_u32 s49, s49, s41
    s_lshl_b32 s50, s3, 5
    s_add_u32 s49, s49, s50
    s_add_u32 s49, s49, 16
    s_mul_i32 s49, s49, 4224
    s_add_u32 s49, s49, 1024
    s_sub_u32 s49, s49, 3072
    v_add_u32 v19, s49, v4
    s_mov_b32 s46, 0
    s_mov_b32 s61, s60
    s_add_u32 m0, s46, s52
    s_nop 0
    buffer_load_dwordx4 v8, s[8:11], s42 offen lds
    buffer_load_dwordx4 v9, s[8:11], s42 offen offset:1024 lds
    buffer_load_dwordx4 v10, s[8:11], s42 offen offset:2048 lds
    buffer_load_dwordx4 v11, s[8:11], s42 offen offset:3072 lds
    s_add_u32 m0, s46, s53
    s_nop 0
    buffer_load_dwordx4 v12, s[8:11], s42 offen lds
    buffer_load_dwordx4 v13, s[8:11], s42 offen offset:1024 lds
    buffer_load_dwordx4 v14, s[8:11], s42 offen offset:2048 lds
    buffer_load_dwordx4 v15, s[8:11], s42 offen offset:3072 lds
    s_add_u32 s42, s42, 128
    s_add_u32 s46, s46, 49152
    s_add_u32 m0, s46, s52
    s_nop 0
    buffer_load_dwordx4 v8, s[8:11], s42 offen lds
    buffer_load_dwordx4 v9, s[8:11], s42 offen offset:1024 lds
    buffer_load_dwordx4 v10, s[8:11], s42 offen offset:2048 lds
    buffer_load_dwordx4 v11, s[8:11], s42 offen offset:3072 lds
    s_add_u32 m0, s46, s53
    s_nop 0
    buffer_load_dwordx4 v12, s[8:11], s42 offen lds
    buffer_load_dwordx4 v13, s[8:11], s42 offen offset:1024 lds
    buffer_load_dwordx4 v14, s[8:11], s42 offen offset:2048 lds
    buffer_load_dwordx4 v15, s[8:11], s42 offen offset:3072 lds
    s_add_u32 s42, s42, 128
    s_add_u32 s46, s46, 49152
    s_add_u32 m0, s46, s52
    s_nop 0
    buffer_load_dwordx4 v8, s[8:11], s42 offen lds
    buffer_load_dwordx4 v9, s[8:11], s42 offen offset:1024 lds
    buffer_load_dwordx4 v10, s[8:11], s42 offen offset:2048 lds
    buffer_load_dwordx4 v11, s[8:11], s42 offen offset:3072 lds
    s_add_u32 m0, s46, s53
    s_nop 0
    buffer_load_dwordx4 v12, s[8:11], s42 offen lds
    buffer_load_dwordx4 v13, s[8:11], s42 offen offset:1024 lds
    buffer_load_dwordx4 v14, s[8:11], s42 offen offset:2048 lds
    buffer_load_dwordx4 v15, s[8:11], s42 offen offset:3072 lds
    s_add_u32 s42, s42, 128
    s_add_u32 s46, s46, 49152
    s_mov_b32 s46, 0
    s_lshl_b32 s49, s30, 10
    s_add_u32 s49, s49, s41
    v_and_b32 v2, 8, v1
    v_lshlrev_b32 v2, 4, v2
    v_min_u32 v2, 127, v2
    v_add_u32 v2, s49, v2
    v_mul_u32_u24 v2, 745, v2
    v_lshrrev_b32 v2, 17, v2
    v_and_b32 v3, 7, v1
    v_lshlrev_b32 v4, 7, v2
    v_lshl_add_u32 v4, v3, 2, v4
    v_add_u32 v4, 1024, v4
    v_mov_b32 v6, 155704
    s_cmp_lg_u32 s3, 0
    s_cbranch_scc1 lw_g2y
    s_mov_b32 s51, 200000
poll_g2y:
    buffer_load_dword v5, v4, s[96:99], 0 offen sc1
    s_waitcnt vmcnt(0)
    v_cmp_ne_u32 vcc, s95, v5
    s_cbranch_vccz polld_g2y
    s_sleep 1
    s_sub_u32 s51, s51, 1
    s_cmp_lg_u32 s51, 0
    s_cbranch_scc1 poll_g2y
polld_g2y:
    v_mov_b32 v5, 1
    ds_write_b32 v6, v5
    s_branch lwd_g2y
lw_g2y:
    s_mov_b32 s51, 4000000
lwl_g2y:
    ds_read_b32 v5, v6
    s_waitcnt lgkmcnt(0)
    v_cmp_ne_u32 vcc, 1, v5
    s_cbranch_vccz lwd_g2y
    s_sleep 1
    s_sub_u32 s51, s51, 1
    s_cmp_lg_u32 s51, 0
    s_cbranch_scc1 lwl_g2y
lwd_g2y:
    s_add_u32 m0, s46, s54
    s_nop 0
    buffer_load_dwordx4 v16, s[64:67], s43 offen sc1 lds
    buffer_load_dwordx4 v17, s[68:71], s43 offen offset:1024 sc1 lds
    buffer_load_dwordx4 v18, s[72:75], s43 offen offset:2048 sc1 lds
    buffer_load_dwordx4 v19, s[76:79], s43 offen offset:3072 sc1 lds
    s_add_u32 s43, s43, 2048
    s_add_u32 s46, s46, 49152
    s_add_u32 m0, s46, s54
    s_nop 0
    buffer_load_dwordx4 v16, s[64:67], s43 offen sc1 lds
    buffer_load_dwordx4 v17, s[68:71], s43 offen offset:1024 sc1 lds
    buffer_load_dwordx4 v18, s[72:75], s43 offen offset:2048 sc1 lds
    buffer_load_dwordx4 v19, s[76:79], s43 offen offset:3072 sc1 lds
    s_add_u32 s43, s43, 2048
    s_add_u32 s46, s46, 49152
    s_add_u32 m0, s46, s54
    s_nop 0
    buffer_load_dwordx4 v16, s[64:67], s43 offen sc1 lds
    buffer_load_dwordx4 v17, s[68:71], s43 offen offset:1024 sc1 lds
    buffer_load_dwordx4 v18, s[72:75], s43 offen offset:2048 sc1 lds
    buffer_load_dwordx4 v19, s[76:79], s43 offen offset:3072 sc1 lds
    s_add_u32 s43, s43, 2048
    s_add_u32 s46, s46, 49152
    s_mov_b32 s46, 0
    s_sub_u32 s61, s60, 3
    s_waitcnt vmcnt(8)
    s_barrier
    s_mov_b32 s45, s60
    s_waitcnt vmcnt(4)
    s_branch g2y_lmid
g2y_lloop:
    s_waitcnt vmcnt(12)
g2y_lmid:
    s_barrier
    s_add_u32 m0, s46, s52
    s_nop 0
    buffer_load_dwordx4 v8, s[8:11], s42 offen lds
    buffer_load_dwordx4 v9, s[8:11], s42 offen offset:1024 lds
    buffer_load_dwordx4 v10, s[8:11], s42 offen offset:2048 lds
    buffer_load_dwordx4 v11, s[8:11], s42 offen offset:3072 lds
    s_add_u32 m0, s46, s53
    s_nop 0
    buffer_load_dwordx4 v12, s[8:11], s42 offen lds
    buffer_load_dwordx4 v13, s[8:11], s42 offen offset:1024 lds
    buffer_load_dwordx4 v14, s[8:11], s42 offen offset:2048 lds
    buffer_load_dwordx4 v15, s[8:11], s42 offen offset:3072 lds
    s_add_u32 m0, s46, s54
    s_nop 0
    buffer_load_dwordx4 v16, s[64:67], s43 offen sc1 lds
    buffer_load_dwordx4 v17, s[68:71], s43 offen offset:1024 sc1 lds
    buffer_load_dwordx4 v18, s[72:75], s43 offen offset:2048 sc1 lds
    buffer_load_dwordx4 v19, s[76:79], s43 offen offset:3072 sc1 lds
    s_add_u32 s42, s42, 128
    s_add_u32 s43, s43, 2048
    s_add_u32 s46, s46, 49152
    s_cmp_ge_u32 s46, 147456
    s_cselect_b32 s46, 0, s46
    s_sub_u32 s61, s61, 1
    s_cmp_lt_i32 s61, 1
    s_cselect_b32 s10, 0, s10
    s_cselect_b32 s66, 0, s66
    s_cselect_b32 s70, 0, s70
    s_cselect_b32 s74, 0, s74
    s_cselect_b32 s78, 0, s78
    s_sub_u32 s45, s45, 1
    s_cmp_lg_u32 s45, 0
    s_cbranch_scc1 g2y_lloop
    s_endpgm
g2o_lstart:
    s_and_b32 s33, s30, 1
    s_sub_u32 s60, 31, s33
    s_mul_i32 s42, s33, 63488
    s_mul_i32 s44, s33, 3735552
    s_mov_b32 s68, 0
    s_mov_b32 s69, 0
    s_mul_i32 s70, s33, 98
    s_add_u32 s70, s70, 1
    s_sub_u32 s71, 11, s33
    s_add_u32 s72, s71, 10
    s_mul_i32 s73, s33, 61440
    s_add_u32 s73, s73, 2048
    s_mul_i32 s74, s33, 3604480
    s_add_u32 s74, s74, 131072
    s_add_u32 s8, s28, 14680064
    s_addc_u32 s9, s29, 0
    s_mov_b32 s10, 15990784
    s_mov_b32 s11, 0x20000
    s_lshl_b32 s49, s3, 6
    s_add_u32 s49, s49, s40
    v_lshrrev_b32 v2, 5, v1
    v_lshrrev_b32 v3, 4, v1
    v_and_b32 v3, 1, v3
    v_xor_b32 v3, v3, v2
    v_lshl_add_u32 v3, v3, 1, v2
    v_xor_b32 v3, v3, v1
    v_lshlrev_b32 v3, 4, v3
    v_mov_b32 v4, v3
    s_lshr_b32 s49, s49, 4
    s_mul_i32 s49, s49, 124928
    s_add_u32 s50, s49, 0
    v_add_u32 v8, s50, v3
    s_add_u32 s50, s49, 0
    v_add_u32 v9, s50, v4
    s_add_u32 s50, s49, 122880
    v_add_u32 v10, s50, v3
    s_add_u32 s50, s49, 122880
    v_add_u32 v11, s50, v4
    s_add_u32 s50, s49, 249856
    v_add_u32 v12, s50, v3
    s_add_u32 s50, s49, 249856
    v_add_u32 v13, s50, v4
    s_add_u32 s50, s49, 372736
    v_add_u32 v14, s50, v3
    s_add_u32 s50, s49, 372736
    v_add_u32 v15, s50, v4
    s_lshl_b32 s52, s3, 13
    s_add_u32 s53, s52, 4096
    s_mul_i32 s54, s3, 4096
    s_add_u32 s54, s54, 32768
    s_mov_b32 s64, s24
    s_mov_b32 s65, s25
    s_mov_b32 s66, 7340032
    s_mov_b32 s67, 0x20000
    s_lshl_b32 s49, s41, 1
    v_lshrrev_b32 v2, 4, v1
    v_mul_u32_u24 v3, 2048, v2
    v_lshlrev_b32 v2, 5, v2
    v_and_b32 v4, 15, v1
    v_lshlrev_b32 v4, 4, v4
    v_xor_b32 v4, v4, v2
    v_xor_b32 v5, 128, v4
    v_add_u32 v4, v4, v3
    v_add_u32 v5, v5, v3
    s_mul_i32 s50, s3, 32768
    s_add_u32 s49, s49, s50
    s_add_u32 s50, s49, 0
    v_add_u32 v16, s50, v4
    s_add_u32 s50, s49, 7168
    v_add_u32 v17, s50, v4
    s_add_u32 s50, s49, 14336
    v_add_u32 v18, s50, v5
    s_add_u32 s50, s49, 21504
    v_add_u32 v19, s50, v5
    s_mov_b32 s46, 0
    s_mov_b32 s61, s60
    s_add_u32 m0, s46, s54
    s_nop 0
    buffer_load_dwordx4 v16, s[64:67], s44 offen lds
    buffer_load_dwordx4 v17, s[64:67], s44 offen offset:1024 lds
    buffer_load_dwordx4 v18, s[64:67], s44 offen offset:2048 lds
    buffer_load_dwordx4 v19, s[64:67], s44 offen offset:3072 lds
    s_add_u32 s68, s68, 1
    s_add_u32 s44, s44, 360448
    s_cmp_eq_u32 s68, s70
    s_cselect_b32 s44, s74, s44
    s_add_u32 s49, s74, 131072
    s_cmp_eq_u32 s68, s71
    s_cselect_b32 s44, s49, s44
    s_add_u32 s49, s74, 262144
    s_cmp_eq_u32 s68, s72
    s_cselect_b32 s44, s49, s44
    s_add_u32 s46, s46, 49152
    s_add_u32 m0, s46, s54
    s_nop 0
    buffer_load_dwordx4 v16, s[64:67], s44 offen lds
    buffer_load_dwordx4 v17, s[64:67], s44 offen offset:1024 lds
    buffer_load_dwordx4 v18, s[64:67], s44 offen offset:2048 lds
    buffer_load_dwordx4 v19, s[64:67], s44 offen offset:3072 lds
    s_add_u32 s68, s68, 1
    s_add_u32 s44, s44, 360448
    s_cmp_eq_u32 s68, s70
    s_cselect_b32 s44, s74, s44
    s_add_u32 s49, s74, 131072
    s_cmp_eq_u32 s68, s71
    s_cselect_b32 s44, s49, s44
    s_add_u32 s49, s74, 262144
    s_cmp_eq_u32 s68, s72
    s_cselect_b32 s44, s49, s44
    s_add_u32 s46, s46, 49152
    s_add_u32 m0, s46, s54
    s_nop 0
    buffer_load_dwordx4 v16, s[64:67], s44 offen lds
    buffer_load_dwordx4 v17, s[64:67], s44 offen offset:1024 lds
    buffer_load_dwordx4 v18, s[64:67], s44 offen offset:2048 lds
    buffer_load_dwordx4 v19, s[64:67], s44 offen offset:3072 lds
    s_add_u32 s68, s68, 1
    s_add_u32 s44, s44, 360448
    s_cmp_eq_u32 s68, s70
    s_cselect_b32 s44, s74, s44
    s_add_u32 s49, s74, 131072
    s_cmp_eq_u32 s68, s71
    s_cselect_b32 s44, s49, s44
    s_add_u32 s49, s74, 262144
    s_cmp_eq_u32 s68, s72
    s_cselect_b32 s44, s49, s44
    s_add_u32 s46, s46, 49152
    s_mov_b32 s46, 0
    v_and_b32 v2, 15, v1
    s_sub_u32 s34, 10, s33
    v_min_u32 v2, s34, v2
    s_mul_i32 s34, s33, 11
    s_add_u32 s34, s34, 11
    v_add_u32 v2, s34, v2
    s_lshr_b32 s34, s40, 1
    s_add_u32 s34, s34, 4096
    v_lshl_add_u32 v4, v2, 2, s34
    v_and_b32 v2, 15, v1
    v_min_u32 v2, 9, v2
    s_mul_i32 s35, s33, 40
    s_add_u32 s35, s35, s34
    s_add_u32 s35, s35, 1072
    v_lshl_add_u32 v22, v2, 2, s35
    v_and_b32 v2, 16, v1
    v_lshl_add_u32 v22, v2, 6, v22
    v_mov_b32 v6, 155704
    s_cmp_lg_u32 s3, 0
    s_cbranch_scc1 lw_g2o
    s_mov_b32 s51, 200000
poll_g2o:
    buffer_load_dword v5, v4, s[96:99], 0 offen sc1
    s_waitcnt vmcnt(0)
    v_cmp_ne_u32 vcc, s95, v5
    s_cbranch_vccz polld_g2o
    s_sleep 1
    s_sub_u32 s51, s51, 1
    s_cmp_lg_u32 s51, 0
    s_cbranch_scc1 poll_g2o
polld_g2o:
    v_mov_b32 v5, 1
    ds_write_b32 v6, v5
    s_branch lwd_g2o
lw_g2o:
    s_mov_b32 s51, 4000000
lwl_g2o:
    ds_read_b32 v5, v6
    s_waitcnt lgkmcnt(0)
    v_cmp_ne_u32 vcc, 1, v5
    s_cbranch_vccz lwd_g2o
    s_sleep 1
    s_sub_u32 s51, s51, 1
    s_cmp_lg_u32 s51, 0
    s_cbranch_scc1 lwl_g2o
lwd_g2o:
    s_add_u32 m0, s46, s52
    s_nop 0
    buffer_load_dwordx4 v8, s[8:11], s42 offen sc1 lds
    buffer_load_dwordx4 v9, s[8:11], s42 offen offset:1024 sc1 lds
    buffer_load_dwordx4 v10, s[8:11], s42 offen offset:2048 sc1 lds
    buffer_load_dwordx4 v11, s[8:11], s42 offen offset:3072 sc1 lds
    s_add_u32 m0, s46, s53
    s_nop 0
    buffer_load_dwordx4 v12, s[8:11], s42 offen sc1 lds
    buffer_load_dwordx4 v13, s[8:11], s42 offen offset:1024 sc1 lds
    buffer_load_dwordx4 v14, s[8:11], s42 offen offset:2048 sc1 lds
    buffer_load_dwordx4 v15, s[8:11], s42 offen offset:3072 sc1 lds
    s_add_u32 s69, s69, 1
    s_add_u32 s42, s42, 6144
    s_cmp_eq_u32 s69, s70
    s_cselect_b32 s42, s73, s42
    s_add_u32 s49, s73, 2048
    s_cmp_eq_u32 s69, s71
    s_cselect_b32 s42, s49, s42
    s_add_u32 s49, s73, 4096
    s_cmp_eq_u32 s69, s72
    s_cselect_b32 s42, s49, s42
    s_add_u32 s46, s46, 49152
    s_add_u32 m0, s46, s52
    s_nop 0
    buffer_load_dwordx4 v8, s[8:11], s42 offen sc1 lds
    buffer_load_dwordx4 v9, s[8:11], s42 offen offset:1024 sc1 lds
    buffer_load_dwordx4 v10, s[8:11], s42 offen offset:2048 sc1 lds
    buffer_load_dwordx4 v11, s[8:11], s42 offen offset:3072 sc1 lds
    s_add_u32 m0, s46, s53
    s_nop 0
    buffer_load_dwordx4 v12, s[8:11], s42 offen sc1 lds
    buffer_load_dwordx4 v13, s[8:11], s42 offen offset:1024 sc1 lds
    buffer_load_dwordx4 v14, s[8:11], s42 offen offset:2048 sc1 lds
    buffer_load_dwordx4 v15, s[8:11], s42 offen offset:3072 sc1 lds
    s_add_u32 s69, s69, 1
    s_add_u32 s42, s42, 6144
    s_cmp_eq_u32 s69, s70
    s_cselect_b32 s42, s73, s42
    s_add_u32 s49, s73, 2048
    s_cmp_eq_u32 s69, s71
    s_cselect_b32 s42, s49, s42
    s_add_u32 s49, s73, 4096
    s_cmp_eq_u32 s69, s72
    s_cselect_b32 s42, s49, s42
    s_add_u32 s46, s46, 49152
    s_add_u32 m0, s46, s52
    s_nop 0
    buffer_load_dwordx4 v8, s[8:11], s42 offen sc1 lds
    buffer_load_dwordx4 v9, s[8:11], s42 offen offset:1024 sc1 lds
    buffer_load_dwordx4 v10, s[8:11], s42 offen offset:2048 sc1 lds
    buffer_load_dwordx4 v11, s[8:11], s42 offen offset:3072 sc1 lds
    s_add_u32 m0, s46, s53
    s_nop 0
    buffer_load_dwordx4 v12, s[8:11], s42 offen sc1 lds
    buffer_load_dwordx4 v13, s[8:11], s42 offen offset:1024 sc1 lds
    buffer_load_dwordx4 v14, s[8:11], s42 offen offset:2048 sc1 lds
    buffer_load_dwordx4 v15, s[8:11], s42 offen offset:3072 sc1 lds
    s_add_u32 s69, s69, 1
    s_add_u32 s42, s42, 6144
    s_cmp_eq_u32 s69, s70
    s_cselect_b32 s42, s73, s42
    s_add_u32 s49, s73, 2048
    s_cmp_eq_u32 s69, s71
    s_cselect_b32 s42, s49, s42
    s_add_u32 s49, s73, 4096
    s_cmp_eq_u32 s69, s72
    s_cselect_b32 s42, s49, s42
    s_add_u32 s46, s46, 49152
    s_mov_b32 s46, 0
    s_sub_u32 s61, s60, 3
    s_waitcnt vmcnt(16)
    s_barrier
    s_mov_b32 s45, s60
    s_waitcnt vmcnt(8)
    s_branch g2o_lmid
g2o_chk:
    v_cmp_ne_u32 vcc, s95, v23
    s_cbranch_vccz g2o_lmid
    s_mov_b32 s51, 200000
poll_g2o_late:
    buffer_load_dword v23, v22, s[96:99], 0 offen sc1
    s_waitcnt vmcnt(0)
    v_cmp_ne_u32 vcc, s95, v23
    s_cbranch_vccz polld_g2o_late
    s_sleep 2
    s_sub_u32 s51, s51, 1
    s_cmp_lg_u32 s51, 0
    s_cbranch_scc1 poll_g2o_late
polld_g2o_late:
    s_branch g2o_lmid
g2o_lloop:
    s_waitcnt vmcnt(12)
    s_cmp_eq_u32 s45, 23
    s_cbranch_scc1 g2o_chk
g2o_lmid:
    s_barrier
    s_cmp_lg_u32 s45, 24
    s_cbranch_scc1 g2o_np
    buffer_load_dword v23, v22, s[96:99], 0 offen sc1
g2o_np:
    s_add_u32 m0, s46, s52
    s_nop 0
    buffer_load_dwordx4 v8, s[8:11], s42 offen sc1 lds
    buffer_load_dwordx4 v9, s[8:11], s42 offen offset:1024 sc1 lds
    buffer_load_dwordx4 v10, s[8:11], s42 offen offset:2048 sc1 lds
    buffer_load_dwordx4 v11, s[8:11], s42 offen offset:3072 sc1 lds
    s_add_u32 m0, s46, s53
    s_nop 0
    buffer_load_dwordx4 v12, s[8:11], s42 offen sc1 lds
    buffer_load_dwordx4 v13, s[8:11], s42 offen offset:1024 sc1 lds
    buffer_load_dwordx4 v14, s[8:11], s42 offen offset:2048 sc1 lds
    buffer_load_dwordx4 v15, s[8:11], s42 offen offset:3072 sc1 lds
    s_add_u32 m0, s46, s54
    s_nop 0
    buffer_load_dwordx4 v16, s[64:67], s44 offen lds
    buffer_load_dwordx4 v17, s[64:67], s44 offen offset:1024 lds
    buffer_load_dwordx4 v18, s[64:67], s44 offen offset:2048 lds
    buffer_load_dwordx4 v19, s[64:67], s44 offen offset:3072 lds
    s_add_u32 s69, s69, 1
    s_add_u32 s42, s42, 6144
    s_cmp_eq_u32 s69, s70
    s_cselect_b32 s42, s73, s42
    s_add_u32 s49, s73, 2048
    s_cmp_eq_u32 s69, s71
    s_cselect_b32 s42, s49, s42
    s_add_u32 s49, s73, 4096
    s_cmp_eq_u32 s69, s72
    s_cselect_b32 s42, s49, s42
    s_add_u32 s68, s68, 1
    s_add_u32 s44, s44, 360448
    s_cmp_eq_u32 s68, s70
    s_cselect_b32 s44, s74, s44
    s_add_u32 s49, s74, 131072
    s_cmp_eq_u32 s68, s71
    s_cselect_b32 s44, s49, s44
    s_add_u32 s49, s74, 262144
    s_cmp_eq_u32 s68, s72
    s_cselect_b32 s44, s49, s44
    s_add_u32 s46, s46, 49152
    s_cmp_ge_u32 s46, 147456
    s_cselect_b32 s46, 0, s46
    s_sub_u32 s61, s61, 1
    s_cmp_lt_i32 s61, 1
    s_cselect_b32 s10, 0, s10
    s_cselect_b32 s66, 0, s66
    s_sub_u32 s45, s45, 1
    s_cmp_lg_u32 s45, 0
    s_cbranch_scc1 g2o_lloop
    s_endpgm
g2_comp:
    s_load_dwordx4 s[20:23], s[0:1], 8
    s_load_dwordx2 s[24:25], s[0:1], 64
    v_mbcnt_lo_u32_b32 v1, -1, 0
    v_mbcnt_hi_u32_b32 v1, -1, v1
    s_lshr_b32 s30, s2, 1
    s_and_b32 s30, s30, 2
    s_and_b32 s31, s2, 1
    s_add_u32 s30, s30, s31
    s_and_b32 s31, s2, 2
    s_lshl_b32 s31, s31, 1
    s_lshr_b32 s32, s2, 3
    s_and_b32 s40, s32, 3
    s_add_u32 s40, s40, s31
    s_lshl_b32 s40, s40, 8
    s_lshr_b32 s41, s32, 2
    s_lshl_b32 s41, s41, 7
    s_mov_b32 s43, 0
    s_waitcnt lgkmcnt(0)
    s_cmp_ge_u32 s30, 2
    s_cbranch_scc1 g2o_cstart
g2y_cstart:
    s_mov_b32 s60, 32
    v_mov_b32 v20, v1
    s_lshr_b32 s49, s3, 1
    s_mul_i32 s49, s49, 16384
    s_and_b32 s50, s3, 1
    v_and_b32 v4, 15, v20
    v_lshrrev_b32 v5, 4, v20
    v_lshrrev_b32 v6, 3, v4
    v_lshrrev_b32 v7, 2, v4
    v_and_b32 v7, 1, v7
    v_xor_b32 v7, v7, v6
    v_lshl_add_u32 v7, v7, 1, v6
    v_xor_b32 v7, v7, v5
    v_lshlrev_b32 v7, 4, v7
    v_lshl_add_u32 v15, v4, 6, v7
    v_lshl_add_u32 v7, v6, 10, v7
    v_and_b32 v6, 7, v4
    v_lshl_add_u32 v6, v6, 6, v7
    v_lshrrev_b32 v8, 2, v20
    v_and_b32 v8, 3, v8
    v_and_b32 v9, 3, v20
    s_mul_i32 s51, s50, 8192
    s_add_u32 s51, s51, 32768
    v_add_u32 v10, s51, v15
    v_mov_b32 v1, v10
    v_add_u32 v0, s49, v6
    v_mov_b32 v80, 0
    v_mov_b32 v81, 0
    v_mov_b32 v82, 0
    v_mov_b32 v83, 0
    v_mov_b32 v84, 0
    v_mov_b32 v85, 0
    v_mov_b32 v86, 0
    v_mov_b32 v87, 0
    v_mov_b32 v88, 0
    v_mov_b32 v89, 0
    v_mov_b32 v90, 0
    v_mov_b32 v91, 0
    v_mov_b32 v92, 0
    v_mov_b32 v93, 0
    v_mov_b32 v94, 0
    v_mov_b32 v95, 0
    v_mov_b32 v96, 0
    v_mov_b32 v97, 0
    v_mov_b32 v98, 0
    v_mov_b32 v99, 0
    v_mov_b32 v100, 0
    v_mov_b32 v101, 0
    v_mov_b32 v102, 0
    v_mov_b32 v103, 0
    v_mov_b32 v104, 0
    v_mov_b32 v105, 0
    v_mov_b32 v106, 0
    v_mov_b32 v107, 0
    v_mov_b32 v108, 0
    v_mov_b32 v109, 0
    v_mov_b32 v110, 0
    v_mov_b32 v111, 0
    v_mov_b32 v112, 0
    v_mov_b32 v113, 0
    v_mov_b32 v114, 0
    v_mov_b32 v115, 0
    v_mov_b32 v116, 0
    v_mov_b32 v117, 0
    v_mov_b32 v118, 0
    v_mov_b32 v119, 0
    v_mov_b32 v120, 0
    v_mov_b32 v121, 0
    v_mov_b32 v122, 0
    v_mov_b32 v123, 0
    v_mov_b32 v124, 0
    v_mov_b32 v125, 0
    v_mov_b32 v126, 0
    v_mov_b32 v127, 0
    v_mov_b32 v128, 0
    v_mov_b32 v129, 0
    v_mov_b32 v130, 0
    v_mov_b32 v131, 0
    v_mov_b32 v132, 0
    v_mov_b32 v133, 0
    v_mov_b32 v134, 0
    v_mov_b32 v135, 0
    v_mov_b32 v136, 0
    v_mov_b32 v137, 0
    v_mov_b32 v138, 0
    v_mov_b32 v139, 0
    v_mov_b32 v140, 0
    v_mov_b32 v141, 0
    v_mov_b32 v142, 0
    v_mov_b32 v143, 0
    v_mov_b32 v144, 0
    v_mov_b32 v145, 0
    v_mov_b32 v146, 0
    v_mov_b32 v147, 0
    v_mov_b32 v148, 0
    v_mov_b32 v149, 0
    v_mov_b32 v150, 0
    v_mov_b32 v151, 0
    v_mov_b32 v152, 0
    v_mov_b32 v153, 0
    v_mov_b32 v154, 0
    v_mov_b32 v155, 0
    v_mov_b32 v156, 0
    v_mov_b32 v157, 0
    v_mov_b32 v158, 0
    v_mov_b32 v159, 0
    v_mov_b32 v160, 0
    v_mov_b32 v161, 0
    v_mov_b32 v162, 0
    v_mov_b32 v163, 0
    v_mov_b32 v164, 0
    v_mov_b32 v165, 0
    v_mov_b32 v166, 0
    v_mov_b32 v167, 0
    v_mov_b32 v168, 0
    v_mov_b32 v169, 0
    v_mov_b32 v170, 0
    v_mov_b32 v171, 0
    v_mov_b32 v172, 0
    v_mov_b32 v173, 0
    v_mov_b32 v174, 0
    v_mov_b32 v175, 0
    v_mov_b32 v176, 0
    v_mov_b32 v177, 0
    v_mov_b32 v178, 0
    v_mov_b32 v179, 0
    v_mov_b32 v180, 0
    v_mov_b32 v181, 0
    v_mov_b32 v182, 0
    v_mov_b32 v183, 0
    v_mov_b32 v184, 0
    v_mov_b32 v185, 0
    v_mov_b32 v186, 0
    v_mov_b32 v187, 0
    v_mov_b32 v188, 0
    v_mov_b32 v189, 0
    v_mov_b32 v190, 0
    v_mov_b32 v191, 0
    v_mov_b32 v192, 0
    v_mov_b32 v193, 0
    v_mov_b32 v194, 0
    v_mov_b32 v195, 0
    v_mov_b32 v196, 0
    v_mov_b32 v197, 0
    v_mov_b32 v198, 0
    v_mov_b32 v199, 0
    v_mov_b32 v200, 0
    v_mov_b32 v201, 0
    v_mov_b32 v202, 0
    v_mov_b32 v203, 0
    v_mov_b32 v204, 0
    v_mov_b32 v205, 0
    v_mov_b32 v206, 0
    v_mov_b32 v207, 0
    s_mov_b32 s47, 0
    s_mov_b32 s88, 49152
    s_mov_b32 s48, 49152
    s_barrier
    ds_read_b128 v[36:39], v1 offset:0
    ds_read_b128 v[40:43], v1 offset:2048
    ds_read_b128 v[44:47], v1 offset:4096
    ds_read_b128 v[48:51], v1 offset:6144
    ds_read_b128 v[4:7], v0 offset:0
    ds_read_b128 v[8:11], v0 offset:2048
    ds_read_b128 v[12:15], v0 offset:4096
    ds_read_b128 v[16:19], v0 offset:6144
    ds_read_b128 v[20:23], v0 offset:8192
    ds_read_b128 v[24:27], v0 offset:10240
    ds_read_b128 v[28:31], v0 offset:12288
    ds_read_b128 v[32:35], v0 offset:14336
    s_mov_b32 s45, s60
    s_waitcnt lgkmcnt(0)
    s_branch g2y_mid
g2y_stub:
    s_waitcnt vmcnt(0)
    v_mov_b32 v72, 155656
    v_mov_b32 v73, 1
    s_mov_b64 exec, 1
    ds_add_rtn_u32 v73, v72, v73
    s_waitcnt lgkmcnt(0)
    v_cmp_eq_u32 vcc, 3, v73
    s_cbranch_vccz sig_dg2y
    v_mov_b32 v72, 0
    v_mov_b32 v73, s95
    buffer_store_dword v73, v72, s[96:99], s75 offen sc1
    buffer_store_dword v73, v72, s[96:99], s74 offen sc1
sig_dg2y:
    s_mov_b64 exec, -1
    s_branch g2y_stubret
.p2align 6
g2y_top:
    v_mfma_f32_16x16x32_bf16 v[136:139], v[60:63], v[16:19], v[136:139]
    ds_read_b128 v[48:51], v1 offset:6144
    v_mfma_f32_16x16x32_bf16 v[140:143], v[64:67], v[16:19], v[140:143]
    ds_read_b128 v[4:7], v0 offset:0
    v_mfma_f32_16x16x32_bf16 v[144:147], v[52:55], v[20:23], v[144:147]
    ds_read_b128 v[8:11], v0 offset:2048
    v_mfma_f32_16x16x32_bf16 v[148:151], v[56:59], v[20:23], v[148:151]
    ds_read_b128 v[12:15], v0 offset:4096
    v_mfma_f32_16x16x32_bf16 v[152:155], v[60:63], v[20:23], v[152:155]
    ds_read_b128 v[16:19], v0 offset:6144
    v_mfma_f32_16x16x32_bf16 v[156:159], v[64:67], v[20:23], v[156:159]
    ds_read_b128 v[20:23], v0 offset:8192
    v_mfma_f32_16x16x32_bf16 v[160:163], v[52:55], v[24:27], v[160:163]
    v_mfma_f32_16x16x32_bf16 v[164:167], v[56:59], v[24:27], v[164:167]
    v_mfma_f32_16x16x32_bf16 v[168:171], v[60:63], v[24:27], v[168:171]
    v_mfma_f32_16x16x32_bf16 v[172:175], v[64:67], v[24:27], v[172:175]
    ds_read_b128 v[24:27], v0 offset:10240
    v_mfma_f32_16x16x32_bf16 v[176:179], v[52:55], v[28:31], v[176:179]
    v_mfma_f32_16x16x32_bf16 v[180:183], v[56:59], v[28:31], v[180:183]
    v_mfma_f32_16x16x32_bf16 v[184:187], v[60:63], v[28:31], v[184:187]
    v_mfma_f32_16x16x32_bf16 v[188:191], v[64:67], v[28:31], v[188:191]
    ds_read_b128 v[28:31], v0 offset:12288
    v_mfma_f32_16x16x32_bf16 v[192:195], v[52:55], v[32:35], v[192:195]
    v_mfma_f32_16x16x32_bf16 v[196:199], v[56:59], v[32:35], v[196:199]
    v_mfma_f32_16x16x32_bf16 v[200:203], v[60:63], v[32:35], v[200:203]
    v_mfma_f32_16x16x32_bf16 v[204:207], v[64:67], v[32:35], v[204:207]
g2y_mid:
    ds_read_b128 v[32:35], v0 offset:14336
    s_waitcnt lgkmcnt(7)
    v_mfma_f32_16x16x32_bf16 v[80:83], v[36:39], v[4:7], v[80:83]
    ds_read_b128 v[52:55], v1 offset:1024
    v_mfma_f32_16x16x32_bf16 v[84:87], v[40:43], v[4:7], v[84:87]
    ds_read_b128 v[56:59], v1 offset:3072
    v_mfma_f32_16x16x32_bf16 v[88:91], v[44:47], v[4:7], v[88:91]
    ds_read_b128 v[60:63], v1 offset:5120
    v_mfma_f32_16x16x32_bf16 v[92:95], v[48:51], v[4:7], v[92:95]
    ds_read_b128 v[64:67], v1 offset:7168
    s_waitcnt lgkmcnt(10)
    v_mfma_f32_16x16x32_bf16 v[96:99], v[36:39], v[8:11], v[96:99]
    ds_read_b128 v[4:7], v0 offset:512
    v_mfma_f32_16x16x32_bf16 v[100:103], v[40:43], v[8:11], v[100:103]
    s_add_u32 s47, s47, 49152
    s_cmp_ge_u32 s47, 147456
    v_mfma_f32_16x16x32_bf16 v[104:107], v[44:47], v[8:11], v[104:107]
    s_cselect_b32 s47, 0, s47
    s_cselect_b32 s48, 4294868992, s88
    v_mfma_f32_16x16x32_bf16 v[108:111], v[48:51], v[8:11], v[108:111]
    ds_read_b128 v[8:11], v0 offset:2560
    s_waitcnt lgkmcnt(11)
    v_mfma_f32_16x16x32_bf16 v[112:115], v[36:39], v[12:15], v[112:115]
    v_mfma_f32_16x16x32_bf16 v[116:119], v[40:43], v[12:15], v[116:119]
    s_cmp_eq_u32 s45, s94
    s_cbranch_scc1 g2y_stub
g2y_stubret:
    v_mfma_f32_16x16x32_bf16 v[120:123], v[44:47], v[12:15], v[120:123]
    v_mfma_f32_16x16x32_bf16 v[124:127], v[48:51], v[12:15], v[124:127]
    ds_read_b128 v[12:15], v0 offset:4608
    s_waitcnt lgkmcnt(11)
    v_mfma_f32_16x16x32_bf16 v[128:131], v[36:39], v[16:19], v[128:131]
    v_mfma_f32_16x16x32_bf16 v[132:135], v[40:43], v[16:19], v[132:135]
    v_mfma_f32_16x16x32_bf16 v[136:139], v[44:47], v[16:19], v[136:139]
    v_mfma_f32_16x16x32_bf16 v[140:143], v[48:51], v[16:19], v[140:143]
    ds_read_b128 v[16:19], v0 offset:6656
    s_waitcnt lgkmcnt(11)
    v_mfma_f32_16x16x32_bf16 v[144:147], v[36:39], v[20:23], v[144:147]
    v_mfma_f32_16x16x32_bf16 v[148:151], v[40:43], v[20:23], v[148:151]
    v_mfma_f32_16x16x32_bf16 v[152:155], v[44:47], v[20:23], v[152:155]
    v_mfma_f32_16x16x32_bf16 v[156:159], v[48:51], v[20:23], v[156:159]
    ds_read_b128 v[20:23], v0 offset:8704
    s_waitcnt lgkmcnt(11)
    v_mfma_f32_16x16x32_bf16 v[160:163], v[36:39], v[24:27], v[160:163]
    v_mfma_f32_16x16x32_bf16 v[164:167], v[40:43], v[24:27], v[164:167]
    v_mfma_f32_16x16x32_bf16 v[168:171], v[44:47], v[24:27], v[168:171]
    v_mfma_f32_16x16x32_bf16 v[172:175], v[48:51], v[24:27], v[172:175]
    ds_read_b128 v[24:27], v0 offset:10752
    s_waitcnt lgkmcnt(11)
    v_mfma_f32_16x16x32_bf16 v[176:179], v[36:39], v[28:31], v[176:179]
    v_mfma_f32_16x16x32_bf16 v[180:183], v[40:43], v[28:31], v[180:183]
    v_mfma_f32_16x16x32_bf16 v[184:187], v[44:47], v[28:31], v[184:187]
    v_mfma_f32_16x16x32_bf16 v[188:191], v[48:51], v[28:31], v[188:191]
    ds_read_b128 v[28:31], v0 offset:12800
    s_waitcnt lgkmcnt(11)
    v_mfma_f32_16x16x32_bf16 v[192:195], v[36:39], v[32:35], v[192:195]
    v_mfma_f32_16x16x32_bf16 v[196:199], v[40:43], v[32:35], v[196:199]
    v_mfma_f32_16x16x32_bf16 v[200:203], v[44:47], v[32:35], v[200:203]
    v_mfma_f32_16x16x32_bf16 v[204:207], v[48:51], v[32:35], v[204:207]
    ds_read_b128 v[32:35], v0 offset:14848
    s_waitcnt lgkmcnt(7)
    v_mfma_f32_16x16x32_bf16 v[80:83], v[52:55], v[4:7], v[80:83]
    v_mfma_f32_16x16x32_bf16 v[84:87], v[56:59], v[4:7], v[84:87]
    v_mfma_f32_16x16x32_bf16 v[88:91], v[60:63], v[4:7], v[88:91]
    v_mfma_f32_16x16x32_bf16 v[92:95], v[64:67], v[4:7], v[92:95]
    s_waitcnt lgkmcnt(6)
    v_mfma_f32_16x16x32_bf16 v[96:99], v[52:55], v[8:11], v[96:99]
    v_mfma_f32_16x16x32_bf16 v[100:103], v[56:59], v[8:11], v[100:103]
    v_mfma_f32_16x16x32_bf16 v[104:107], v[60:63], v[8:11], v[104:107]
    v_mfma_f32_16x16x32_bf16 v[108:111], v[64:67], v[8:11], v[108:111]
    s_waitcnt lgkmcnt(0)
    s_barrier
    v_mfma_f32_16x16x32_bf16 v[112:115], v[52:55], v[12:15], v[112:115]
    v_add_u32 v0, s48, v0
    v_add_u32 v1, s48, v1
    v_mfma_f32_16x16x32_bf16 v[116:119], v[56:59], v[12:15], v[116:119]
    ds_read_b128 v[36:39], v1 offset:0
    v_mfma_f32_16x16x32_bf16 v[120:123], v[60:63], v[12:15], v[120:123]
    ds_read_b128 v[40:43], v1 offset:2048
    v_mfma_f32_16x16x32_bf16 v[124:127], v[64:67], v[12:15], v[124:127]
    ds_read_b128 v[44:47], v1 offset:4096
    v_mfma_f32_16x16x32_bf16 v[128:131], v[52:55], v[16:19], v[128:131]
    s_sub_u32 s45, s45, 1
    s_cmp_lg_u32 s45, 0
    v_mfma_f32_16x16x32_bf16 v[132:135], v[56:59], v[16:19], v[132:135]
    s_cbranch_scc1 g2y_top
    v_mfma_f32_16x16x32_bf16 v[136:139], v[60:63], v[16:19], v[136:139]
    v_mfma_f32_16x16x32_bf16 v[140:143], v[64:67], v[16:19], v[140:143]
    v_mfma_f32_16x16x32_bf16 v[144:147], v[52:55], v[20:23], v[144:147]
    v_mfma_f32_16x16x32_bf16 v[148:151], v[56:59], v[20:23], v[148:151]
    v_mfma_f32_16x16x32_bf16 v[152:155], v[60:63], v[20:23], v[152:155]
    v_mfma_f32_16x16x32_bf16 v[156:159], v[64:67], v[20:23], v[156:159]
    v_mfma_f32_16x16x32_bf16 v[160:163], v[52:55], v[24:27], v[160:163]
    v_mfma_f32_16x16x32_bf16 v[164:167], v[56:59], v[24:27], v[164:167]
    v_mfma_f32_16x16x32_bf16 v[168:171], v[60:63], v[24:27], v[168:171]
    v_mfma_f32_16x16x32_bf16 v[172:175], v[64:67], v[24:27], v[172:175]
    v_mfma_f32_16x16x32_bf16 v[176:179], v[52:55], v[28:31], v[176:179]
    v_mfma_f32_16x16x32_bf16 v[180:183], v[56:59], v[28:31], v[180:183]
    v_mfma_f32_16x16x32_bf16 v[184:187], v[60:63], v[28:31], v[184:187]
    v_mfma_f32_16x16x32_bf16 v[188:191], v[64:67], v[28:31], v[188:191]
    v_mfma_f32_16x16x32_bf16 v[192:195], v[52:55], v[32:35], v[192:195]
    v_mfma_f32_16x16x32_bf16 v[196:199], v[56:59], v[32:35], v[196:199]
    v_mfma_f32_16x16x32_bf16 v[200:203], v[60:63], v[32:35], v[200:203]
    v_mfma_f32_16x16x32_bf16 v[204:207], v[64:67], v[32:35], v[204:207]
    s_waitcnt lgkmcnt(0)
    s_nop 7
    s_nop 7
    s_and_b32 s33, s30, 1
    s_cmp_eq_u32 s33, 1
    s_cbranch_scc1 g2y_e1
    v_mbcnt_lo_u32_b32 v1, -1, 0
    v_mbcnt_hi_u32_b32 v1, -1, v1
    v_and_b32 v2, 15, v1
    v_lshrrev_b32 v3, 4, v1
    v_lshlrev_b32 v5, 4, v1
    s_add_u32 s12, s28, 33554432
    s_addc_u32 s13, s29, 0
    s_mov_b32 s14, 33554432
    s_mov_b32 s15, 0x20000
    s_lshr_b32 s34, s40, 5
    s_lshr_b32 s35, s41, 7
    s_add_u32 s34, s34, s35
    s_lshl_b32 s34, s34, 4
    s_add_u32 s34, s34, s3
    s_lshl_b32 s34, s34, 15
    s_add_u32 s35, s34, 0
    s_add_u32 s51, s35, 8192
    v_cvt_pk_bf16_f32 v32, v112, v113
    v_cvt_pk_bf16_f32 v33, v114, v115
    v_cvt_pk_bf16_f32 v34, v116, v117
    v_cvt_pk_bf16_f32 v35, v118, v119
    buffer_store_dwordx4 v[32:35], v5, s[12:15], s51 offen offset:0 sc1
    v_cvt_pk_bf16_f32 v36, v120, v121
    v_cvt_pk_bf16_f32 v37, v122, v123
    v_cvt_pk_bf16_f32 v38, v124, v125
    v_cvt_pk_bf16_f32 v39, v126, v127
    buffer_store_dwordx4 v[36:39], v5, s[12:15], s51 offen offset:1024 sc1
    s_add_u32 s51, s35, 12288
    v_cvt_pk_bf16_f32 v40, v128, v129
    v_cvt_pk_bf16_f32 v41, v130, v131
    v_cvt_pk_bf16_f32 v42, v132, v133
    v_cvt_pk_bf16_f32 v43, v134, v135
    buffer_store_dwordx4 v[40:43], v5, s[12:15], s51 offen offset:0 sc1
    v_cvt_pk_bf16_f32 v44, v136, v137
    v_cvt_pk_bf16_f32 v45, v138, v139
    v_cvt_pk_bf16_f32 v46, v140, v141
    v_cvt_pk_bf16_f32 v47, v142, v143
    buffer_store_dwordx4 v[44:47], v5, s[12:15], s51 offen offset:1024 sc1
    s_add_u32 s51, s35, 16384
    v_cvt_pk_bf16_f32 v16, v144, v145
    v_cvt_pk_bf16_f32 v17, v146, v147
    v_cvt_pk_bf16_f32 v18, v148, v149
    v_cvt_pk_bf16_f32 v19, v150, v151
    buffer_store_dwordx4 v[16:19], v5, s[12:15], s51 offen offset:0 sc1
    v_cvt_pk_bf16_f32 v20, v152, v153
    v_cvt_pk_bf16_f32 v21, v154, v155
    v_cvt_pk_bf16_f32 v22, v156, v157
    v_cvt_pk_bf16_f32 v23, v158, v159
    buffer_store_dwordx4 v[20:23], v5, s[12:15], s51 offen offset:1024 sc1
    s_add_u32 s51, s35, 20480
    v_cvt_pk_bf16_f32 v24, v160, v161
    v_cvt_pk_bf16_f32 v25, v162, v163
    v_cvt_pk_bf16_f32 v26, v164, v165
    v_cvt_pk_bf16_f32 v27, v166, v167
    buffer_store_dwordx4 v[24:27], v5, s[12:15], s51 offen offset:0 sc1
    v_cvt_pk_bf16_f32 v28, v168, v169
    v_cvt_pk_bf16_f32 v29, v170, v171
    v_cvt_pk_bf16_f32 v30, v172, v173
    v_cvt_pk_bf16_f32 v31, v174, v175
    buffer_store_dwordx4 v[28:31], v5, s[12:15], s51 offen offset:1024 sc1
    s_add_u32 s51, s35, 24576
    v_cvt_pk_bf16_f32 v32, v176, v177
    v_cvt_pk_bf16_f32 v33, v178, v179
    v_cvt_pk_bf16_f32 v34, v180, v181
    v_cvt_pk_bf16_f32 v35, v182, v183
    buffer_store_dwordx4 v[32:35], v5, s[12:15], s51 offen offset:0 sc1
    v_cvt_pk_bf16_f32 v36, v184, v185
    v_cvt_pk_bf16_f32 v37, v186, v187
    v_cvt_pk_bf16_f32 v38, v188, v189
    v_cvt_pk_bf16_f32 v39, v190, v191
    buffer_store_dwordx4 v[36:39], v5, s[12:15], s51 offen offset:1024 sc1
    s_add_u32 s51, s35, 28672
    v_cvt_pk_bf16_f32 v40, v192, v193
    v_cvt_pk_bf16_f32 v41, v194, v195
    v_cvt_pk_bf16_f32 v42, v196, v197
    v_cvt_pk_bf16_f32 v43, v198, v199
    buffer_store_dwordx4 v[40:43], v5, s[12:15], s51 offen offset:0 sc1
    v_cvt_pk_bf16_f32 v44, v200, v201
    v_cvt_pk_bf16_f32 v45, v202, v203
    v_cvt_pk_bf16_f32 v46, v204, v205
    v_cvt_pk_bf16_f32 v47, v206, v207
    buffer_store_dwordx4 v[44:47], v5, s[12:15], s51 offen offset:1024 sc1
    s_lshr_b32 s36, s34, 12
    s_and_b32 s36, s36, 0xff80
    s_add_u32 s36, s36, 8192
    s_add_u32 s37, s36, 0
    s_waitcnt vmcnt(0)
    v_mov_b32 v0, 155660
    v_mov_b32 v1, 1
    s_mov_b64 exec, 1
    ds_add_rtn_u32 v1, v0, v1
    s_waitcnt lgkmcnt(0)
    v_cmp_eq_u32 vcc, 3, v1
    s_cbranch_vccz sig_c0
    v_mov_b32 v0, 0
    v_mov_b32 v1, s95
    buffer_store_dword v1, v0, s[96:99], s37 offen sc1
sig_c0:
    s_mov_b64 exec, -1
    s_load_dwordx2 s[20:21], s[0:1], 0
    s_load_dwordx4 s[24:27], s[0:1], 72
    v_mbcnt_lo_u32_b32 v1, -1, 0
    v_mbcnt_hi_u32_b32 v1, -1, v1
    s_lshr_b32 s49, s3, 1
    s_lshl_b32 s49, s49, 7
    s_add_u32 s49, s49, s40
    s_add_u32 s49, s49, 0
    s_and_b32 s50, s3, 1
    s_lshl_b32 s50, s50, 6
    s_add_u32 s50, s50, s41
    v_add_u32 v6, s49, v2
    v_lshlrev_b32 v6, 11, v6
    v_lshl_add_u32 v7, v3, 2, s50
    v_lshlrev_b32 v7, 1, v7
    v_add_u32 v8, v6, v7
    v_and_b32 v4, 1, v3
    v_lshlrev_b32 v4, 4, v4
    v_lshrrev_b32 v9, 1, v3
    v_lshl_add_u32 v4, v9, 3, v4
    v_add_u32 v4, s50, v4
    v_lshl_add_u32 v9, v4, 1, v6
    v_and_b32 v10, 3, v1
    v_lshl_add_u32 v10, v10, 2, s36
    s_waitcnt lgkmcnt(0)
    s_mov_b32 s64, s20
    s_mov_b32 s65, s21
    s_mov_b32 s66, 4194304
    s_mov_b32 s67, 0x20000
    s_mov_b32 s68, s24
    s_mov_b32 s69, s25
    s_mov_b32 s70, 2048
    s_mov_b32 s71, 0x20000
    s_mov_b32 s72, s26
    s_mov_b32 s73, s27
    s_mov_b32 s74, 4194304
    s_mov_b32 s75, 0x20000
    buffer_load_dwordx2 v[240:241], v8, s[64:67], 0 offen offset:0
    buffer_load_dwordx2 v[242:243], v8, s[64:67], 0 offen offset:32
    buffer_load_dwordx2 v[244:245], v8, s[64:67], 0 offen offset:64
    buffer_load_dwordx2 v[246:247], v8, s[64:67], 0 offen offset:96
    v_add_u32 v12, 0x8000, v8
    buffer_load_dwordx2 v[248:249], v12, s[64:67], 0 offen offset:0
    buffer_load_dwordx2 v[250:251], v12, s[64:67], 0 offen offset:32
    buffer_load_dwordx2 v[252:253], v12, s[64:67], 0 offen offset:64
    buffer_load_dwordx2 v[254:255], v12, s[64:67], 0 offen offset:96
    buffer_load_dwordx2 v[72:73], v7, s[68:71], 0 offen offset:0
    buffer_load_dwordx2 v[74:75], v7, s[68:71], 0 offen offset:32
    buffer_load_dwordx2 v[76:77], v7, s[68:71], 0 offen offset:64
    buffer_load_dwordx2 v[78:79], v7, s[68:71], 0 offen offset:96
    s_mov_b32 s51, 200000
poll_c0:
    buffer_load_dword v11, v10, s[96:99], 0 offen sc1
    s_waitcnt vmcnt(0)
    v_cmp_ne_u32 vcc, s95, v11
    s_cbranch_vccz polld_c0
    s_sleep 1
    s_sub_u32 s51, s51, 1
    s_cmp_lg_u32 s51, 0
    s_cbranch_scc1 poll_c0
polld_c0:
    s_add_u32 s51, s34, 131072
    buffer_load_dwordx4 v[112:115], v5, s[12:15], s51 offen offset:0 sc1
    buffer_load_dwordx4 v[116:119], v5, s[12:15], s51 offen offset:1024 sc1
    s_add_u32 s51, s34, 262144
    buffer_load_dwordx4 v[120:123], v5, s[12:15], s51 offen offset:0 sc1
    buffer_load_dwordx4 v[124:127], v5, s[12:15], s51 offen offset:1024 sc1
    s_add_u32 s51, s34, 393216
    buffer_load_dwordx4 v[128:131], v5, s[12:15], s51 offen offset:0 sc1
    buffer_load_dwordx4 v[132:135], v5, s[12:15], s51 offen offset:1024 sc1
    s_add_u32 s51, s34, 135168
    buffer_load_dwordx4 v[136:139], v5, s[12:15], s51 offen offset:0 sc1
    buffer_load_dwordx4 v[140:143], v5, s[12:15], s51 offen offset:1024 sc1
    s_add_u32 s51, s34, 266240
    buffer_load_dwordx4 v[144:147], v5, s[12:15], s51 offen offset:0 sc1
    buffer_load_dwordx4 v[148:151], v5, s[12:15], s51 offen offset:1024 sc1
    s_add_u32 s51, s34, 397312
    buffer_load_dwordx4 v[152:155], v5, s[12:15], s51 offen offset:0 sc1
    buffer_load_dwordx4 v[156:159], v5, s[12:15], s51 offen offset:1024 sc1
    s_mov_b32 s37, 0xbfb8aa3b
    s_waitcnt vmcnt(6)
    v_cvt_pk_bf16_f32 v28, v80, v81
    v_cvt_pk_bf16_f32 v29, v82, v83
    v_cvt_pk_bf16_f32 v30, v84, v85
    v_cvt_pk_bf16_f32 v31, v86, v87
    v_lshlrev_b32 v12, 16, v28
    v_and_b32 v13, 0xffff0000, v28
    v_lshlrev_b32 v14, 16, v29
    v_and_b32 v15, 0xffff0000, v29
    v_lshlrev_b32 v16, 16, v30
    v_and_b32 v17, 0xffff0000, v30
    v_lshlrev_b32 v18, 16, v31
    v_and_b32 v19, 0xffff0000, v31
    v_lshlrev_b32 v20, 16, v112
    v_and_b32 v21, 0xffff0000, v112
    v_lshlrev_b32 v22, 16, v113
    v_and_b32 v23, 0xffff0000, v113
    v_lshlrev_b32 v24, 16, v114
    v_and_b32 v25, 0xffff0000, v114
    v_lshlrev_b32 v26, 16, v115
    v_and_b32 v27, 0xffff0000, v115
    v_pk_add_f32 v[12:13], v[12:13], v[20:21]
    v_pk_add_f32 v[14:15], v[14:15], v[22:23]
    v_pk_add_f32 v[16:17], v[16:17], v[24:25]
    v_pk_add_f32 v[18:19], v[18:19], v[26:27]
    v_cvt_pk_bf16_f32 v28, v12, v13
    v_cvt_pk_bf16_f32 v29, v14, v15
    v_cvt_pk_bf16_f32 v30, v16, v17
    v_cvt_pk_bf16_f32 v31, v18, v19
    v_lshlrev_b32 v12, 16, v28
    v_and_b32 v13, 0xffff0000, v28
    v_lshlrev_b32 v14, 16, v29
    v_and_b32 v15, 0xffff0000, v29
    v_lshlrev_b32 v16, 16, v30
    v_and_b32 v17, 0xffff0000, v30
    v_lshlrev_b32 v18, 16, v31
    v_and_b32 v19, 0xffff0000, v31
    v_lshlrev_b32 v20, 16, v120
    v_and_b32 v21, 0xffff0000, v120
    v_lshlrev_b32 v22, 16, v121
    v_and_b32 v23, 0xffff0000, v121
    v_lshlrev_b32 v24, 16, v122
    v_and_b32 v25, 0xffff0000, v122
    v_lshlrev_b32 v26, 16, v123
    v_and_b32 v27, 0xffff0000, v123
    v_lshlrev_b32 v32, 16, v128
    v_and_b32 v33, 0xffff0000, v128
    v_lshlrev_b32 v34, 16, v129
    v_and_b32 v35, 0xffff0000, v129
    v_lshlrev_b32 v36, 16, v130
    v_and_b32 v37, 0xffff0000, v130
    v_lshlrev_b32 v38, 16, v131
    v_and_b32 v39, 0xffff0000, v131
    v_pk_add_f32 v[20:21], v[20:21], v[32:33]
    v_pk_add_f32 v[22:23], v[22:23], v[34:35]
    v_pk_add_f32 v[24:25], v[24:25], v[36:37]
    v_pk_add_f32 v[26:27], v[26:27], v[38:39]
    v_cvt_pk_bf16_f32 v28, v20, v21
    v_cvt_pk_bf16_f32 v29, v22, v23
    v_cvt_pk_bf16_f32 v30, v24, v25
    v_cvt_pk_bf16_f32 v31, v26, v27
    v_lshlrev_b32 v20, 16, v28
    v_and_b32 v21, 0xffff0000, v28
    v_lshlrev_b32 v22, 16, v29
    v_and_b32 v23, 0xffff0000, v29
    v_lshlrev_b32 v24, 16, v30
    v_and_b32 v25, 0xffff0000, v30
    v_lshlrev_b32 v26, 16, v31
    v_and_b32 v27, 0xffff0000, v31
    v_lshlrev_b32 v28, 16, v72
    v_and_b32 v29, 0xffff0000, v72
    v_lshlrev_b32 v30, 16, v73
    v_and_b32 v31, 0xffff0000, v73
    v_pk_add_f32 v[20:21], v[20:21], v[28:29]
    v_pk_add_f32 v[22:23], v[22:23], v[30:31]
    v_lshlrev_b32 v28, 16, v74
    v_and_b32 v29, 0xffff0000, v74
    v_lshlrev_b32 v30, 16, v75
    v_and_b32 v31, 0xffff0000, v75
    v_pk_add_f32 v[24:25], v[24:25], v[28:29]
    v_pk_add_f32 v[26:27], v[26:27], v[30:31]
    v_cvt_pk_bf16_f32 v28, v20, v21
    v_cvt_pk_bf16_f32 v29, v22, v23
    v_cvt_pk_bf16_f32 v30, v24, v25
    v_cvt_pk_bf16_f32 v31, v26, v27
    v_lshlrev_b32 v20, 16, v28
    v_and_b32 v21, 0xffff0000, v28
    v_lshlrev_b32 v22, 16, v29
    v_and_b32 v23, 0xffff0000, v29
    v_lshlrev_b32 v24, 16, v30
    v_and_b32 v25, 0xffff0000, v30
    v_lshlrev_b32 v26, 16, v31
    v_and_b32 v27, 0xffff0000, v31
    v_mul_f32 v32, s37, v20
    v_mul_f32 v33, s37, v21
    v_mul_f32 v34, s37, v22
    v_mul_f32 v35, s37, v23
    v_mul_f32 v36, s37, v24
    v_mul_f32 v37, s37, v25
    v_mul_f32 v38, s37, v26
    v_mul_f32 v39, s37, v27
    v_exp_f32 v32, v32
    v_exp_f32 v33, v33
    v_exp_f32 v34, v34
    v_exp_f32 v35, v35
    v_exp_f32 v36, v36
    v_exp_f32 v37, v37
    v_exp_f32 v38, v38
    v_exp_f32 v39, v39
    v_add_f32 v32, 1.0, v32
    v_add_f32 v33, 1.0, v33
    v_add_f32 v34, 1.0, v34
    v_add_f32 v35, 1.0, v35
    v_add_f32 v36, 1.0, v36
    v_add_f32 v37, 1.0, v37
    v_add_f32 v38, 1.0, v38
    v_add_f32 v39, 1.0, v39
    v_rcp_f32 v32, v32
    v_rcp_f32 v33, v33
    v_rcp_f32 v34, v34
    v_rcp_f32 v35, v35
    v_rcp_f32 v36, v36
    v_rcp_f32 v37, v37
    v_rcp_f32 v38, v38
    v_rcp_f32 v39, v39
    v_pk_mul_f32 v[20:21], v[20:21], v[32:33]
    v_pk_mul_f32 v[22:23], v[22:23], v[34:35]
    v_pk_mul_f32 v[24:25], v[24:25], v[36:37]
    v_pk_mul_f32 v[26:27], v[26:27], v[38:39]
    v_cvt_pk_bf16_f32 v28, v20, v21
    v_cvt_pk_bf16_f32 v29, v22, v23
    v_cvt_pk_bf16_f32 v30, v24, v25
    v_cvt_pk_bf16_f32 v31, v26, v27
    v_lshlrev_b32 v20, 16, v28
    v_and_b32 v21, 0xffff0000, v28
    v_lshlrev_b32 v22, 16, v29
    v_and_b32 v23, 0xffff0000, v29
    v_lshlrev_b32 v24, 16, v30
    v_and_b32 v25, 0xffff0000, v30
    v_lshlrev_b32 v26, 16, v31
    v_and_b32 v27, 0xffff0000, v31
    v_pk_mul_f32 v[12:13], v[12:13], v[20:21]
    v_pk_mul_f32 v[14:15], v[14:15], v[22:23]
    v_pk_mul_f32 v[16:17], v[16:17], v[24:25]
    v_pk_mul_f32 v[18:19], v[18:19], v[26:27]
    v_cvt_pk_bf16_f32 v28, v12, v13
    v_cvt_pk_bf16_f32 v29, v14, v15
    v_cvt_pk_bf16_f32 v30, v16, v17
    v_cvt_pk_bf16_f32 v31, v18, v19
    v_lshlrev_b32 v12, 16, v28
    v_and_b32 v13, 0xffff0000, v28
    v_lshlrev_b32 v14, 16, v29
    v_and_b32 v15, 0xffff0000, v29
    v_lshlrev_b32 v16, 16, v30
    v_and_b32 v17, 0xffff0000, v30
    v_lshlrev_b32 v18, 16, v31
    v_and_b32 v19, 0xffff0000, v31
    v_lshlrev_b32 v20, 16, v240
    v_and_b32 v21, 0xffff0000, v240
    v_lshlrev_b32 v22, 16, v241
    v_and_b32 v23, 0xffff0000, v241
    v_lshlrev_b32 v24, 16, v242
    v_and_b32 v25, 0xffff0000, v242
    v_lshlrev_b32 v26, 16, v243
    v_and_b32 v27, 0xffff0000, v243
    v_pk_add_f32 v[12:13], v[12:13], v[20:21]
    v_pk_add_f32 v[14:15], v[14:15], v[22:23]
    v_pk_add_f32 v[16:17], v[16:17], v[24:25]
    v_pk_add_f32 v[18:19], v[18:19], v[26:27]
    v_cvt_pk_bf16_f32 v40, v12, v13
    v_cvt_pk_bf16_f32 v41, v14, v15
    v_cvt_pk_bf16_f32 v42, v16, v17
    v_cvt_pk_bf16_f32 v43, v18, v19
    s_mov_b32 s51, 0
    s_nop 0
    v_permlane16_swap_b32 v40, v42
    v_permlane16_swap_b32 v41, v43
    buffer_store_dwordx4 v[40:43], v9, s[72:75], s51 offen offset:0
    v_cvt_pk_bf16_f32 v28, v88, v89
    v_cvt_pk_bf16_f32 v29, v90, v91
    v_cvt_pk_bf16_f32 v30, v92, v93
    v_cvt_pk_bf16_f32 v31, v94, v95
    v_lshlrev_b32 v12, 16, v28
    v_and_b32 v13, 0xffff0000, v28
    v_lshlrev_b32 v14, 16, v29
    v_and_b32 v15, 0xffff0000, v29
    v_lshlrev_b32 v16, 16, v30
    v_and_b32 v17, 0xffff0000, v30
    v_lshlrev_b32 v18, 16, v31
    v_and_b32 v19, 0xffff0000, v31
    v_lshlrev_b32 v20, 16, v116
    v_and_b32 v21, 0xffff0000, v116
    v_lshlrev_b32 v22, 16, v117
    v_and_b32 v23, 0xffff0000, v117
    v_lshlrev_b32 v24, 16, v118
    v_and_b32 v25, 0xffff0000, v118
    v_lshlrev_b32 v26, 16, v119
    v_and_b32 v27, 0xffff0000, v119
    v_pk_add_f32 v[12:13], v[12:13], v[20:21]
    v_pk_add_f32 v[14:15], v[14:15], v[22:23]
    v_pk_add_f32 v[16:17], v[16:17], v[24:25]
    v_pk_add_f32 v[18:19], v[18:19], v[26:27]
    v_cvt_pk_bf16_f32 v28, v12, v13
    v_cvt_pk_bf16_f32 v29, v14, v15
    v_cvt_pk_bf16_f32 v30, v16, v17
    v_cvt_pk_bf16_f32 v31, v18, v19
    v_lshlrev_b32 v12, 16, v28
    v_and_b32 v13, 0xffff0000, v28
    v_lshlrev_b32 v14, 16, v29
    v_and_b32 v15, 0xffff0000, v29
    v_lshlrev_b32 v16, 16, v30
    v_and_b32 v17, 0xffff0000, v30
    v_lshlrev_b32 v18, 16, v31
    v_and_b32 v19, 0xffff0000, v31
    v_lshlrev_b32 v20, 16, v124
    v_and_b32 v21, 0xffff0000, v124
    v_lshlrev_b32 v22, 16, v125
    v_and_b32 v23, 0xffff0000, v125
    v_lshlrev_b32 v24, 16, v126
    v_and_b32 v25, 0xffff0000, v126
    v_lshlrev_b32 v26, 16, v127
    v_and_b32 v27, 0xffff0000, v127
    v_lshlrev_b32 v32, 16, v132
    v_and_b32 v33, 0xffff0000, v132
    v_lshlrev_b32 v34, 16, v133
    v_and_b32 v35, 0xffff0000, v133
    v_lshlrev_b32 v36, 16, v134
    v_and_b32 v37, 0xffff0000, v134
    v_lshlrev_b32 v38, 16, v135
    v_and_b32 v39, 0xffff0000, v135
    v_pk_add_f32 v[20:21], v[20:21], v[32:33]
    v_pk_add_f32 v[22:23], v[22:23], v[34:35]
    v_pk_add_f32 v[24:25], v[24:25], v[36:37]
    v_pk_add_f32 v[26:27], v[26:27], v[38:39]
    v_cvt_pk_bf16_f32 v28, v20, v21
    v_cvt_pk_bf16_f32 v29, v22, v23
    v_cvt_pk_bf16_f32 v30, v24, v25
    v_cvt_pk_bf16_f32 v31, v26, v27
    v_lshlrev_b32 v20, 16, v28
    v_and_b32 v21, 0xffff0000, v28
    v_lshlrev_b32 v22, 16, v29
    v_and_b32 v23, 0xffff0000, v29
    v_lshlrev_b32 v24, 16, v30
    v_and_b32 v25, 0xffff0000, v30
    v_lshlrev_b32 v26, 16, v31
    v_and_b32 v27, 0xffff0000, v31
    v_lshlrev_b32 v28, 16, v76
    v_and_b32 v29, 0xffff0000, v76
    v_lshlrev_b32 v30, 16, v77
    v_and_b32 v31, 0xffff0000, v77
    v_pk_add_f32 v[20:21], v[20:21], v[28:29]
    v_pk_add_f32 v[22:23], v[22:23], v[30:31]
    v_lshlrev_b32 v28, 16, v78
    v_and_b32 v29, 0xffff0000, v78
    v_lshlrev_b32 v30, 16, v79
    v_and_b32 v31, 0xffff0000, v79
    v_pk_add_f32 v[24:25], v[24:25], v[28:29]
    v_pk_add_f32 v[26:27], v[26:27], v[30:31]
    v_cvt_pk_bf16_f32 v28, v20, v21
    v_cvt_pk_bf16_f32 v29, v22, v23
    v_cvt_pk_bf16_f32 v30, v24, v25
    v_cvt_pk_bf16_f32 v31, v26, v27
    v_lshlrev_b32 v20, 16, v28
    v_and_b32 v21, 0xffff0000, v28
    v_lshlrev_b32 v22, 16, v29
    v_and_b32 v23, 0xffff0000, v29
    v_lshlrev_b32 v24, 16, v30
    v_and_b32 v25, 0xffff0000, v30
    v_lshlrev_b32 v26, 16, v31
    v_and_b32 v27, 0xffff0000, v31
    v_mul_f32 v32, s37, v20
    v_mul_f32 v33, s37, v21
    v_mul_f32 v34, s37, v22
    v_mul_f32 v35, s37, v23
    v_mul_f32 v36, s37, v24
    v_mul_f32 v37, s37, v25
    v_mul_f32 v38, s37, v26
    v_mul_f32 v39, s37, v27
    v_exp_f32 v32, v32
    v_exp_f32 v33, v33
    v_exp_f32 v34, v34
    v_exp_f32 v35, v35
    v_exp_f32 v36, v36
    v_exp_f32 v37, v37
    v_exp_f32 v38, v38
    v_exp_f32 v39, v39
    v_add_f32 v32, 1.0, v32
    v_add_f32 v33, 1.0, v33
    v_add_f32 v34, 1.0, v34
    v_add_f32 v35, 1.0, v35
    v_add_f32 v36, 1.0, v36
    v_add_f32 v37, 1.0, v37
    v_add_f32 v38, 1.0, v38
    v_add_f32 v39, 1.0, v39
    v_rcp_f32 v32, v32
    v_rcp_f32 v33, v33
    v_rcp_f32 v34, v34
    v_rcp_f32 v35, v35
    v_rcp_f32 v36, v36
    v_rcp_f32 v37, v37
    v_rcp_f32 v38, v38
    v_rcp_f32 v39, v39
    v_pk_mul_f32 v[20:21], v[20:21], v[32:33]
    v_pk_mul_f32 v[22:23], v[22:23], v[34:35]
    v_pk_mul_f32 v[24:25], v[24:25], v[36:37]
    v_pk_mul_f32 v[26:27], v[26:27], v[38:39]
    v_cvt_pk_bf16_f32 v28, v20, v21
    v_cvt_pk_bf16_f32 v29, v22, v23
    v_cvt_pk_bf16_f32 v30, v24, v25
    v_cvt_pk_bf16_f32 v31, v26, v27
    v_lshlrev_b32 v20, 16, v28
    v_and_b32 v21, 0xffff0000, v28
    v_lshlrev_b32 v22, 16, v29
    v_and_b32 v23, 0xffff0000, v29
    v_lshlrev_b32 v24, 16, v30
    v_and_b32 v25, 0xffff0000, v30
    v_lshlrev_b32 v26, 16, v31
    v_and_b32 v27, 0xffff0000, v31
    v_pk_mul_f32 v[12:13], v[12:13], v[20:21]
    v_pk_mul_f32 v[14:15], v[14:15], v[22:23]
    v_pk_mul_f32 v[16:17], v[16:17], v[24:25]
    v_pk_mul_f32 v[18:19], v[18:19], v[26:27]
    v_cvt_pk_bf16_f32 v28, v12, v13
    v_cvt_pk_bf16_f32 v29, v14, v15
    v_cvt_pk_bf16_f32 v30, v16, v17
    v_cvt_pk_bf16_f32 v31, v18, v19
    v_lshlrev_b32 v12, 16, v28
    v_and_b32 v13, 0xffff0000, v28
    v_lshlrev_b32 v14, 16, v29
    v_and_b32 v15, 0xffff0000, v29
    v_lshlrev_b32 v16, 16, v30
    v_and_b32 v17, 0xffff0000, v30
    v_lshlrev_b32 v18, 16, v31
    v_and_b32 v19, 0xffff0000, v31
    v_lshlrev_b32 v20, 16, v244
    v_and_b32 v21, 0xffff0000, v244
    v_lshlrev_b32 v22, 16, v245
    v_and_b32 v23, 0xffff0000, v245
    v_lshlrev_b32 v24, 16, v246
    v_and_b32 v25, 0xffff0000, v246
    v_lshlrev_b32 v26, 16, v247
    v_and_b32 v27, 0xffff0000, v247
    v_pk_add_f32 v[12:13], v[12:13], v[20:21]
    v_pk_add_f32 v[14:15], v[14:15], v[22:23]
    v_pk_add_f32 v[16:17], v[16:17], v[24:25]
    v_pk_add_f32 v[18:19], v[18:19], v[26:27]
    v_cvt_pk_bf16_f32 v44, v12, v13
    v_cvt_pk_bf16_f32 v45, v14, v15
    v_cvt_pk_bf16_f32 v46, v16, v17
    v_cvt_pk_bf16_f32 v47, v18, v19
    s_mov_b32 s51, 0
    s_nop 0
    v_permlane16_swap_b32 v44, v46
    v_permlane16_swap_b32 v45, v47
    buffer_store_dwordx4 v[44:47], v9, s[72:75], s51 offen offset:64
    s_waitcnt vmcnt(2)
    v_cvt_pk_bf16_f32 v28, v96, v97
    v_cvt_pk_bf16_f32 v29, v98, v99
    v_cvt_pk_bf16_f32 v30, v100, v101
    v_cvt_pk_bf16_f32 v31, v102, v103
    v_lshlrev_b32 v12, 16, v28
    v_and_b32 v13, 0xffff0000, v28
    v_lshlrev_b32 v14, 16, v29
    v_and_b32 v15, 0xffff0000, v29
    v_lshlrev_b32 v16, 16, v30
    v_and_b32 v17, 0xffff0000, v30
    v_lshlrev_b32 v18, 16, v31
    v_and_b32 v19, 0xffff0000, v31
    v_lshlrev_b32 v20, 16, v136
    v_and_b32 v21, 0xffff0000, v136
    v_lshlrev_b32 v22, 16, v137
    v_and_b32 v23, 0xffff0000, v137
    v_lshlrev_b32 v24, 16, v138
    v_and_b32 v25, 0xffff0000, v138
    v_lshlrev_b32 v26, 16, v139
    v_and_b32 v27, 0xffff0000, v139
    v_pk_add_f32 v[12:13], v[12:13], v[20:21]
    v_pk_add_f32 v[14:15], v[14:15], v[22:23]
    v_pk_add_f32 v[16:17], v[16:17], v[24:25]
    v_pk_add_f32 v[18:19], v[18:19], v[26:27]
    v_cvt_pk_bf16_f32 v28, v12, v13
    v_cvt_pk_bf16_f32 v29, v14, v15
    v_cvt_pk_bf16_f32 v30, v16, v17
    v_cvt_pk_bf16_f32 v31, v18, v19
    v_lshlrev_b32 v12, 16, v28
    v_and_b32 v13, 0xffff0000, v28
    v_lshlrev_b32 v14, 16, v29
    v_and_b32 v15, 0xffff0000, v29
    v_lshlrev_b32 v16, 16, v30
    v_and_b32 v17, 0xffff0000, v30
    v_lshlrev_b32 v18, 16, v31
    v_and_b32 v19, 0xffff0000, v31
    v_lshlrev_b32 v20, 16, v144
    v_and_b32 v21, 0xffff0000, v144
    v_lshlrev_b32 v22, 16, v145
    v_and_b32 v23, 0xffff0000, v145
    v_lshlrev_b32 v24, 16, v146
    v_and_b32 v25, 0xffff0000, v146
    v_lshlrev_b32 v26, 16, v147
    v_and_b32 v27, 0xffff0000, v147
    v_lshlrev_b32 v32, 16, v152
    v_and_b32 v33, 0xffff0000, v152
    v_lshlrev_b32 v34, 16, v153
    v_and_b32 v35, 0xffff0000, v153
    v_lshlrev_b32 v36, 16, v154
    v_and_b32 v37, 0xffff0000, v154
    v_lshlrev_b32 v38, 16, v155
    v_and_b32 v39, 0xffff0000, v155
    v_pk_add_f32 v[20:21], v[20:21], v[32:33]
    v_pk_add_f32 v[22:23], v[22:23], v[34:35]
    v_pk_add_f32 v[24:25], v[24:25], v[36:37]
    v_pk_add_f32 v[26:27], v[26:27], v[38:39]
    v_cvt_pk_bf16_f32 v28, v20, v21
    v_cvt_pk_bf16_f32 v29, v22, v23
    v_cvt_pk_bf16_f32 v30, v24, v25
    v_cvt_pk_bf16_f32 v31, v26, v27
    v_lshlrev_b32 v20, 16, v28
    v_and_b32 v21, 0xffff0000, v28
    v_lshlrev_b32 v22, 16, v29
    v_and_b32 v23, 0xffff0000, v29
    v_lshlrev_b32 v24, 16, v30
    v_and_b32 v25, 0xffff0000, v30
    v_lshlrev_b32 v26, 16, v31
    v_and_b32 v27, 0xffff0000, v31
    v_lshlrev_b32 v28, 16, v72
    v_and_b32 v29, 0xffff0000, v72
    v_lshlrev_b32 v30, 16, v73
    v_and_b32 v31, 0xffff0000, v73
    v_pk_add_f32 v[20:21], v[20:21], v[28:29]
    v_pk_add_f32 v[22:23], v[22:23], v[30:31]
    v_lshlrev_b32 v28, 16, v74
    v_and_b32 v29, 0xffff0000, v74
    v_lshlrev_b32 v30, 16, v75
    v_and_b32 v31, 0xffff0000, v75
    v_pk_add_f32 v[24:25], v[24:25], v[28:29]
    v_pk_add_f32 v[26:27], v[26:27], v[30:31]
    v_cvt_pk_bf16_f32 v28, v20, v21
    v_cvt_pk_bf16_f32 v29, v22, v23
    v_cvt_pk_bf16_f32 v30, v24, v25
    v_cvt_pk_bf16_f32 v31, v26, v27
    v_lshlrev_b32 v20, 16, v28
    v_and_b32 v21, 0xffff0000, v28
    v_lshlrev_b32 v22, 16, v29
    v_and_b32 v23, 0xffff0000, v29
    v_lshlrev_b32 v24, 16, v30
    v_and_b32 v25, 0xffff0000, v30
    v_lshlrev_b32 v26, 16, v31
    v_and_b32 v27, 0xffff0000, v31
    v_mul_f32 v32, s37, v20
    v_mul_f32 v33, s37, v21
    v_mul_f32 v34, s37, v22
    v_mul_f32 v35, s37, v23
    v_mul_f32 v36, s37, v24
    v_mul_f32 v37, s37, v25
    v_mul_f32 v38, s37, v26
    v_mul_f32 v39, s37, v27
    v_exp_f32 v32, v32
    v_exp_f32 v33, v33
    v_exp_f32 v34, v34
    v_exp_f32 v35, v35
    v_exp_f32 v36, v36
    v_exp_f32 v37, v37
    v_exp_f32 v38, v38
    v_exp_f32 v39, v39
    v_add_f32 v32, 1.0, v32
    v_add_f32 v33, 1.0, v33
    v_add_f32 v34, 1.0, v34
    v_add_f32 v35, 1.0, v35
    v_add_f32 v36, 1.0, v36
    v_add_f32 v37, 1.0, v37
    v_add_f32 v38, 1.0, v38
    v_add_f32 v39, 1.0, v39
    v_rcp_f32 v32, v32
    v_rcp_f32 v33, v33
    v_rcp_f32 v34, v34
    v_rcp_f32 v35, v35
    v_rcp_f32 v36, v36
    v_rcp_f32 v37, v37
    v_rcp_f32 v38, v38
    v_rcp_f32 v39, v39
    v_pk_mul_f32 v[20:21], v[20:21], v[32:33]
    v_pk_mul_f32 v[22:23], v[22:23], v[34:35]
    v_pk_mul_f32 v[24:25], v[24:25], v[36:37]
    v_pk_mul_f32 v[26:27], v[26:27], v[38:39]
    v_cvt_pk_bf16_f32 v28, v20, v21
    v_cvt_pk_bf16_f32 v29, v22, v23
    v_cvt_pk_bf16_f32 v30, v24, v25
    v_cvt_pk_bf16_f32 v31, v26, v27
    v_lshlrev_b32 v20, 16, v28
    v_and_b32 v21, 0xffff0000, v28
    v_lshlrev_b32 v22, 16, v29
    v_and_b32 v23, 0xffff0000, v29
    v_lshlrev_b32 v24, 16, v30
    v_and_b32 v25, 0xffff0000, v30
    v_lshlrev_b32 v26, 16, v31
    v_and_b32 v27, 0xffff0000, v31
    v_pk_mul_f32 v[12:13], v[12:13], v[20:21]
    v_pk_mul_f32 v[14:15], v[14:15], v[22:23]
    v_pk_mul_f32 v[16:17], v[16:17], v[24:25]
    v_pk_mul_f32 v[18:19], v[18:19], v[26:27]
    v_cvt_pk_bf16_f32 v28, v12, v13
    v_cvt_pk_bf16_f32 v29, v14, v15
    v_cvt_pk_bf16_f32 v30, v16, v17
    v_cvt_pk_bf16_f32 v31, v18, v19
    v_lshlrev_b32 v12, 16, v28
    v_and_b32 v13, 0xffff0000, v28
    v_lshlrev_b32 v14, 16, v29
    v_and_b32 v15, 0xffff0000, v29
    v_lshlrev_b32 v16, 16, v30
    v_and_b32 v17, 0xffff0000, v30
    v_lshlrev_b32 v18, 16, v31
    v_and_b32 v19, 0xffff0000, v31
    v_lshlrev_b32 v20, 16, v248
    v_and_b32 v21, 0xffff0000, v248
    v_lshlrev_b32 v22, 16, v249
    v_and_b32 v23, 0xffff0000, v249
    v_lshlrev_b32 v24, 16, v250
    v_and_b32 v25, 0xffff0000, v250
    v_lshlrev_b32 v26, 16, v251
    v_and_b32 v27, 0xffff0000, v251
    v_pk_add_f32 v[12:13], v[12:13], v[20:21]
    v_pk_add_f32 v[14:15], v[14:15], v[22:23]
    v_pk_add_f32 v[16:17], v[16:17], v[24:25]
    v_pk_add_f32 v[18:19], v[18:19], v[26:27]
    v_cvt_pk_bf16_f32 v48, v12, v13
    v_cvt_pk_bf16_f32 v49, v14, v15
    v_cvt_pk_bf16_f32 v50, v16, v17
    v_cvt_pk_bf16_f32 v51, v18, v19
    s_mov_b32 s51, 32768
    s_nop 0
    v_permlane16_swap_b32 v48, v50
    v_permlane16_swap_b32 v49, v51
    buffer_store_dwordx4 v[48:51], v9, s[72:75], s51 offen offset:0
    v_cvt_pk_bf16_f32 v28, v104, v105
    v_cvt_pk_bf16_f32 v29, v106, v107
    v_cvt_pk_bf16_f32 v30, v108, v109
    v_cvt_pk_bf16_f32 v31, v110, v111
    v_lshlrev_b32 v12, 16, v28
    v_and_b32 v13, 0xffff0000, v28
    v_lshlrev_b32 v14, 16, v29
    v_and_b32 v15, 0xffff0000, v29
    v_lshlrev_b32 v16, 16, v30
    v_and_b32 v17, 0xffff0000, v30
    v_lshlrev_b32 v18, 16, v31
    v_and_b32 v19, 0xffff0000, v31
    v_lshlrev_b32 v20, 16, v140
    v_and_b32 v21, 0xffff0000, v140
    v_lshlrev_b32 v22, 16, v141
    v_and_b32 v23, 0xffff0000, v141
    v_lshlrev_b32 v24, 16, v142
    v_and_b32 v25, 0xffff0000, v142
    v_lshlrev_b32 v26, 16, v143
    v_and_b32 v27, 0xffff0000, v143
    v_pk_add_f32 v[12:13], v[12:13], v[20:21]
    v_pk_add_f32 v[14:15], v[14:15], v[22:23]
    v_pk_add_f32 v[16:17], v[16:17], v[24:25]
    v_pk_add_f32 v[18:19], v[18:19], v[26:27]
    v_cvt_pk_bf16_f32 v28, v12, v13
    v_cvt_pk_bf16_f32 v29, v14, v15
    v_cvt_pk_bf16_f32 v30, v16, v17
    v_cvt_pk_bf16_f32 v31, v18, v19
    v_lshlrev_b32 v12, 16, v28
    v_and_b32 v13, 0xffff0000, v28
    v_lshlrev_b32 v14, 16, v29
    v_and_b32 v15, 0xffff0000, v29
    v_lshlrev_b32 v16, 16, v30
    v_and_b32 v17, 0xffff0000, v30
    v_lshlrev_b32 v18, 16, v31
    v_and_b32 v19, 0xffff0000, v31
    v_lshlrev_b32 v20, 16, v148
    v_and_b32 v21, 0xffff0000, v148
    v_lshlrev_b32 v22, 16, v149
    v_and_b32 v23, 0xffff0000, v149
    v_lshlrev_b32 v24, 16, v150
    v_and_b32 v25, 0xffff0000, v150
    v_lshlrev_b32 v26, 16, v151
    v_and_b32 v27, 0xffff0000, v151
    v_lshlrev_b32 v32, 16, v156
    v_and_b32 v33, 0xffff0000, v156
    v_lshlrev_b32 v34, 16, v157
    v_and_b32 v35, 0xffff0000, v157
    v_lshlrev_b32 v36, 16, v158
    v_and_b32 v37, 0xffff0000, v158
    v_lshlrev_b32 v38, 16, v159
    v_and_b32 v39, 0xffff0000, v159
    v_pk_add_f32 v[20:21], v[20:21], v[32:33]
    v_pk_add_f32 v[22:23], v[22:23], v[34:35]
    v_pk_add_f32 v[24:25], v[24:25], v[36:37]
    v_pk_add_f32 v[26:27], v[26:27], v[38:39]
    v_cvt_pk_bf16_f32 v28, v20, v21
    v_cvt_pk_bf16_f32 v29, v22, v23
    v_cvt_pk_bf16_f32 v30, v24, v25
    v_cvt_pk_bf16_f32 v31, v26, v27
    v_lshlrev_b32 v20, 16, v28
    v_and_b32 v21, 0xffff0000, v28
    v_lshlrev_b32 v22, 16, v29
    v_and_b32 v23, 0xffff0000, v29
    v_lshlrev_b32 v24, 16, v30
    v_and_b32 v25, 0xffff0000, v30
    v_lshlrev_b32 v26, 16, v31
    v_and_b32 v27, 0xffff0000, v31
    v_lshlrev_b32 v28, 16, v76
    v_and_b32 v29, 0xffff0000, v76
    v_lshlrev_b32 v30, 16, v77
    v_and_b32 v31, 0xffff0000, v77
    v_pk_add_f32 v[20:21], v[20:21], v[28:29]
    v_pk_add_f32 v[22:23], v[22:23], v[30:31]
    v_lshlrev_b32 v28, 16, v78
    v_and_b32 v29, 0xffff0000, v78
    v_lshlrev_b32 v30, 16, v79
    v_and_b32 v31, 0xffff0000, v79
    v_pk_add_f32 v[24:25], v[24:25], v[28:29]
    v_pk_add_f32 v[26:27], v[26:27], v[30:31]
    v_cvt_pk_bf16_f32 v28, v20, v21
    v_cvt_pk_bf16_f32 v29, v22, v23
    v_cvt_pk_bf16_f32 v30, v24, v25
    v_cvt_pk_bf16_f32 v31, v26, v27
    v_lshlrev_b32 v20, 16, v28
    v_and_b32 v21, 0xffff0000, v28
    v_lshlrev_b32 v22, 16, v29
    v_and_b32 v23, 0xffff0000, v29
    v_lshlrev_b32 v24, 16, v30
    v_and_b32 v25, 0xffff0000, v30
    v_lshlrev_b32 v26, 16, v31
    v_and_b32 v27, 0xffff0000, v31
    v_mul_f32 v32, s37, v20
    v_mul_f32 v33, s37, v21
    v_mul_f32 v34, s37, v22
    v_mul_f32 v35, s37, v23
    v_mul_f32 v36, s37, v24
    v_mul_f32 v37, s37, v25
    v_mul_f32 v38, s37, v26
    v_mul_f32 v39, s37, v27
    v_exp_f32 v32, v32
    v_exp_f32 v33, v33
    v_exp_f32 v34, v34
    v_exp_f32 v35, v35
    v_exp_f32 v36, v36
    v_exp_f32 v37, v37
    v_exp_f32 v38, v38
    v_exp_f32 v39, v39
    v_add_f32 v32, 1.0, v32
    v_add_f32 v33, 1.0, v33
    v_add_f32 v34, 1.0, v34
    v_add_f32 v35, 1.0, v35
    v_add_f32 v36, 1.0, v36
    v_add_f32 v37, 1.0, v37
    v_add_f32 v38, 1.0, v38
    v_add_f32 v39, 1.0, v39
    v_rcp_f32 v32, v32
    v_rcp_f32 v33, v33
    v_rcp_f32 v34, v34
    v_rcp_f32 v35, v35
    v_rcp_f32 v36, v36
    v_rcp_f32 v37, v37
    v_rcp_f32 v38, v38
    v_rcp_f32 v39, v39
    v_pk_mul_f32 v[20:21], v[20:21], v[32:33]
    v_pk_mul_f32 v[22:23], v[22:23], v[34:35]
    v_pk_mul_f32 v[24:25], v[24:25], v[36:37]
    v_pk_mul_f32 v[26:27], v[26:27], v[38:39]
    v_cvt_pk_bf16_f32 v28, v20, v21
    v_cvt_pk_bf16_f32 v29, v22, v23
    v_cvt_pk_bf16_f32 v30, v24, v25
    v_cvt_pk_bf16_f32 v31, v26, v27
    v_lshlrev_b32 v20, 16, v28
    v_and_b32 v21, 0xffff0000, v28
    v_lshlrev_b32 v22, 16, v29
    v_and_b32 v23, 0xffff0000, v29
    v_lshlrev_b32 v24, 16, v30
    v_and_b32 v25, 0xffff0000, v30
    v_lshlrev_b32 v26, 16, v31
    v_and_b32 v27, 0xffff0000, v31
    v_pk_mul_f32 v[12:13], v[12:13], v[20:21]
    v_pk_mul_f32 v[14:15], v[14:15], v[22:23]
    v_pk_mul_f32 v[16:17], v[16:17], v[24:25]
    v_pk_mul_f32 v[18:19], v[18:19], v[26:27]
    v_cvt_pk_bf16_f32 v28, v12, v13
    v_cvt_pk_bf16_f32 v29, v14, v15
    v_cvt_pk_bf16_f32 v30, v16, v17
    v_cvt_pk_bf16_f32 v31, v18, v19
    v_lshlrev_b32 v12, 16, v28
    v_and_b32 v13, 0xffff0000, v28
    v_lshlrev_b32 v14, 16, v29
    v_and_b32 v15, 0xffff0000, v29
    v_lshlrev_b32 v16, 16, v30
    v_and_b32 v17, 0xffff0000, v30
    v_lshlrev_b32 v18, 16, v31
    v_and_b32 v19, 0xffff0000, v31
    v_lshlrev_b32 v20, 16, v252
    v_and_b32 v21, 0xffff0000, v252
    v_lshlrev_b32 v22, 16, v253
    v_and_b32 v23, 0xffff0000, v253
    v_lshlrev_b32 v24, 16, v254
    v_and_b32 v25, 0xffff0000, v254
    v_lshlrev_b32 v26, 16, v255
    v_and_b32 v27, 0xffff0000, v255
    v_pk_add_f32 v[12:13], v[12:13], v[20:21]
    v_pk_add_f32 v[14:15], v[14:15], v[22:23]
    v_pk_add_f32 v[16:17], v[16:17], v[24:25]
    v_pk_add_f32 v[18:19], v[18:19], v[26:27]
    v_cvt_pk_bf16_f32 v52, v12, v13
    v_cvt_pk_bf16_f32 v53, v14, v15
    v_cvt_pk_bf16_f32 v54, v16, v17
    v_cvt_pk_bf16_f32 v55, v18, v19
    s_mov_b32 s51, 32768
    s_nop 0
    v_permlane16_swap_b32 v52, v54
    v_permlane16_swap_b32 v53, v55
    buffer_store_dwordx4 v[52:55], v9, s[72:75], s51 offen offset:64
    s_endpgm
g2y_e1:
    v_mbcnt_lo_u32_b32 v1, -1, 0
    v_mbcnt_hi_u32_b32 v1, -1, v1
    v_and_b32 v2, 15, v1
    v_lshrrev_b32 v3, 4, v1
    v_lshlrev_b32 v5, 4, v1
    s_add_u32 s12, s28, 33554432
    s_addc_u32 s13, s29, 0
    s_mov_b32 s14, 33554432
    s_mov_b32 s15, 0x20000
    s_lshr_b32 s34, s40, 5
    s_lshr_b32 s35, s41, 7
    s_add_u32 s34, s34, s35
    s_lshl_b32 s34, s34, 4
    s_add_u32 s34, s34, s3
    s_lshl_b32 s34, s34, 15
    s_add_u32 s35, s34, 131072
    s_add_u32 s51, s35, 0
    v_cvt_pk_bf16_f32 v16, v80, v81
    v_cvt_pk_bf16_f32 v17, v82, v83
    v_cvt_pk_bf16_f32 v18, v84, v85
    v_cvt_pk_bf16_f32 v19, v86, v87
    buffer_store_dwordx4 v[16:19], v5, s[12:15], s51 offen offset:0 sc1
    v_cvt_pk_bf16_f32 v20, v88, v89
    v_cvt_pk_bf16_f32 v21, v90, v91
    v_cvt_pk_bf16_f32 v22, v92, v93
    v_cvt_pk_bf16_f32 v23, v94, v95
    buffer_store_dwordx4 v[20:23], v5, s[12:15], s51 offen offset:1024 sc1
    s_add_u32 s51, s35, 4096
    v_cvt_pk_bf16_f32 v24, v96, v97
    v_cvt_pk_bf16_f32 v25, v98, v99
    v_cvt_pk_bf16_f32 v26, v100, v101
    v_cvt_pk_bf16_f32 v27, v102, v103
    buffer_store_dwordx4 v[24:27], v5, s[12:15], s51 offen offset:0 sc1
    v_cvt_pk_bf16_f32 v28, v104, v105
    v_cvt_pk_bf16_f32 v29, v106, v107
    v_cvt_pk_bf16_f32 v30, v108, v109
    v_cvt_pk_bf16_f32 v31, v110, v111
    buffer_store_dwordx4 v[28:31], v5, s[12:15], s51 offen offset:1024 sc1
    s_add_u32 s51, s35, 16384
    v_cvt_pk_bf16_f32 v16, v144, v145
    v_cvt_pk_bf16_f32 v17, v146, v147
    v_cvt_pk_bf16_f32 v18, v148, v149
    v_cvt_pk_bf16_f32 v19, v150, v151
    buffer_store_dwordx4 v[16:19], v5, s[12:15], s51 offen offset:0 sc1
    v_cvt_pk_bf16_f32 v20, v152, v153
    v_cvt_pk_bf16_f32 v21, v154, v155
    v_cvt_pk_bf16_f32 v22, v156, v157
    v_cvt_pk_bf16_f32 v23, v158, v159
    buffer_store_dwordx4 v[20:23], v5, s[12:15], s51 offen offset:1024 sc1
    s_add_u32 s51, s35, 20480
    v_cvt_pk_bf16_f32 v24, v160, v161
    v_cvt_pk_bf16_f32 v25, v162, v163
    v_cvt_pk_bf16_f32 v26, v164, v165
    v_cvt_pk_bf16_f32 v27, v166, v167
    buffer_store_dwordx4 v[24:27], v5, s[12:15], s51 offen offset:0 sc1
    v_cvt_pk_bf16_f32 v28, v168, v169
    v_cvt_pk_bf16_f32 v29, v170, v171
    v_cvt_pk_bf16_f32 v30, v172, v173
    v_cvt_pk_bf16_f32 v31, v174, v175
    buffer_store_dwordx4 v[28:31], v5, s[12:15], s51 offen offset:1024 sc1
    s_add_u32 s51, s35, 24576
    v_cvt_pk_bf16_f32 v32, v176, v177
    v_cvt_pk_bf16_f32 v33, v178, v179
    v_cvt_pk_bf16_f32 v34, v180, v181
    v_cvt_pk_bf16_f32 v35, v182, v183
    buffer_store_dwordx4 v[32:35], v5, s[12:15], s51 offen offset:0 sc1
    v_cvt_pk_bf16_f32 v36, v184, v185
    v_cvt_pk_bf16_f32 v37, v186, v187
    v_cvt_pk_bf16_f32 v38, v188, v189
    v_cvt_pk_bf16_f32 v39, v190, v191
    buffer_store_dwordx4 v[36:39], v5, s[12:15], s51 offen offset:1024 sc1
    s_add_u32 s51, s35, 28672
    v_cvt_pk_bf16_f32 v40, v192, v193
    v_cvt_pk_bf16_f32 v41, v194, v195
    v_cvt_pk_bf16_f32 v42, v196, v197
    v_cvt_pk_bf16_f32 v43, v198, v199
    buffer_store_dwordx4 v[40:43], v5, s[12:15], s51 offen offset:0 sc1
    v_cvt_pk_bf16_f32 v44, v200, v201
    v_cvt_pk_bf16_f32 v45, v202, v203
    v_cvt_pk_bf16_f32 v46, v204, v205
    v_cvt_pk_bf16_f32 v47, v206, v207
    buffer_store_dwordx4 v[44:47], v5, s[12:15], s51 offen offset:1024 sc1
    s_lshr_b32 s36, s34, 12
    s_and_b32 s36, s36, 0xff80
    s_add_u32 s36, s36, 8192
    s_add_u32 s37, s36, 4
    s_waitcnt vmcnt(0)
    v_mov_b32 v0, 155660
    v_mov_b32 v1, 1
    s_mov_b64 exec, 1
    ds_add_rtn_u32 v1, v0, v1
    s_waitcnt lgkmcnt(0)
    v_cmp_eq_u32 vcc, 3, v1
    s_cbranch_vccz sig_c1
    v_mov_b32 v0, 0
    v_mov_b32 v1, s95
    buffer_store_dword v1, v0, s[96:99], s37 offen sc1
sig_c1:
    s_mov_b64 exec, -1
    s_load_dwordx2 s[20:21], s[0:1], 0
    s_load_dwordx4 s[24:27], s[0:1], 72
    v_mbcnt_lo_u32_b32 v1, -1, 0
    v_mbcnt_hi_u32_b32 v1, -1, v1
    s_lshr_b32 s49, s3, 1
    s_lshl_b32 s49, s49, 7
    s_add_u32 s49, s49, s40
    s_add_u32 s49, s49, 32
    s_and_b32 s50, s3, 1
    s_lshl_b32 s50, s50, 6
    s_add_u32 s50, s50, s41
    v_add_u32 v6, s49, v2
    v_lshlrev_b32 v6, 11, v6
    v_lshl_add_u32 v7, v3, 2, s50
    v_lshlrev_b32 v7, 1, v7
    v_add_u32 v8, v6, v7
    v_and_b32 v4, 1, v3
    v_lshlrev_b32 v4, 4, v4
    v_lshrrev_b32 v9, 1, v3
    v_lshl_add_u32 v4, v9, 3, v4
    v_add_u32 v4, s50, v4
    v_lshl_add_u32 v9, v4, 1, v6
    v_and_b32 v10, 3, v1
    v_lshl_add_u32 v10, v10, 2, s36
    s_waitcnt lgkmcnt(0)
    s_mov_b32 s64, s20
    s_mov_b32 s65, s21
    s_mov_b32 s66, 4194304
    s_mov_b32 s67, 0x20000
    s_mov_b32 s68, s24
    s_mov_b32 s69, s25
    s_mov_b32 s70, 2048
    s_mov_b32 s71, 0x20000
    s_mov_b32 s72, s26
    s_mov_b32 s73, s27
    s_mov_b32 s74, 4194304
    s_mov_b32 s75, 0x20000
    buffer_load_dwordx2 v[240:241], v8, s[64:67], 0 offen offset:0
    buffer_load_dwordx2 v[242:243], v8, s[64:67], 0 offen offset:32
    buffer_load_dwordx2 v[244:245], v8, s[64:67], 0 offen offset:64
    buffer_load_dwordx2 v[246:247], v8, s[64:67], 0 offen offset:96
    v_add_u32 v12, 0x8000, v8
    buffer_load_dwordx2 v[248:249], v12, s[64:67], 0 offen offset:0
    buffer_load_dwordx2 v[250:251], v12, s[64:67], 0 offen offset:32
    buffer_load_dwordx2 v[252:253], v12, s[64:67], 0 offen offset:64
    buffer_load_dwordx2 v[254:255], v12, s[64:67], 0 offen offset:96
    buffer_load_dwordx2 v[72:73], v7, s[68:71], 0 offen offset:0
    buffer_load_dwordx2 v[74:75], v7, s[68:71], 0 offen offset:32
    buffer_load_dwordx2 v[76:77], v7, s[68:71], 0 offen offset:64
    buffer_load_dwordx2 v[78:79], v7, s[68:71], 0 offen offset:96
    s_mov_b32 s51, 200000
poll_c1:
    buffer_load_dword v11, v10, s[96:99], 0 offen sc1
    s_waitcnt vmcnt(0)
    v_cmp_ne_u32 vcc, s95, v11
    s_cbranch_vccz polld_c1
    s_sleep 1
    s_sub_u32 s51, s51, 1
    s_cmp_lg_u32 s51, 0
    s_cbranch_scc1 poll_c1
polld_c1:
    s_add_u32 s51, s34, 8192
    buffer_load_dwordx4 v[80:83], v5, s[12:15], s51 offen offset:0 sc1
    buffer_load_dwordx4 v[84:87], v5, s[12:15], s51 offen offset:1024 sc1
    s_add_u32 s51, s34, 270336
    buffer_load_dwordx4 v[88:91], v5, s[12:15], s51 offen offset:0 sc1
    buffer_load_dwordx4 v[92:95], v5, s[12:15], s51 offen offset:1024 sc1
    s_add_u32 s51, s34, 401408
    buffer_load_dwordx4 v[96:99], v5, s[12:15], s51 offen offset:0 sc1
    buffer_load_dwordx4 v[100:103], v5, s[12:15], s51 offen offset:1024 sc1
    s_add_u32 s51, s34, 12288
    buffer_load_dwordx4 v[104:107], v5, s[12:15], s51 offen offset:0 sc1
    buffer_load_dwordx4 v[108:111], v5, s[12:15], s51 offen offset:1024 sc1
    s_add_u32 s51, s34, 274432
    buffer_load_dwordx4 v[144:147], v5, s[12:15], s51 offen offset:0 sc1
    buffer_load_dwordx4 v[148:151], v5, s[12:15], s51 offen offset:1024 sc1
    s_add_u32 s51, s34, 405504
    buffer_load_dwordx4 v[152:155], v5, s[12:15], s51 offen offset:0 sc1
    buffer_load_dwordx4 v[156:159], v5, s[12:15], s51 offen offset:1024 sc1
    s_mov_b32 s37, 0xbfb8aa3b
    s_waitcnt vmcnt(6)
    v_lshlrev_b32 v12, 16, v80
    v_and_b32 v13, 0xffff0000, v80
    v_lshlrev_b32 v14, 16, v81
    v_and_b32 v15, 0xffff0000, v81
    v_lshlrev_b32 v16, 16, v82
    v_and_b32 v17, 0xffff0000, v82
    v_lshlrev_b32 v18, 16, v83
    v_and_b32 v19, 0xffff0000, v83
    v_cvt_pk_bf16_f32 v28, v112, v113
    v_cvt_pk_bf16_f32 v29, v114, v115
    v_cvt_pk_bf16_f32 v30, v116, v117
    v_cvt_pk_bf16_f32 v31, v118, v119
    v_lshlrev_b32 v20, 16, v28
    v_and_b32 v21, 0xffff0000, v28
    v_lshlrev_b32 v22, 16, v29
    v_and_b32 v23, 0xffff0000, v29
    v_lshlrev_b32 v24, 16, v30
    v_and_b32 v25, 0xffff0000, v30
    v_lshlrev_b32 v26, 16, v31
    v_and_b32 v27, 0xffff0000, v31
    v_pk_add_f32 v[12:13], v[12:13], v[20:21]
    v_pk_add_f32 v[14:15], v[14:15], v[22:23]
    v_pk_add_f32 v[16:17], v[16:17], v[24:25]
    v_pk_add_f32 v[18:19], v[18:19], v[26:27]
    v_cvt_pk_bf16_f32 v28, v12, v13
    v_cvt_pk_bf16_f32 v29, v14, v15
    v_cvt_pk_bf16_f32 v30, v16, v17
    v_cvt_pk_bf16_f32 v31, v18, v19
    v_lshlrev_b32 v12, 16, v28
    v_and_b32 v13, 0xffff0000, v28
    v_lshlrev_b32 v14, 16, v29
    v_and_b32 v15, 0xffff0000, v29
    v_lshlrev_b32 v16, 16, v30
    v_and_b32 v17, 0xffff0000, v30
    v_lshlrev_b32 v18, 16, v31
    v_and_b32 v19, 0xffff0000, v31
    v_lshlrev_b32 v20, 16, v88
    v_and_b32 v21, 0xffff0000, v88
    v_lshlrev_b32 v22, 16, v89
    v_and_b32 v23, 0xffff0000, v89
    v_lshlrev_b32 v24, 16, v90
    v_and_b32 v25, 0xffff0000, v90
    v_lshlrev_b32 v26, 16, v91
    v_and_b32 v27, 0xffff0000, v91
    v_lshlrev_b32 v32, 16, v96
    v_and_b32 v33, 0xffff0000, v96
    v_lshlrev_b32 v34, 16, v97
    v_and_b32 v35, 0xffff0000, v97
    v_lshlrev_b32 v36, 16, v98
    v_and_b32 v37, 0xffff0000, v98
    v_lshlrev_b32 v38, 16, v99
    v_and_b32 v39, 0xffff0000, v99
    v_pk_add_f32 v[20:21], v[20:21], v[32:33]
    v_pk_add_f32 v[22:23], v[22:23], v[34:35]
    v_pk_add_f32 v[24:25], v[24:25], v[36:37]
    v_pk_add_f32 v[26:27], v[26:27], v[38:39]
    v_cvt_pk_bf16_f32 v28, v20, v21
    v_cvt_pk_bf16_f32 v29, v22, v23
    v_cvt_pk_bf16_f32 v30, v24, v25
    v_cvt_pk_bf16_f32 v31, v26, v27
    v_lshlrev_b32 v20, 16, v28
    v_and_b32 v21, 0xffff0000, v28
    v_lshlrev_b32 v22, 16, v29
    v_and_b32 v23, 0xffff0000, v29
    v_lshlrev_b32 v24, 16, v30
    v_and_b32 v25, 0xffff0000, v30
    v_lshlrev_b32 v26, 16, v31
    v_and_b32 v27, 0xffff0000, v31
    v_lshlrev_b32 v28, 16, v72
    v_and_b32 v29, 0xffff0000, v72
    v_lshlrev_b32 v30, 16, v73
    v_and_b32 v31, 0xffff0000, v73
    v_pk_add_f32 v[20:21], v[20:21], v[28:29]
    v_pk_add_f32 v[22:23], v[22:23], v[30:31]
    v_lshlrev_b32 v28, 16, v74
    v_and_b32 v29, 0xffff0000, v74
    v_lshlrev_b32 v30, 16, v75
    v_and_b32 v31, 0xffff0000, v75
    v_pk_add_f32 v[24:25], v[24:25], v[28:29]
    v_pk_add_f32 v[26:27], v[26:27], v[30:31]
    v_cvt_pk_bf16_f32 v28, v20, v21
    v_cvt_pk_bf16_f32 v29, v22, v23
    v_cvt_pk_bf16_f32 v30, v24, v25
    v_cvt_pk_bf16_f32 v31, v26, v27
    v_lshlrev_b32 v20, 16, v28
    v_and_b32 v21, 0xffff0000, v28
    v_lshlrev_b32 v22, 16, v29
    v_and_b32 v23, 0xffff0000, v29
    v_lshlrev_b32 v24, 16, v30
    v_and_b32 v25, 0xffff0000, v30
    v_lshlrev_b32 v26, 16, v31
    v_and_b32 v27, 0xffff0000, v31
    v_mul_f32 v32, s37, v20
    v_mul_f32 v33, s37, v21
    v_mul_f32 v34, s37, v22
    v_mul_f32 v35, s37, v23
    v_mul_f32 v36, s37, v24
    v_mul_f32 v37, s37, v25
    v_mul_f32 v38, s37, v26
    v_mul_f32 v39, s37, v27
    v_exp_f32 v32, v32
    v_exp_f32 v33, v33
    v_exp_f32 v34, v34
    v_exp_f32 v35, v35
    v_exp_f32 v36, v36
    v_exp_f32 v37, v37
    v_exp_f32 v38, v38
    v_exp_f32 v39, v39
    v_add_f32 v32, 1.0, v32
    v_add_f32 v33, 1.0, v33
    v_add_f32 v34, 1.0, v34
    v_add_f32 v35, 1.0, v35
    v_add_f32 v36, 1.0, v36
    v_add_f32 v37, 1.0, v37
    v_add_f32 v38, 1.0, v38
    v_add_f32 v39, 1.0, v39
    v_rcp_f32 v32, v32
    v_rcp_f32 v33, v33
    v_rcp_f32 v34, v34
    v_rcp_f32 v35, v35
    v_rcp_f32 v36, v36
    v_rcp_f32 v37, v37
    v_rcp_f32 v38, v38
    v_rcp_f32 v39, v39
    v_pk_mul_f32 v[20:21], v[20:21], v[32:33]
    v_pk_mul_f32 v[22:23], v[22:23], v[34:35]
    v_pk_mul_f32 v[24:25], v[24:25], v[36:37]
    v_pk_mul_f32 v[26:27], v[26:27], v[38:39]
    v_cvt_pk_bf16_f32 v28, v20, v21
    v_cvt_pk_bf16_f32 v29, v22, v23
    v_cvt_pk_bf16_f32 v30, v24, v25
    v_cvt_pk_bf16_f32 v31, v26, v27
    v_lshlrev_b32 v20, 16, v28
    v_and_b32 v21, 0xffff0000, v28
    v_lshlrev_b32 v22, 16, v29
    v_and_b32 v23, 0xffff0000, v29
    v_lshlrev_b32 v24, 16, v30
    v_and_b32 v25, 0xffff0000, v30
    v_lshlrev_b32 v26, 16, v31
    v_and_b32 v27, 0xffff0000, v31
    v_pk_mul_f32 v[12:13], v[12:13], v[20:21]
    v_pk_mul_f32 v[14:15], v[14:15], v[22:23]
    v_pk_mul_f32 v[16:17], v[16:17], v[24:25]
    v_pk_mul_f32 v[18:19], v[18:19], v[26:27]
    v_cvt_pk_bf16_f32 v28, v12, v13
    v_cvt_pk_bf16_f32 v29, v14, v15
    v_cvt_pk_bf16_f32 v30, v16, v17
    v_cvt_pk_bf16_f32 v31, v18, v19
    v_lshlrev_b32 v12, 16, v28
    v_and_b32 v13, 0xffff0000, v28
    v_lshlrev_b32 v14, 16, v29
    v_and_b32 v15, 0xffff0000, v29
    v_lshlrev_b32 v16, 16, v30
    v_and_b32 v17, 0xffff0000, v30
    v_lshlrev_b32 v18, 16, v31
    v_and_b32 v19, 0xffff0000, v31
    v_lshlrev_b32 v20, 16, v240
    v_and_b32 v21, 0xffff0000, v240
    v_lshlrev_b32 v22, 16, v241
    v_and_b32 v23, 0xffff0000, v241
    v_lshlrev_b32 v24, 16, v242
    v_and_b32 v25, 0xffff0000, v242
    v_lshlrev_b32 v26, 16, v243
    v_and_b32 v27, 0xffff0000, v243
    v_pk_add_f32 v[12:13], v[12:13], v[20:21]
    v_pk_add_f32 v[14:15], v[14:15], v[22:23]
    v_pk_add_f32 v[16:17], v[16:17], v[24:25]
    v_pk_add_f32 v[18:19], v[18:19], v[26:27]
    v_cvt_pk_bf16_f32 v40, v12, v13
    v_cvt_pk_bf16_f32 v41, v14, v15
    v_cvt_pk_bf16_f32 v42, v16, v17
    v_cvt_pk_bf16_f32 v43, v18, v19
    s_mov_b32 s51, 0
    s_nop 0
    v_permlane16_swap_b32 v40, v42
    v_permlane16_swap_b32 v41, v43
    buffer_store_dwordx4 v[40:43], v9, s[72:75], s51 offen offset:0
    v_lshlrev_b32 v12, 16, v84
    v_and_b32 v13, 0xffff0000, v84
    v_lshlrev_b32 v14, 16, v85
    v_and_b32 v15, 0xffff0000, v85
    v_lshlrev_b32 v16, 16, v86
    v_and_b32 v17, 0xffff0000, v86
    v_lshlrev_b32 v18, 16, v87
    v_and_b32 v19, 0xffff0000, v87
    v_cvt_pk_bf16_f32 v28, v120, v121
    v_cvt_pk_bf16_f32 v29, v122, v123
    v_cvt_pk_bf16_f32 v30, v124, v125
    v_cvt_pk_bf16_f32 v31, v126, v127
    v_lshlrev_b32 v20, 16, v28
    v_and_b32 v21, 0xffff0000, v28
    v_lshlrev_b32 v22, 16, v29
    v_and_b32 v23, 0xffff0000, v29
    v_lshlrev_b32 v24, 16, v30
    v_and_b32 v25, 0xffff0000, v30
    v_lshlrev_b32 v26, 16, v31
    v_and_b32 v27, 0xffff0000, v31
    v_pk_add_f32 v[12:13], v[12:13], v[20:21]
    v_pk_add_f32 v[14:15], v[14:15], v[22:23]
    v_pk_add_f32 v[16:17], v[16:17], v[24:25]
    v_pk_add_f32 v[18:19], v[18:19], v[26:27]
    v_cvt_pk_bf16_f32 v28, v12, v13
    v_cvt_pk_bf16_f32 v29, v14, v15
    v_cvt_pk_bf16_f32 v30, v16, v17
    v_cvt_pk_bf16_f32 v31, v18, v19
    v_lshlrev_b32 v12, 16, v28
    v_and_b32 v13, 0xffff0000, v28
    v_lshlrev_b32 v14, 16, v29
    v_and_b32 v15, 0xffff0000, v29
    v_lshlrev_b32 v16, 16, v30
    v_and_b32 v17, 0xffff0000, v30
    v_lshlrev_b32 v18, 16, v31
    v_and_b32 v19, 0xffff0000, v31
    v_lshlrev_b32 v20, 16, v92
    v_and_b32 v21, 0xffff0000, v92
    v_lshlrev_b32 v22, 16, v93
    v_and_b32 v23, 0xffff0000, v93
    v_lshlrev_b32 v24, 16, v94
    v_and_b32 v25, 0xffff0000, v94
    v_lshlrev_b32 v26, 16, v95
    v_and_b32 v27, 0xffff0000, v95
    v_lshlrev_b32 v32, 16, v100
    v_and_b32 v33, 0xffff0000, v100
    v_lshlrev_b32 v34, 16, v101
    v_and_b32 v35, 0xffff0000, v101
    v_lshlrev_b32 v36, 16, v102
    v_and_b32 v37, 0xffff0000, v102
    v_lshlrev_b32 v38, 16, v103
    v_and_b32 v39, 0xffff0000, v103
    v_pk_add_f32 v[20:21], v[20:21], v[32:33]
    v_pk_add_f32 v[22:23], v[22:23], v[34:35]
    v_pk_add_f32 v[24:25], v[24:25], v[36:37]
    v_pk_add_f32 v[26:27], v[26:27], v[38:39]
    v_cvt_pk_bf16_f32 v28, v20, v21
    v_cvt_pk_bf16_f32 v29, v22, v23
    v_cvt_pk_bf16_f32 v30, v24, v25
    v_cvt_pk_bf16_f32 v31, v26, v27
    v_lshlrev_b32 v20, 16, v28
    v_and_b32 v21, 0xffff0000, v28
    v_lshlrev_b32 v22, 16, v29
    v_and_b32 v23, 0xffff0000, v29
    v_lshlrev_b32 v24, 16, v30
    v_and_b32 v25, 0xffff0000, v30
    v_lshlrev_b32 v26, 16, v31
    v_and_b32 v27, 0xffff0000, v31
    v_lshlrev_b32 v28, 16, v76
    v_and_b32 v29, 0xffff0000, v76
    v_lshlrev_b32 v30, 16, v77
    v_and_b32 v31, 0xffff0000, v77
    v_pk_add_f32 v[20:21], v[20:21], v[28:29]
    v_pk_add_f32 v[22:23], v[22:23], v[30:31]
    v_lshlrev_b32 v28, 16, v78
    v_and_b32 v29, 0xffff0000, v78
    v_lshlrev_b32 v30, 16, v79
    v_and_b32 v31, 0xffff0000, v79
    v_pk_add_f32 v[24:25], v[24:25], v[28:29]
    v_pk_add_f32 v[26:27], v[26:27], v[30:31]
    v_cvt_pk_bf16_f32 v28, v20, v21
    v_cvt_pk_bf16_f32 v29, v22, v23
    v_cvt_pk_bf16_f32 v30, v24, v25
    v_cvt_pk_bf16_f32 v31, v26, v27
    v_lshlrev_b32 v20, 16, v28
    v_and_b32 v21, 0xffff0000, v28
    v_lshlrev_b32 v22, 16, v29
    v_and_b32 v23, 0xffff0000, v29
    v_lshlrev_b32 v24, 16, v30
    v_and_b32 v25, 0xffff0000, v30
    v_lshlrev_b32 v26, 16, v31
    v_and_b32 v27, 0xffff0000, v31
    v_mul_f32 v32, s37, v20
    v_mul_f32 v33, s37, v21
    v_mul_f32 v34, s37, v22
    v_mul_f32 v35, s37, v23
    v_mul_f32 v36, s37, v24
    v_mul_f32 v37, s37, v25
    v_mul_f32 v38, s37, v26
    v_mul_f32 v39, s37, v27
    v_exp_f32 v32, v32
    v_exp_f32 v33, v33
    v_exp_f32 v34, v34
    v_exp_f32 v35, v35
    v_exp_f32 v36, v36
    v_exp_f32 v37, v37
    v_exp_f32 v38, v38
    v_exp_f32 v39, v39
    v_add_f32 v32, 1.0, v32
    v_add_f32 v33, 1.0, v33
    v_add_f32 v34, 1.0, v34
    v_add_f32 v35, 1.0, v35
    v_add_f32 v36, 1.0, v36
    v_add_f32 v37, 1.0, v37
    v_add_f32 v38, 1.0, v38
    v_add_f32 v39, 1.0, v39
    v_rcp_f32 v32, v32
    v_rcp_f32 v33, v33
    v_rcp_f32 v34, v34
    v_rcp_f32 v35, v35
    v_rcp_f32 v36, v36
    v_rcp_f32 v37, v37
    v_rcp_f32 v38, v38
    v_rcp_f32 v39, v39
    v_pk_mul_f32 v[20:21], v[20:21], v[32:33]
    v_pk_mul_f32 v[22:23], v[22:23], v[34:35]
    v_pk_mul_f32 v[24:25], v[24:25], v[36:37]
    v_pk_mul_f32 v[26:27], v[26:27], v[38:39]
    v_cvt_pk_bf16_f32 v28, v20, v21
    v_cvt_pk_bf16_f32 v29, v22, v23
    v_cvt_pk_bf16_f32 v30, v24, v25
    v_cvt_pk_bf16_f32 v31, v26, v27
    v_lshlrev_b32 v20, 16, v28
    v_and_b32 v21, 0xffff0000, v28
    v_lshlrev_b32 v22, 16, v29
    v_and_b32 v23, 0xffff0000, v29
    v_lshlrev_b32 v24, 16, v30
    v_and_b32 v25, 0xffff0000, v30
    v_lshlrev_b32 v26, 16, v31
    v_and_b32 v27, 0xffff0000, v31
    v_pk_mul_f32 v[12:13], v[12:13], v[20:21]
    v_pk_mul_f32 v[14:15], v[14:15], v[22:23]
    v_pk_mul_f32 v[16:17], v[16:17], v[24:25]
    v_pk_mul_f32 v[18:19], v[18:19], v[26:27]
    v_cvt_pk_bf16_f32 v28, v12, v13
    v_cvt_pk_bf16_f32 v29, v14, v15
    v_cvt_pk_bf16_f32 v30, v16, v17
    v_cvt_pk_bf16_f32 v31, v18, v19
    v_lshlrev_b32 v12, 16, v28
    v_and_b32 v13, 0xffff0000, v28
    v_lshlrev_b32 v14, 16, v29
    v_and_b32 v15, 0xffff0000, v29
    v_lshlrev_b32 v16, 16, v30
    v_and_b32 v17, 0xffff0000, v30
    v_lshlrev_b32 v18, 16, v31
    v_and_b32 v19, 0xffff0000, v31
    v_lshlrev_b32 v20, 16, v244
    v_and_b32 v21, 0xffff0000, v244
    v_lshlrev_b32 v22, 16, v245
    v_and_b32 v23, 0xffff0000, v245
    v_lshlrev_b32 v24, 16, v246
    v_and_b32 v25, 0xffff0000, v246
    v_lshlrev_b32 v26, 16, v247
    v_and_b32 v27, 0xffff0000, v247
    v_pk_add_f32 v[12:13], v[12:13], v[20:21]
    v_pk_add_f32 v[14:15], v[14:15], v[22:23]
    v_pk_add_f32 v[16:17], v[16:17], v[24:25]
    v_pk_add_f32 v[18:19], v[18:19], v[26:27]
    v_cvt_pk_bf16_f32 v44, v12, v13
    v_cvt_pk_bf16_f32 v45, v14, v15
    v_cvt_pk_bf16_f32 v46, v16, v17
    v_cvt_pk_bf16_f32 v47, v18, v19
    s_mov_b32 s51, 0
    s_nop 0
    v_permlane16_swap_b32 v44, v46
    v_permlane16_swap_b32 v45, v47
    buffer_store_dwordx4 v[44:47], v9, s[72:75], s51 offen offset:64
    s_waitcnt vmcnt(2)
    v_lshlrev_b32 v12, 16, v104
    v_and_b32 v13, 0xffff0000, v104
    v_lshlrev_b32 v14, 16, v105
    v_and_b32 v15, 0xffff0000, v105
    v_lshlrev_b32 v16, 16, v106
    v_and_b32 v17, 0xffff0000, v106
    v_lshlrev_b32 v18, 16, v107
    v_and_b32 v19, 0xffff0000, v107
    v_cvt_pk_bf16_f32 v28, v128, v129
    v_cvt_pk_bf16_f32 v29, v130, v131
    v_cvt_pk_bf16_f32 v30, v132, v133
    v_cvt_pk_bf16_f32 v31, v134, v135
    v_lshlrev_b32 v20, 16, v28
    v_and_b32 v21, 0xffff0000, v28
    v_lshlrev_b32 v22, 16, v29
    v_and_b32 v23, 0xffff0000, v29
    v_lshlrev_b32 v24, 16, v30
    v_and_b32 v25, 0xffff0000, v30
    v_lshlrev_b32 v26, 16, v31
    v_and_b32 v27, 0xffff0000, v31
    v_pk_add_f32 v[12:13], v[12:13], v[20:21]
    v_pk_add_f32 v[14:15], v[14:15], v[22:23]
    v_pk_add_f32 v[16:17], v[16:17], v[24:25]
    v_pk_add_f32 v[18:19], v[18:19], v[26:27]
    v_cvt_pk_bf16_f32 v28, v12, v13
    v_cvt_pk_bf16_f32 v29, v14, v15
    v_cvt_pk_bf16_f32 v30, v16, v17
    v_cvt_pk_bf16_f32 v31, v18, v19
    v_lshlrev_b32 v12, 16, v28
    v_and_b32 v13, 0xffff0000, v28
    v_lshlrev_b32 v14, 16, v29
    v_and_b32 v15, 0xffff0000, v29
    v_lshlrev_b32 v16, 16, v30
    v_and_b32 v17, 0xffff0000, v30
    v_lshlrev_b32 v18, 16, v31
    v_and_b32 v19, 0xffff0000, v31
    v_lshlrev_b32 v20, 16, v144
    v_and_b32 v21, 0xffff0000, v144
    v_lshlrev_b32 v22, 16, v145
    v_and_b32 v23, 0xffff0000, v145
    v_lshlrev_b32 v24, 16, v146
    v_and_b32 v25, 0xffff0000, v146
    v_lshlrev_b32 v26, 16, v147
    v_and_b32 v27, 0xffff0000, v147
    v_lshlrev_b32 v32, 16, v152
    v_and_b32 v33, 0xffff0000, v152
    v_lshlrev_b32 v34, 16, v153
    v_and_b32 v35, 0xffff0000, v153
    v_lshlrev_b32 v36, 16, v154
    v_and_b32 v37, 0xffff0000, v154
    v_lshlrev_b32 v38, 16, v155
    v_and_b32 v39, 0xffff0000, v155
    v_pk_add_f32 v[20:21], v[20:21], v[32:33]
    v_pk_add_f32 v[22:23], v[22:23], v[34:35]
    v_pk_add_f32 v[24:25], v[24:25], v[36:37]
    v_pk_add_f32 v[26:27], v[26:27], v[38:39]
    v_cvt_pk_bf16_f32 v28, v20, v21
    v_cvt_pk_bf16_f32 v29, v22, v23
    v_cvt_pk_bf16_f32 v30, v24, v25
    v_cvt_pk_bf16_f32 v31, v26, v27
    v_lshlrev_b32 v20, 16, v28
    v_and_b32 v21, 0xffff0000, v28
    v_lshlrev_b32 v22, 16, v29
    v_and_b32 v23, 0xffff0000, v29
    v_lshlrev_b32 v24, 16, v30
    v_and_b32 v25, 0xffff0000, v30
    v_lshlrev_b32 v26, 16, v31
    v_and_b32 v27, 0xffff0000, v31
    v_lshlrev_b32 v28, 16, v72
    v_and_b32 v29, 0xffff0000, v72
    v_lshlrev_b32 v30, 16, v73
    v_and_b32 v31, 0xffff0000, v73
    v_pk_add_f32 v[20:21], v[20:21], v[28:29]
    v_pk_add_f32 v[22:23], v[22:23], v[30:31]
    v_lshlrev_b32 v28, 16, v74
    v_and_b32 v29, 0xffff0000, v74
    v_lshlrev_b32 v30, 16, v75
    v_and_b32 v31, 0xffff0000, v75
    v_pk_add_f32 v[24:25], v[24:25], v[28:29]
    v_pk_add_f32 v[26:27], v[26:27], v[30:31]
    v_cvt_pk_bf16_f32 v28, v20, v21
    v_cvt_pk_bf16_f32 v29, v22, v23
    v_cvt_pk_bf16_f32 v30, v24, v25
    v_cvt_pk_bf16_f32 v31, v26, v27
    v_lshlrev_b32 v20, 16, v28
    v_and_b32 v21, 0xffff0000, v28
    v_lshlrev_b32 v22, 16, v29
    v_and_b32 v23, 0xffff0000, v29
    v_lshlrev_b32 v24, 16, v30
    v_and_b32 v25, 0xffff0000, v30
    v_lshlrev_b32 v26, 16, v31
    v_and_b32 v27, 0xffff0000, v31
    v_mul_f32 v32, s37, v20
    v_mul_f32 v33, s37, v21
    v_mul_f32 v34, s37, v22
    v_mul_f32 v35, s37, v23
    v_mul_f32 v36, s37, v24
    v_mul_f32 v37, s37, v25
    v_mul_f32 v38, s37, v26
    v_mul_f32 v39, s37, v27
    v_exp_f32 v32, v32
    v_exp_f32 v33, v33
    v_exp_f32 v34, v34
    v_exp_f32 v35, v35
    v_exp_f32 v36, v36
    v_exp_f32 v37, v37
    v_exp_f32 v38, v38
    v_exp_f32 v39, v39
    v_add_f32 v32, 1.0, v32
    v_add_f32 v33, 1.0, v33
    v_add_f32 v34, 1.0, v34
    v_add_f32 v35, 1.0, v35
    v_add_f32 v36, 1.0, v36
    v_add_f32 v37, 1.0, v37
    v_add_f32 v38, 1.0, v38
    v_add_f32 v39, 1.0, v39
    v_rcp_f32 v32, v32
    v_rcp_f32 v33, v33
    v_rcp_f32 v34, v34
    v_rcp_f32 v35, v35
    v_rcp_f32 v36, v36
    v_rcp_f32 v37, v37
    v_rcp_f32 v38, v38
    v_rcp_f32 v39, v39
    v_pk_mul_f32 v[20:21], v[20:21], v[32:33]
    v_pk_mul_f32 v[22:23], v[22:23], v[34:35]
    v_pk_mul_f32 v[24:25], v[24:25], v[36:37]
    v_pk_mul_f32 v[26:27], v[26:27], v[38:39]
    v_cvt_pk_bf16_f32 v28, v20, v21
    v_cvt_pk_bf16_f32 v29, v22, v23
    v_cvt_pk_bf16_f32 v30, v24, v25
    v_cvt_pk_bf16_f32 v31, v26, v27
    v_lshlrev_b32 v20, 16, v28
    v_and_b32 v21, 0xffff0000, v28
    v_lshlrev_b32 v22, 16, v29
    v_and_b32 v23, 0xffff0000, v29
    v_lshlrev_b32 v24, 16, v30
    v_and_b32 v25, 0xffff0000, v30
    v_lshlrev_b32 v26, 16, v31
    v_and_b32 v27, 0xffff0000, v31
    v_pk_mul_f32 v[12:13], v[12:13], v[20:21]
    v_pk_mul_f32 v[14:15], v[14:15], v[22:23]
    v_pk_mul_f32 v[16:17], v[16:17], v[24:25]
    v_pk_mul_f32 v[18:19], v[18:19], v[26:27]
    v_cvt_pk_bf16_f32 v28, v12, v13
    v_cvt_pk_bf16_f32 v29, v14, v15
    v_cvt_pk_bf16_f32 v30, v16, v17
    v_cvt_pk_bf16_f32 v31, v18, v19
    v_lshlrev_b32 v12, 16, v28
    v_and_b32 v13, 0xffff0000, v28
    v_lshlrev_b32 v14, 16, v29
    v_and_b32 v15, 0xffff0000, v29
    v_lshlrev_b32 v16, 16, v30
    v_and_b32 v17, 0xffff0000, v30
    v_lshlrev_b32 v18, 16, v31
    v_and_b32 v19, 0xffff0000, v31
    v_lshlrev_b32 v20, 16, v248
    v_and_b32 v21, 0xffff0000, v248
    v_lshlrev_b32 v22, 16, v249
    v_and_b32 v23, 0xffff0000, v249
    v_lshlrev_b32 v24, 16, v250
    v_and_b32 v25, 0xffff0000, v250
    v_lshlrev_b32 v26, 16, v251
    v_and_b32 v27, 0xffff0000, v251
    v_pk_add_f32 v[12:13], v[12:13], v[20:21]
    v_pk_add_f32 v[14:15], v[14:15], v[22:23]
    v_pk_add_f32 v[16:17], v[16:17], v[24:25]
    v_pk_add_f32 v[18:19], v[18:19], v[26:27]
    v_cvt_pk_bf16_f32 v48, v12, v13
    v_cvt_pk_bf16_f32 v49, v14, v15
    v_cvt_pk_bf16_f32 v50, v16, v17
    v_cvt_pk_bf16_f32 v51, v18, v19
    s_mov_b32 s51, 32768
    s_nop 0
    v_permlane16_swap_b32 v48, v50
    v_permlane16_swap_b32 v49, v51
    buffer_store_dwordx4 v[48:51], v9, s[72:75], s51 offen offset:0
    v_lshlrev_b32 v12, 16, v108
    v_and_b32 v13, 0xffff0000, v108
    v_lshlrev_b32 v14, 16, v109
    v_and_b32 v15, 0xffff0000, v109
    v_lshlrev_b32 v16, 16, v110
    v_and_b32 v17, 0xffff0000, v110
    v_lshlrev_b32 v18, 16, v111
    v_and_b32 v19, 0xffff0000, v111
    v_cvt_pk_bf16_f32 v28, v136, v137
    v_cvt_pk_bf16_f32 v29, v138, v139
    v_cvt_pk_bf16_f32 v30, v140, v141
    v_cvt_pk_bf16_f32 v31, v142, v143
    v_lshlrev_b32 v20, 16, v28
    v_and_b32 v21, 0xffff0000, v28
    v_lshlrev_b32 v22, 16, v29
    v_and_b32 v23, 0xffff0000, v29
    v_lshlrev_b32 v24, 16, v30
    v_and_b32 v25, 0xffff0000, v30
    v_lshlrev_b32 v26, 16, v31
    v_and_b32 v27, 0xffff0000, v31
    v_pk_add_f32 v[12:13], v[12:13], v[20:21]
    v_pk_add_f32 v[14:15], v[14:15], v[22:23]
    v_pk_add_f32 v[16:17], v[16:17], v[24:25]
    v_pk_add_f32 v[18:19], v[18:19], v[26:27]
    v_cvt_pk_bf16_f32 v28, v12, v13
    v_cvt_pk_bf16_f32 v29, v14, v15
    v_cvt_pk_bf16_f32 v30, v16, v17
    v_cvt_pk_bf16_f32 v31, v18, v19
    v_lshlrev_b32 v12, 16, v28
    v_and_b32 v13, 0xffff0000, v28
    v_lshlrev_b32 v14, 16, v29
    v_and_b32 v15, 0xffff0000, v29
    v_lshlrev_b32 v16, 16, v30
    v_and_b32 v17, 0xffff0000, v30
    v_lshlrev_b32 v18, 16, v31
    v_and_b32 v19, 0xffff0000, v31
    v_lshlrev_b32 v20, 16, v148
    v_and_b32 v21, 0xffff0000, v148
    v_lshlrev_b32 v22, 16, v149
    v_and_b32 v23, 0xffff0000, v149
    v_lshlrev_b32 v24, 16, v150
    v_and_b32 v25, 0xffff0000, v150
    v_lshlrev_b32 v26, 16, v151
    v_and_b32 v27, 0xffff0000, v151
    v_lshlrev_b32 v32, 16, v156
    v_and_b32 v33, 0xffff0000, v156
    v_lshlrev_b32 v34, 16, v157
    v_and_b32 v35, 0xffff0000, v157
    v_lshlrev_b32 v36, 16, v158
    v_and_b32 v37, 0xffff0000, v158
    v_lshlrev_b32 v38, 16, v159
    v_and_b32 v39, 0xffff0000, v159
    v_pk_add_f32 v[20:21], v[20:21], v[32:33]
    v_pk_add_f32 v[22:23], v[22:23], v[34:35]
    v_pk_add_f32 v[24:25], v[24:25], v[36:37]
    v_pk_add_f32 v[26:27], v[26:27], v[38:39]
    v_cvt_pk_bf16_f32 v28, v20, v21
    v_cvt_pk_bf16_f32 v29, v22, v23
    v_cvt_pk_bf16_f32 v30, v24, v25
    v_cvt_pk_bf16_f32 v31, v26, v27
    v_lshlrev_b32 v20, 16, v28
    v_and_b32 v21, 0xffff0000, v28
    v_lshlrev_b32 v22, 16, v29
    v_and_b32 v23, 0xffff0000, v29
    v_lshlrev_b32 v24, 16, v30
    v_and_b32 v25, 0xffff0000, v30
    v_lshlrev_b32 v26, 16, v31
    v_and_b32 v27, 0xffff0000, v31
    v_lshlrev_b32 v28, 16, v76
    v_and_b32 v29, 0xffff0000, v76
    v_lshlrev_b32 v30, 16, v77
    v_and_b32 v31, 0xffff0000, v77
    v_pk_add_f32 v[20:21], v[20:21], v[28:29]
    v_pk_add_f32 v[22:23], v[22:23], v[30:31]
    v_lshlrev_b32 v28, 16, v78
    v_and_b32 v29, 0xffff0000, v78
    v_lshlrev_b32 v30, 16, v79
    v_and_b32 v31, 0xffff0000, v79
    v_pk_add_f32 v[24:25], v[24:25], v[28:29]
    v_pk_add_f32 v[26:27], v[26:27], v[30:31]
    v_cvt_pk_bf16_f32 v28, v20, v21
    v_cvt_pk_bf16_f32 v29, v22, v23
    v_cvt_pk_bf16_f32 v30, v24, v25
    v_cvt_pk_bf16_f32 v31, v26, v27
    v_lshlrev_b32 v20, 16, v28
    v_and_b32 v21, 0xffff0000, v28
    v_lshlrev_b32 v22, 16, v29
    v_and_b32 v23, 0xffff0000, v29
    v_lshlrev_b32 v24, 16, v30
    v_and_b32 v25, 0xffff0000, v30
    v_lshlrev_b32 v26, 16, v31
    v_and_b32 v27, 0xffff0000, v31
    v_mul_f32 v32, s37, v20
    v_mul_f32 v33, s37, v21
    v_mul_f32 v34, s37, v22
    v_mul_f32 v35, s37, v23
    v_mul_f32 v36, s37, v24
    v_mul_f32 v37, s37, v25
    v_mul_f32 v38, s37, v26
    v_mul_f32 v39, s37, v27
    v_exp_f32 v32, v32
    v_exp_f32 v33, v33
    v_exp_f32 v34, v34
    v_exp_f32 v35, v35
    v_exp_f32 v36, v36
    v_exp_f32 v37, v37
    v_exp_f32 v38, v38
    v_exp_f32 v39, v39
    v_add_f32 v32, 1.0, v32
    v_add_f32 v33, 1.0, v33
    v_add_f32 v34, 1.0, v34
    v_add_f32 v35, 1.0, v35
    v_add_f32 v36, 1.0, v36
    v_add_f32 v37, 1.0, v37
    v_add_f32 v38, 1.0, v38
    v_add_f32 v39, 1.0, v39
    v_rcp_f32 v32, v32
    v_rcp_f32 v33, v33
    v_rcp_f32 v34, v34
    v_rcp_f32 v35, v35
    v_rcp_f32 v36, v36
    v_rcp_f32 v37, v37
    v_rcp_f32 v38, v38
    v_rcp_f32 v39, v39
    v_pk_mul_f32 v[20:21], v[20:21], v[32:33]
    v_pk_mul_f32 v[22:23], v[22:23], v[34:35]
    v_pk_mul_f32 v[24:25], v[24:25], v[36:37]
    v_pk_mul_f32 v[26:27], v[26:27], v[38:39]
    v_cvt_pk_bf16_f32 v28, v20, v21
    v_cvt_pk_bf16_f32 v29, v22, v23
    v_cvt_pk_bf16_f32 v30, v24, v25
    v_cvt_pk_bf16_f32 v31, v26, v27
    v_lshlrev_b32 v20, 16, v28
    v_and_b32 v21, 0xffff0000, v28
    v_lshlrev_b32 v22, 16, v29
    v_and_b32 v23, 0xffff0000, v29
    v_lshlrev_b32 v24, 16, v30
    v_and_b32 v25, 0xffff0000, v30
    v_lshlrev_b32 v26, 16, v31
    v_and_b32 v27, 0xffff0000, v31
    v_pk_mul_f32 v[12:13], v[12:13], v[20:21]
    v_pk_mul_f32 v[14:15], v[14:15], v[22:23]
    v_pk_mul_f32 v[16:17], v[16:17], v[24:25]
    v_pk_mul_f32 v[18:19], v[18:19], v[26:27]
    v_cvt_pk_bf16_f32 v28, v12, v13
    v_cvt_pk_bf16_f32 v29, v14, v15
    v_cvt_pk_bf16_f32 v30, v16, v17
    v_cvt_pk_bf16_f32 v31, v18, v19
    v_lshlrev_b32 v12, 16, v28
    v_and_b32 v13, 0xffff0000, v28
    v_lshlrev_b32 v14, 16, v29
    v_and_b32 v15, 0xffff0000, v29
    v_lshlrev_b32 v16, 16, v30
    v_and_b32 v17, 0xffff0000, v30
    v_lshlrev_b32 v18, 16, v31
    v_and_b32 v19, 0xffff0000, v31
    v_lshlrev_b32 v20, 16, v252
    v_and_b32 v21, 0xffff0000, v252
    v_lshlrev_b32 v22, 16, v253
    v_and_b32 v23, 0xffff0000, v253
    v_lshlrev_b32 v24, 16, v254
    v_and_b32 v25, 0xffff0000, v254
    v_lshlrev_b32 v26, 16, v255
    v_and_b32 v27, 0xffff0000, v255
    v_pk_add_f32 v[12:13], v[12:13], v[20:21]
    v_pk_add_f32 v[14:15], v[14:15], v[22:23]
    v_pk_add_f32 v[16:17], v[16:17], v[24:25]
    v_pk_add_f32 v[18:19], v[18:19], v[26:27]
    v_cvt_pk_bf16_f32 v52, v12, v13
    v_cvt_pk_bf16_f32 v53, v14, v15
    v_cvt_pk_bf16_f32 v54, v16, v17
    v_cvt_pk_bf16_f32 v55, v18, v19
    s_mov_b32 s51, 32768
    s_nop 0
    v_permlane16_swap_b32 v52, v54
    v_permlane16_swap_b32 v53, v55
    buffer_store_dwordx4 v[52:55], v9, s[72:75], s51 offen offset:64
    s_endpgm
g2o_cstart:
    s_and_b32 s33, s30, 1
    s_sub_u32 s60, 31, s33
    v_mov_b32 v24, v1
    s_lshr_b32 s49, s3, 1
    s_mul_i32 s49, s49, 16384
    s_and_b32 s50, s3, 1
    v_and_b32 v8, 15, v24
    v_lshrrev_b32 v9, 4, v24
    v_lshrrev_b32 v10, 3, v8
    v_lshrrev_b32 v11, 2, v8
    v_and_b32 v11, 1, v11
    v_xor_b32 v11, v11, v10
    v_lshl_add_u32 v11, v11, 1, v10
    v_xor_b32 v11, v11, v9
    v_lshlrev_b32 v11, 4, v11
    v_lshl_add_u32 v19, v8, 6, v11
    v_lshl_add_u32 v11, v10, 10, v11
    v_and_b32 v10, 7, v8
    v_lshl_add_u32 v10, v10, 6, v11
    v_lshrrev_b32 v12, 2, v24
    v_and_b32 v12, 3, v12
    v_and_b32 v13, 3, v24
    v_lshl_add_u32 v14, v9, 3, v12
    v_mul_u32_u24 v14, 256, v14
    v_lshl_add_u32 v14, v13, 3, v14
    v_add_u32 v14, 32768, v14
    v_and_b32 v15, 1, v9
    v_lshl_add_u32 v15, v15, 2, v12
    s_mul_i32 s51, s50, 4
    v_xor_b32 v15, s51, v15
    v_lshl_add_u32 v14, v15, 5, v14
    v_xor_b32 v1, 0, v14
    v_xor_b32 v2, 32, v14
    v_xor_b32 v3, 64, v14
    v_xor_b32 v4, 96, v14
    v_add_u32 v0, s49, v19
    v_mov_b32 v80, 0
    v_mov_b32 v81, 0
    v_mov_b32 v82, 0
    v_mov_b32 v83, 0
    v_mov_b32 v84, 0
    v_mov_b32 v85, 0
    v_mov_b32 v86, 0
    v_mov_b32 v87, 0
    v_mov_b32 v88, 0
    v_mov_b32 v89, 0
    v_mov_b32 v90, 0
    v_mov_b32 v91, 0
    v_mov_b32 v92, 0
    v_mov_b32 v93, 0
    v_mov_b32 v94, 0
    v_mov_b32 v95, 0
    v_mov_b32 v96, 0
    v_mov_b32 v97, 0
    v_mov_b32 v98, 0
    v_mov_b32 v99, 0
    v_mov_b32 v100, 0
    v_mov_b32 v101, 0
    v_mov_b32 v102, 0
    v_mov_b32 v103, 0
    v_mov_b32 v104, 0
    v_mov_b32 v105, 0
    v_mov_b32 v106, 0
    v_mov_b32 v107, 0
    v_mov_b32 v108, 0
    v_mov_b32 v109, 0
    v_mov_b32 v110, 0
    v_mov_b32 v111, 0
    v_mov_b32 v112, 0
    v_mov_b32 v113, 0
    v_mov_b32 v114, 0
    v_mov_b32 v115, 0
    v_mov_b32 v116, 0
    v_mov_b32 v117, 0
    v_mov_b32 v118, 0
    v_mov_b32 v119, 0
    v_mov_b32 v120, 0
    v_mov_b32 v121, 0
    v_mov_b32 v122, 0
    v_mov_b32 v123, 0
    v_mov_b32 v124, 0
    v_mov_b32 v125, 0
    v_mov_b32 v126, 0
    v_mov_b32 v127, 0
    v_mov_b32 v128, 0
    v_mov_b32 v129, 0
    v_mov_b32 v130, 0
    v_mov_b32 v131, 0
    v_mov_b32 v132, 0
    v_mov_b32 v133, 0
    v_mov_b32 v134, 0
    v_mov_b32 v135, 0
    v_mov_b32 v136, 0
    v_mov_b32 v137, 0
    v_mov_b32 v138, 0
    v_mov_b32 v139, 0
    v_mov_b32 v140, 0
    v_mov_b32 v141, 0
    v_mov_b32 v142, 0
    v_mov_b32 v143, 0
    v_mov_b32 v144, 0
    v_mov_b32 v145, 0
    v_mov_b32 v146, 0
    v_mov_b32 v147, 0
    v_mov_b32 v148, 0
    v_mov_b32 v149, 0
    v_mov_b32 v150, 0
    v_mov_b32 v151, 0
    v_mov_b32 v152, 0
    v_mov_b32 v153, 0
    v_mov_b32 v154, 0
    v_mov_b32 v155, 0
    v_mov_b32 v156, 0
    v_mov_b32 v157, 0
    v_mov_b32 v158, 0
    v_mov_b32 v159, 0
    v_mov_b32 v160, 0
    v_mov_b32 v161, 0
    v_mov_b32 v162, 0
    v_mov_b32 v163, 0
    v_mov_b32 v164, 0
    v_mov_b32 v165, 0
    v_mov_b32 v166, 0
    v_mov_b32 v167, 0
    v_mov_b32 v168, 0
    v_mov_b32 v169, 0
    v_mov_b32 v170, 0
    v_mov_b32 v171, 0
    v_mov_b32 v172, 0
    v_mov_b32 v173, 0
    v_mov_b32 v174, 0
    v_mov_b32 v175, 0
    v_mov_b32 v176, 0
    v_mov_b32 v177, 0
    v_mov_b32 v178, 0
    v_mov_b32 v179, 0
    v_mov_b32 v180, 0
    v_mov_b32 v181, 0
    v_mov_b32 v182, 0
    v_mov_b32 v183, 0
    v_mov_b32 v184, 0
    v_mov_b32 v185, 0
    v_mov_b32 v186, 0
    v_mov_b32 v187, 0
    v_mov_b32 v188, 0
    v_mov_b32 v189, 0
    v_mov_b32 v190, 0
    v_mov_b32 v191, 0
    v_mov_b32 v192, 0
    v_mov_b32 v193, 0
    v_mov_b32 v194, 0
    v_mov_b32 v195, 0
    v_mov_b32 v196, 0
    v_mov_b32 v197, 0
    v_mov_b32 v198, 0
    v_mov_b32 v199, 0
    v_mov_b32 v200, 0
    v_mov_b32 v201, 0
    v_mov_b32 v202, 0
    v_mov_b32 v203, 0
    v_mov_b32 v204, 0
    v_mov_b32 v205, 0
    v_mov_b32 v206, 0
    v_mov_b32 v207, 0
    s_mov_b32 s47, 0
    s_mov_b32 s88, 49152
    s_mov_b32 s48, 49152
    s_barrier
    ds_read_b64_tr_b16 v[40:41], v1 offset:0
    ds_read_b64_tr_b16 v[42:43], v1 offset:1024
    ds_read_b64_tr_b16 v[44:45], v2 offset:0
    ds_read_b64_tr_b16 v[46:47], v2 offset:1024
    ds_read_b64_tr_b16 v[48:49], v3 offset:0
    ds_read_b64_tr_b16 v[50:51], v3 offset:1024
    ds_read_b64_tr_b16 v[52:53], v4 offset:0
    ds_read_b64_tr_b16 v[54:55], v4 offset:1024
    ds_read_b128 v[8:11], v0 offset:0
    ds_read_b128 v[12:15], v0 offset:2048
    ds_read_b128 v[16:19], v0 offset:4096
    ds_read_b128 v[20:23], v0 offset:6144
    ds_read_b128 v[24:27], v0 offset:8192
    ds_read_b128 v[28:31], v0 offset:10240
    ds_read_b128 v[32:35], v0 offset:12288
    ds_read_b128 v[36:39], v0 offset:14336
    s_mov_b32 s45, s60
    s_waitcnt lgkmcnt(0)
    s_branch g2o_mid
g2o_stub:
    s_waitcnt vmcnt(0)
    v_mov_b32 v72, 155656
    v_mov_b32 v73, 1
    s_mov_b64 exec, 1
    ds_add_rtn_u32 v73, v72, v73
    s_waitcnt lgkmcnt(0)
    v_cmp_eq_u32 vcc, 3, v73
    s_cbranch_vccz sig_dg2o
    v_mov_b32 v72, 0
    v_mov_b32 v73, s95
    buffer_store_dword v73, v72, s[96:99], s75 offen sc1
    buffer_store_dword v73, v72, s[96:99], s74 offen sc1
sig_dg2o:
    s_mov_b64 exec, -1
    s_branch g2o_stubret
.p2align 6
g2o_top:
    v_mfma_f32_16x16x32_bf16 v[136:139], v[64:67], v[20:23], v[136:139]
    ds_read_b64_tr_b16 v[42:43], v1 offset:1024
    v_mfma_f32_16x16x32_bf16 v[140:143], v[68:71], v[20:23], v[140:143]
    ds_read_b64_tr_b16 v[44:45], v2 offset:0
    v_mfma_f32_16x16x32_bf16 v[144:147], v[56:59], v[24:27], v[144:147]
    ds_read_b64_tr_b16 v[46:47], v2 offset:1024
    v_mfma_f32_16x16x32_bf16 v[148:151], v[60:63], v[24:27], v[148:151]
    ds_read_b64_tr_b16 v[48:49], v3 offset:0
    v_mfma_f32_16x16x32_bf16 v[152:155], v[64:67], v[24:27], v[152:155]
    ds_read_b64_tr_b16 v[50:51], v3 offset:1024
    v_mfma_f32_16x16x32_bf16 v[156:159], v[68:71], v[24:27], v[156:159]
    ds_read_b64_tr_b16 v[52:53], v4 offset:0
    v_mfma_f32_16x16x32_bf16 v[160:163], v[56:59], v[28:31], v[160:163]
    ds_read_b64_tr_b16 v[54:55], v4 offset:1024
    v_mfma_f32_16x16x32_bf16 v[164:167], v[60:63], v[28:31], v[164:167]
    ds_read_b128 v[8:11], v0 offset:0
    v_mfma_f32_16x16x32_bf16 v[168:171], v[64:67], v[28:31], v[168:171]
    ds_read_b128 v[12:15], v0 offset:2048
    v_mfma_f32_16x16x32_bf16 v[172:175], v[68:71], v[28:31], v[172:175]
    ds_read_b128 v[16:19], v0 offset:4096
    v_mfma_f32_16x16x32_bf16 v[176:179], v[56:59], v[32:35], v[176:179]
    ds_read_b128 v[20:23], v0 offset:6144
    v_mfma_f32_16x16x32_bf16 v[180:183], v[60:63], v[32:35], v[180:183]
    ds_read_b128 v[24:27], v0 offset:8192
    v_mfma_f32_16x16x32_bf16 v[184:187], v[64:67], v[32:35], v[184:187]
    ds_read_b128 v[28:31], v0 offset:10240
    v_mfma_f32_16x16x32_bf16 v[188:191], v[68:71], v[32:35], v[188:191]
    ds_read_b128 v[32:35], v0 offset:12288
    v_mfma_f32_16x16x32_bf16 v[192:195], v[56:59], v[36:39], v[192:195]
    v_mfma_f32_16x16x32_bf16 v[196:199], v[60:63], v[36:39], v[196:199]
    v_mfma_f32_16x16x32_bf16 v[200:203], v[64:67], v[36:39], v[200:203]
    v_mfma_f32_16x16x32_bf16 v[204:207], v[68:71], v[36:39], v[204:207]
g2o_mid:
    ds_read_b128 v[36:39], v0 offset:14336
    s_waitcnt lgkmcnt(7)
    v_mfma_f32_16x16x32_bf16 v[80:83], v[40:43], v[8:11], v[80:83]
    ds_read_b64_tr_b16 v[56:57], v1 offset:8192
    v_mfma_f32_16x16x32_bf16 v[84:87], v[44:47], v[8:11], v[84:87]
    ds_read_b64_tr_b16 v[58:59], v1 offset:9216
    v_mfma_f32_16x16x32_bf16 v[88:91], v[48:51], v[8:11], v[88:91]
    ds_read_b64_tr_b16 v[60:61], v2 offset:8192
    v_mfma_f32_16x16x32_bf16 v[92:95], v[52:55], v[8:11], v[92:95]
    ds_read_b64_tr_b16 v[62:63], v2 offset:9216
    s_waitcnt lgkmcnt(10)
    v_mfma_f32_16x16x32_bf16 v[96:99], v[40:43], v[12:15], v[96:99]
    ds_read_b64_tr_b16 v[64:65], v3 offset:8192
    v_mfma_f32_16x16x32_bf16 v[100:103], v[44:47], v[12:15], v[100:103]
    ds_read_b64_tr_b16 v[66:67], v3 offset:9216
    v_mfma_f32_16x16x32_bf16 v[104:107], v[48:51], v[12:15], v[104:107]
    ds_read_b64_tr_b16 v[68:69], v4 offset:8192
    v_mfma_f32_16x16x32_bf16 v[108:111], v[52:55], v[12:15], v[108:111]
    ds_read_b64_tr_b16 v[70:71], v4 offset:9216
    s_waitcnt lgkmcnt(13)
    v_mfma_f32_16x16x32_bf16 v[112:115], v[40:43], v[16:19], v[112:115]
    ds_read_b128 v[8:11], v0 offset:1024
    v_mfma_f32_16x16x32_bf16 v[116:119], v[44:47], v[16:19], v[116:119]
    ds_read_b128 v[12:15], v0 offset:3072
    v_mfma_f32_16x16x32_bf16 v[120:123], v[48:51], v[16:19], v[120:123]
    s_add_u32 s47, s47, 49152
    s_cmp_ge_u32 s47, 147456
    v_mfma_f32_16x16x32_bf16 v[124:127], v[52:55], v[16:19], v[124:127]
    ds_read_b128 v[16:19], v0 offset:5120
    s_waitcnt lgkmcnt(15)
    v_mfma_f32_16x16x32_bf16 v[128:131], v[40:43], v[20:23], v[128:131]
    s_cselect_b32 s47, 0, s47
    s_cselect_b32 s48, 4294868992, s88
    v_mfma_f32_16x16x32_bf16 v[132:135], v[44:47], v[20:23], v[132:135]
    s_cmp_eq_u32 s45, s94
    s_cbranch_scc1 g2o_stub
g2o_stubret:
    v_mfma_f32_16x16x32_bf16 v[136:139], v[48:51], v[20:23], v[136:139]
    v_mfma_f32_16x16x32_bf16 v[140:143], v[52:55], v[20:23], v[140:143]
    ds_read_b128 v[20:23], v0 offset:7168
    s_waitcnt lgkmcnt(15)
    v_mfma_f32_16x16x32_bf16 v[144:147], v[40:43], v[24:27], v[144:147]
    v_mfma_f32_16x16x32_bf16 v[148:151], v[44:47], v[24:27], v[148:151]
    v_mfma_f32_16x16x32_bf16 v[152:155], v[48:51], v[24:27], v[152:155]
    v_mfma_f32_16x16x32_bf16 v[156:159], v[52:55], v[24:27], v[156:159]
    ds_read_b128 v[24:27], v0 offset:9216
    s_waitcnt lgkmcnt(15)
    v_mfma_f32_16x16x32_bf16 v[160:163], v[40:43], v[28:31], v[160:163]
    v_mfma_f32_16x16x32_bf16 v[164:167], v[44:47], v[28:31], v[164:167]
    v_mfma_f32_16x16x32_bf16 v[168:171], v[48:51], v[28:31], v[168:171]
    v_mfma_f32_16x16x32_bf16 v[172:175], v[52:55], v[28:31], v[172:175]
    ds_read_b128 v[28:31], v0 offset:11264
    s_waitcnt lgkmcnt(15)
    v_mfma_f32_16x16x32_bf16 v[176:179], v[40:43], v[32:35], v[176:179]
    v_mfma_f32_16x16x32_bf16 v[180:183], v[44:47], v[32:35], v[180:183]
    v_mfma_f32_16x16x32_bf16 v[184:187], v[48:51], v[32:35], v[184:187]
    v_mfma_f32_16x16x32_bf16 v[188:191], v[52:55], v[32:35], v[188:191]
    ds_read_b128 v[32:35], v0 offset:13312
    s_waitcnt lgkmcnt(15)
    v_mfma_f32_16x16x32_bf16 v[192:195], v[40:43], v[36:39], v[192:195]
    v_mfma_f32_16x16x32_bf16 v[196:199], v[44:47], v[36:39], v[196:199]
    v_mfma_f32_16x16x32_bf16 v[200:203], v[48:51], v[36:39], v[200:203]
    v_mfma_f32_16x16x32_bf16 v[204:207], v[52:55], v[36:39], v[204:207]
    ds_read_b128 v[36:39], v0 offset:15360
    s_waitcnt lgkmcnt(7)
    v_mfma_f32_16x16x32_bf16 v[80:83], v[56:59], v[8:11], v[80:83]
    v_mfma_f32_16x16x32_bf16 v[84:87], v[60:63], v[8:11], v[84:87]
    v_mfma_f32_16x16x32_bf16 v[88:91], v[64:67], v[8:11], v[88:91]
    v_mfma_f32_16x16x32_bf16 v[92:95], v[68:71], v[8:11], v[92:95]
    s_waitcnt lgkmcnt(6)
    v_mfma_f32_16x16x32_bf16 v[96:99], v[56:59], v[12:15], v[96:99]
    v_mfma_f32_16x16x32_bf16 v[100:103], v[60:63], v[12:15], v[100:103]
    v_mfma_f32_16x16x32_bf16 v[104:107], v[64:67], v[12:15], v[104:107]
    v_mfma_f32_16x16x32_bf16 v[108:111], v[68:71], v[12:15], v[108:111]
    s_waitcnt lgkmcnt(0)
    s_barrier
    v_mfma_f32_16x16x32_bf16 v[112:115], v[56:59], v[16:19], v[112:115]
    v_add_u32 v0, s48, v0
    v_add_u32 v1, s48, v1
    v_mfma_f32_16x16x32_bf16 v[116:119], v[60:63], v[16:19], v[116:119]
    v_add_u32 v2, s48, v2
    v_add_u32 v3, s48, v3
    v_mfma_f32_16x16x32_bf16 v[120:123], v[64:67], v[16:19], v[120:123]
    v_add_u32 v4, s48, v4
    v_mfma_f32_16x16x32_bf16 v[124:127], v[68:71], v[16:19], v[124:127]
    ds_read_b64_tr_b16 v[40:41], v1 offset:0
    v_mfma_f32_16x16x32_bf16 v[128:131], v[56:59], v[20:23], v[128:131]
    s_sub_u32 s45, s45, 1
    s_cmp_lg_u32 s45, 0
    v_mfma_f32_16x16x32_bf16 v[132:135], v[60:63], v[20:23], v[132:135]
    s_cbranch_scc1 g2o_top
    v_mfma_f32_16x16x32_bf16 v[136:139], v[64:67], v[20:23], v[136:139]
    v_mfma_f32_16x16x32_bf16 v[140:143], v[68:71], v[20:23], v[140:143]
    v_mfma_f32_16x16x32_bf16 v[144:147], v[56:59], v[24:27], v[144:147]
    v_mfma_f32_16x16x32_bf16 v[148:151], v[60:63], v[24:27], v[148:151]
    v_mfma_f32_16x16x32_bf16 v[152:155], v[64:67], v[24:27], v[152:155]
    v_mfma_f32_16x16x32_bf16 v[156:159], v[68:71], v[24:27], v[156:159]
    v_mfma_f32_16x16x32_bf16 v[160:163], v[56:59], v[28:31], v[160:163]
    v_mfma_f32_16x16x32_bf16 v[164:167], v[60:63], v[28:31], v[164:167]
    v_mfma_f32_16x16x32_bf16 v[168:171], v[64:67], v[28:31], v[168:171]
    v_mfma_f32_16x16x32_bf16 v[172:175], v[68:71], v[28:31], v[172:175]
    v_mfma_f32_16x16x32_bf16 v[176:179], v[56:59], v[32:35], v[176:179]
    v_mfma_f32_16x16x32_bf16 v[180:183], v[60:63], v[32:35], v[180:183]
    v_mfma_f32_16x16x32_bf16 v[184:187], v[64:67], v[32:35], v[184:187]
    v_mfma_f32_16x16x32_bf16 v[188:191], v[68:71], v[32:35], v[188:191]
    v_mfma_f32_16x16x32_bf16 v[192:195], v[56:59], v[36:39], v[192:195]
    v_mfma_f32_16x16x32_bf16 v[196:199], v[60:63], v[36:39], v[196:199]
    v_mfma_f32_16x16x32_bf16 v[200:203], v[64:67], v[36:39], v[200:203]
    v_mfma_f32_16x16x32_bf16 v[204:207], v[68:71], v[36:39], v[204:207]
    s_waitcnt lgkmcnt(0)
    s_nop 7
    s_nop 7
    s_and_b32 s33, s30, 1
    s_cmp_eq_u32 s33, 1
    s_cbranch_scc1 g2o_e1
    v_mbcnt_lo_u32_b32 v1, -1, 0
    v_mbcnt_hi_u32_b32 v1, -1, v1
    v_and_b32 v2, 15, v1
    v_lshrrev_b32 v3, 4, v1
    v_lshlrev_b32 v5, 4, v1
    s_add_u32 s12, s28, 33554432
    s_addc_u32 s13, s29, 0
    s_mov_b32 s14, 33554432
    s_mov_b32 s15, 0x20000
    s_lshr_b32 s34, s40, 5
    s_lshr_b32 s35, s41, 7
    s_add_u32 s34, s34, s35
    s_lshl_b32 s34, s34, 4
    s_add_u32 s34, s34, s3
    s_lshl_b32 s34, s34, 15
    s_add_u32 s35, s34, 262144
    s_add_u32 s51, s35, 0
    v_cvt_pk_bf16_f32 v16, v80, v81
    v_cvt_pk_bf16_f32 v17, v82, v83
    v_cvt_pk_bf16_f32 v18, v84, v85
    v_cvt_pk_bf16_f32 v19, v86, v87
    buffer_store_dwordx4 v[16:19], v5, s[12:15], s51 offen offset:0 sc1
    v_cvt_pk_bf16_f32 v20, v88, v89
    v_cvt_pk_bf16_f32 v21, v90, v91
    v_cvt_pk_bf16_f32 v22, v92, v93
    v_cvt_pk_bf16_f32 v23, v94, v95
    buffer_store_dwordx4 v[20:23], v5, s[12:15], s51 offen offset:1024 sc1
    s_add_u32 s51, s35, 4096
    v_cvt_pk_bf16_f32 v24, v96, v97
    v_cvt_pk_bf16_f32 v25, v98, v99
    v_cvt_pk_bf16_f32 v26, v100, v101
    v_cvt_pk_bf16_f32 v27, v102, v103
    buffer_store_dwordx4 v[24:27], v5, s[12:15], s51 offen offset:0 sc1
    v_cvt_pk_bf16_f32 v28, v104, v105
    v_cvt_pk_bf16_f32 v29, v106, v107
    v_cvt_pk_bf16_f32 v30, v108, v109
    v_cvt_pk_bf16_f32 v31, v110, v111
    buffer_store_dwordx4 v[28:31], v5, s[12:15], s51 offen offset:1024 sc1
    s_add_u32 s51, s35, 8192
    v_cvt_pk_bf16_f32 v32, v112, v113
    v_cvt_pk_bf16_f32 v33, v114, v115
    v_cvt_pk_bf16_f32 v34, v116, v117
    v_cvt_pk_bf16_f32 v35, v118, v119
    buffer_store_dwordx4 v[32:35], v5, s[12:15], s51 offen offset:0 sc1
    v_cvt_pk_bf16_f32 v36, v120, v121
    v_cvt_pk_bf16_f32 v37, v122, v123
    v_cvt_pk_bf16_f32 v38, v124, v125
    v_cvt_pk_bf16_f32 v39, v126, v127
    buffer_store_dwordx4 v[36:39], v5, s[12:15], s51 offen offset:1024 sc1
    s_add_u32 s51, s35, 12288
    v_cvt_pk_bf16_f32 v40, v128, v129
    v_cvt_pk_bf16_f32 v41, v130, v131
    v_cvt_pk_bf16_f32 v42, v132, v133
    v_cvt_pk_bf16_f32 v43, v134, v135
    buffer_store_dwordx4 v[40:43], v5, s[12:15], s51 offen offset:0 sc1
    v_cvt_pk_bf16_f32 v44, v136, v137
    v_cvt_pk_bf16_f32 v45, v138, v139
    v_cvt_pk_bf16_f32 v46, v140, v141
    v_cvt_pk_bf16_f32 v47, v142, v143
    buffer_store_dwordx4 v[44:47], v5, s[12:15], s51 offen offset:1024 sc1
    s_add_u32 s51, s35, 24576
    v_cvt_pk_bf16_f32 v32, v176, v177
    v_cvt_pk_bf16_f32 v33, v178, v179
    v_cvt_pk_bf16_f32 v34, v180, v181
    v_cvt_pk_bf16_f32 v35, v182, v183
    buffer_store_dwordx4 v[32:35], v5, s[12:15], s51 offen offset:0 sc1
    v_cvt_pk_bf16_f32 v36, v184, v185
    v_cvt_pk_bf16_f32 v37, v186, v187
    v_cvt_pk_bf16_f32 v38, v188, v189
    v_cvt_pk_bf16_f32 v39, v190, v191
    buffer_store_dwordx4 v[36:39], v5, s[12:15], s51 offen offset:1024 sc1
    s_add_u32 s51, s35, 28672
    v_cvt_pk_bf16_f32 v40, v192, v193
    v_cvt_pk_bf16_f32 v41, v194, v195
    v_cvt_pk_bf16_f32 v42, v196, v197
    v_cvt_pk_bf16_f32 v43, v198, v199
    buffer_store_dwordx4 v[40:43], v5, s[12:15], s51 offen offset:0 sc1
    v_cvt_pk_bf16_f32 v44, v200, v201
    v_cvt_pk_bf16_f32 v45, v202, v203
    v_cvt_pk_bf16_f32 v46, v204, v205
    v_cvt_pk_bf16_f32 v47, v206, v207
    buffer_store_dwordx4 v[44:47], v5, s[12:15], s51 offen offset:1024 sc1
    s_lshr_b32 s36, s34, 12
    s_and_b32 s36, s36, 0xff80
    s_add_u32 s36, s36, 8192
    s_add_u32 s37, s36, 8
    s_waitcnt vmcnt(0)
    v_mov_b32 v0, 155660
    v_mov_b32 v1, 1
    s_mov_b64 exec, 1
    ds_add_rtn_u32 v1, v0, v1
    s_waitcnt lgkmcnt(0)
    v_cmp_eq_u32 vcc, 3, v1
    s_cbranch_vccz sig_c2
    v_mov_b32 v0, 0
    v_mov_b32 v1, s95
    buffer_store_dword v1, v0, s[96:99], s37 offen sc1
sig_c2:
    s_mov_b64 exec, -1
    s_load_dwordx2 s[20:21], s[0:1], 0
    s_load_dwordx4 s[24:27], s[0:1], 72
    v_mbcnt_lo_u32_b32 v1, -1, 0
    v_mbcnt_hi_u32_b32 v1, -1, v1
    s_lshr_b32 s49, s3, 1
    s_lshl_b32 s49, s49, 7
    s_add_u32 s49, s49, s40
    s_add_u32 s49, s49, 64
    s_and_b32 s50, s3, 1
    s_lshl_b32 s50, s50, 6
    s_add_u32 s50, s50, s41
    v_add_u32 v6, s49, v2
    v_lshlrev_b32 v6, 11, v6
    v_lshl_add_u32 v7, v3, 2, s50
    v_lshlrev_b32 v7, 1, v7
    v_add_u32 v8, v6, v7
    v_and_b32 v4, 1, v3
    v_lshlrev_b32 v4, 4, v4
    v_lshrrev_b32 v9, 1, v3
    v_lshl_add_u32 v4, v9, 3, v4
    v_add_u32 v4, s50, v4
    v_lshl_add_u32 v9, v4, 1, v6
    v_and_b32 v10, 3, v1
    v_lshl_add_u32 v10, v10, 2, s36
    s_waitcnt lgkmcnt(0)
    s_mov_b32 s64, s20
    s_mov_b32 s65, s21
    s_mov_b32 s66, 4194304
    s_mov_b32 s67, 0x20000
    s_mov_b32 s68, s24
    s_mov_b32 s69, s25
    s_mov_b32 s70, 2048
    s_mov_b32 s71, 0x20000
    s_mov_b32 s72, s26
    s_mov_b32 s73, s27
    s_mov_b32 s74, 4194304
    s_mov_b32 s75, 0x20000
    buffer_load_dwordx2 v[240:241], v8, s[64:67], 0 offen offset:0
    buffer_load_dwordx2 v[242:243], v8, s[64:67], 0 offen offset:32
    buffer_load_dwordx2 v[244:245], v8, s[64:67], 0 offen offset:64
    buffer_load_dwordx2 v[246:247], v8, s[64:67], 0 offen offset:96
    v_add_u32 v12, 0x8000, v8
    buffer_load_dwordx2 v[248:249], v12, s[64:67], 0 offen offset:0
    buffer_load_dwordx2 v[250:251], v12, s[64:67], 0 offen offset:32
    buffer_load_dwordx2 v[252:253], v12, s[64:67], 0 offen offset:64
    buffer_load_dwordx2 v[254:255], v12, s[64:67], 0 offen offset:96
    buffer_load_dwordx2 v[72:73], v7, s[68:71], 0 offen offset:0
    buffer_load_dwordx2 v[74:75], v7, s[68:71], 0 offen offset:32
    buffer_load_dwordx2 v[76:77], v7, s[68:71], 0 offen offset:64
    buffer_load_dwordx2 v[78:79], v7, s[68:71], 0 offen offset:96
    s_mov_b32 s51, 200000
poll_c2:
    buffer_load_dword v11, v10, s[96:99], 0 offen sc1
    s_waitcnt vmcnt(0)
    v_cmp_ne_u32 vcc, s95, v11
    s_cbranch_vccz polld_c2
    s_sleep 1
    s_sub_u32 s51, s51, 1
    s_cmp_lg_u32 s51, 0
    s_cbranch_scc1 poll_c2
polld_c2:
    s_add_u32 s51, s34, 16384
    buffer_load_dwordx4 v[80:83], v5, s[12:15], s51 offen offset:0 sc1
    buffer_load_dwordx4 v[84:87], v5, s[12:15], s51 offen offset:1024 sc1
    s_add_u32 s51, s34, 147456
    buffer_load_dwordx4 v[88:91], v5, s[12:15], s51 offen offset:0 sc1
    buffer_load_dwordx4 v[92:95], v5, s[12:15], s51 offen offset:1024 sc1
    s_add_u32 s51, s34, 409600
    buffer_load_dwordx4 v[96:99], v5, s[12:15], s51 offen offset:0 sc1
    buffer_load_dwordx4 v[100:103], v5, s[12:15], s51 offen offset:1024 sc1
    s_add_u32 s51, s34, 20480
    buffer_load_dwordx4 v[104:107], v5, s[12:15], s51 offen offset:0 sc1
    buffer_load_dwordx4 v[108:111], v5, s[12:15], s51 offen offset:1024 sc1
    s_add_u32 s51, s34, 151552
    buffer_load_dwordx4 v[112:115], v5, s[12:15], s51 offen offset:0 sc1
    buffer_load_dwordx4 v[116:119], v5, s[12:15], s51 offen offset:1024 sc1
    s_add_u32 s51, s34, 413696
    buffer_load_dwordx4 v[120:123], v5, s[12:15], s51 offen offset:0 sc1
    buffer_load_dwordx4 v[124:127], v5, s[12:15], s51 offen offset:1024 sc1
    s_mov_b32 s37, 0xbfb8aa3b
    s_waitcnt vmcnt(6)
    v_lshlrev_b32 v12, 16, v80
    v_and_b32 v13, 0xffff0000, v80
    v_lshlrev_b32 v14, 16, v81
    v_and_b32 v15, 0xffff0000, v81
    v_lshlrev_b32 v16, 16, v82
    v_and_b32 v17, 0xffff0000, v82
    v_lshlrev_b32 v18, 16, v83
    v_and_b32 v19, 0xffff0000, v83
    v_lshlrev_b32 v20, 16, v88
    v_and_b32 v21, 0xffff0000, v88
    v_lshlrev_b32 v22, 16, v89
    v_and_b32 v23, 0xffff0000, v89
    v_lshlrev_b32 v24, 16, v90
    v_and_b32 v25, 0xffff0000, v90
    v_lshlrev_b32 v26, 16, v91
    v_and_b32 v27, 0xffff0000, v91
    v_pk_add_f32 v[12:13], v[12:13], v[20:21]
    v_pk_add_f32 v[14:15], v[14:15], v[22:23]
    v_pk_add_f32 v[16:17], v[16:17], v[24:25]
    v_pk_add_f32 v[18:19], v[18:19], v[26:27]
    v_cvt_pk_bf16_f32 v28, v12, v13
    v_cvt_pk_bf16_f32 v29, v14, v15
    v_cvt_pk_bf16_f32 v30, v16, v17
    v_cvt_pk_bf16_f32 v31, v18, v19
    v_lshlrev_b32 v12, 16, v28
    v_and_b32 v13, 0xffff0000, v28
    v_lshlrev_b32 v14, 16, v29
    v_and_b32 v15, 0xffff0000, v29
    v_lshlrev_b32 v16, 16, v30
    v_and_b32 v17, 0xffff0000, v30
    v_lshlrev_b32 v18, 16, v31
    v_and_b32 v19, 0xffff0000, v31
    v_cvt_pk_bf16_f32 v28, v144, v145
    v_cvt_pk_bf16_f32 v29, v146, v147
    v_cvt_pk_bf16_f32 v30, v148, v149
    v_cvt_pk_bf16_f32 v31, v150, v151
    v_lshlrev_b32 v20, 16, v28
    v_and_b32 v21, 0xffff0000, v28
    v_lshlrev_b32 v22, 16, v29
    v_and_b32 v23, 0xffff0000, v29
    v_lshlrev_b32 v24, 16, v30
    v_and_b32 v25, 0xffff0000, v30
    v_lshlrev_b32 v26, 16, v31
    v_and_b32 v27, 0xffff0000, v31
    v_lshlrev_b32 v32, 16, v96
    v_and_b32 v33, 0xffff0000, v96
    v_lshlrev_b32 v34, 16, v97
    v_and_b32 v35, 0xffff0000, v97
    v_lshlrev_b32 v36, 16, v98
    v_and_b32 v37, 0xffff0000, v98
    v_lshlrev_b32 v38, 16, v99
    v_and_b32 v39, 0xffff0000, v99
    v_pk_add_f32 v[20:21], v[20:21], v[32:33]
    v_pk_add_f32 v[22:23], v[22:23], v[34:35]
    v_pk_add_f32 v[24:25], v[24:25], v[36:37]
    v_pk_add_f32 v[26:27], v[26:27], v[38:39]
    v_cvt_pk_bf16_f32 v28, v20, v21
    v_cvt_pk_bf16_f32 v29, v22, v23
    v_cvt_pk_bf16_f32 v30, v24, v25
    v_cvt_pk_bf16_f32 v31, v26, v27
    v_lshlrev_b32 v20, 16, v28
    v_and_b32 v21, 0xffff0000, v28
    v_lshlrev_b32 v22, 16, v29
    v_and_b32 v23, 0xffff0000, v29
    v_lshlrev_b32 v24, 16, v30
    v_and_b32 v25, 0xffff0000, v30
    v_lshlrev_b32 v26, 16, v31
    v_and_b32 v27, 0xffff0000, v31
    v_lshlrev_b32 v28, 16, v72
    v_and_b32 v29, 0xffff0000, v72
    v_lshlrev_b32 v30, 16, v73
    v_and_b32 v31, 0xffff0000, v73
    v_pk_add_f32 v[20:21], v[20:21], v[28:29]
    v_pk_add_f32 v[22:23], v[22:23], v[30:31]
    v_lshlrev_b32 v28, 16, v74
    v_and_b32 v29, 0xffff0000, v74
    v_lshlrev_b32 v30, 16, v75
    v_and_b32 v31, 0xffff0000, v75
    v_pk_add_f32 v[24:25], v[24:25], v[28:29]
    v_pk_add_f32 v[26:27], v[26:27], v[30:31]
    v_cvt_pk_bf16_f32 v28, v20, v21
    v_cvt_pk_bf16_f32 v29, v22, v23
    v_cvt_pk_bf16_f32 v30, v24, v25
    v_cvt_pk_bf16_f32 v31, v26, v27
    v_lshlrev_b32 v20, 16, v28
    v_and_b32 v21, 0xffff0000, v28
    v_lshlrev_b32 v22, 16, v29
    v_and_b32 v23, 0xffff0000, v29
    v_lshlrev_b32 v24, 16, v30
    v_and_b32 v25, 0xffff0000, v30
    v_lshlrev_b32 v26, 16, v31
    v_and_b32 v27, 0xffff0000, v31
    v_mul_f32 v32, s37, v20
    v_mul_f32 v33, s37, v21
    v_mul_f32 v34, s37, v22
    v_mul_f32 v35, s37, v23
    v_mul_f32 v36, s37, v24
    v_mul_f32 v37, s37, v25
    v_mul_f32 v38, s37, v26
    v_mul_f32 v39, s37, v27
    v_exp_f32 v32, v32
    v_exp_f32 v33, v33
    v_exp_f32 v34, v34
    v_exp_f32 v35, v35
    v_exp_f32 v36, v36
    v_exp_f32 v37, v37
    v_exp_f32 v38, v38
    v_exp_f32 v39, v39
    v_add_f32 v32, 1.0, v32
    v_add_f32 v33, 1.0, v33
    v_add_f32 v34, 1.0, v34
    v_add_f32 v35, 1.0, v35
    v_add_f32 v36, 1.0, v36
    v_add_f32 v37, 1.0, v37
    v_add_f32 v38, 1.0, v38
    v_add_f32 v39, 1.0, v39
    v_rcp_f32 v32, v32
    v_rcp_f32 v33, v33
    v_rcp_f32 v34, v34
    v_rcp_f32 v35, v35
    v_rcp_f32 v36, v36
    v_rcp_f32 v37, v37
    v_rcp_f32 v38, v38
    v_rcp_f32 v39, v39
    v_pk_mul_f32 v[20:21], v[20:21], v[32:33]
    v_pk_mul_f32 v[22:23], v[22:23], v[34:35]
    v_pk_mul_f32 v[24:25], v[24:25], v[36:37]
    v_pk_mul_f32 v[26:27], v[26:27], v[38:39]
    v_cvt_pk_bf16_f32 v28, v20, v21
    v_cvt_pk_bf16_f32 v29, v22, v23
    v_cvt_pk_bf16_f32 v30, v24, v25
    v_cvt_pk_bf16_f32 v31, v26, v27
    v_lshlrev_b32 v20, 16, v28
    v_and_b32 v21, 0xffff0000, v28
    v_lshlrev_b32 v22, 16, v29
    v_and_b32 v23, 0xffff0000, v29
    v_lshlrev_b32 v24, 16, v30
    v_and_b32 v25, 0xffff0000, v30
    v_lshlrev_b32 v26, 16, v31
    v_and_b32 v27, 0xffff0000, v31
    v_pk_mul_f32 v[12:13], v[12:13], v[20:21]
    v_pk_mul_f32 v[14:15], v[14:15], v[22:23]
    v_pk_mul_f32 v[16:17], v[16:17], v[24:25]
    v_pk_mul_f32 v[18:19], v[18:19], v[26:27]
    v_cvt_pk_bf16_f32 v28, v12, v13
    v_cvt_pk_bf16_f32 v29, v14, v15
    v_cvt_pk_bf16_f32 v30, v16, v17
    v_cvt_pk_bf16_f32 v31, v18, v19
    v_lshlrev_b32 v12, 16, v28
    v_and_b32 v13, 0xffff0000, v28
    v_lshlrev_b32 v14, 16, v29
    v_and_b32 v15, 0xffff0000, v29
    v_lshlrev_b32 v16, 16, v30
    v_and_b32 v17, 0xffff0000, v30
    v_lshlrev_b32 v18, 16, v31
    v_and_b32 v19, 0xffff0000, v31
    v_lshlrev_b32 v20, 16, v240
    v_and_b32 v21, 0xffff0000, v240
    v_lshlrev_b32 v22, 16, v241
    v_and_b32 v23, 0xffff0000, v241
    v_lshlrev_b32 v24, 16, v242
    v_and_b32 v25, 0xffff0000, v242
    v_lshlrev_b32 v26, 16, v243
    v_and_b32 v27, 0xffff0000, v243
    v_pk_add_f32 v[12:13], v[12:13], v[20:21]
    v_pk_add_f32 v[14:15], v[14:15], v[22:23]
    v_pk_add_f32 v[16:17], v[16:17], v[24:25]
    v_pk_add_f32 v[18:19], v[18:19], v[26:27]
    v_cvt_pk_bf16_f32 v40, v12, v13
    v_cvt_pk_bf16_f32 v41, v14, v15
    v_cvt_pk_bf16_f32 v42, v16, v17
    v_cvt_pk_bf16_f32 v43, v18, v19
    s_mov_b32 s51, 0
    s_nop 0
    v_permlane16_swap_b32 v40, v42
    v_permlane16_swap_b32 v41, v43
    buffer_store_dwordx4 v[40:43], v9, s[72:75], s51 offen offset:0
    v_lshlrev_b32 v12, 16, v84
    v_and_b32 v13, 0xffff0000, v84
    v_lshlrev_b32 v14, 16, v85
    v_and_b32 v15, 0xffff0000, v85
    v_lshlrev_b32 v16, 16, v86
    v_and_b32 v17, 0xffff0000, v86
    v_lshlrev_b32 v18, 16, v87
    v_and_b32 v19, 0xffff0000, v87
    v_lshlrev_b32 v20, 16, v92
    v_and_b32 v21, 0xffff0000, v92
    v_lshlrev_b32 v22, 16, v93
    v_and_b32 v23, 0xffff0000, v93
    v_lshlrev_b32 v24, 16, v94
    v_and_b32 v25, 0xffff0000, v94
    v_lshlrev_b32 v26, 16, v95
    v_and_b32 v27, 0xffff0000, v95
    v_pk_add_f32 v[12:13], v[12:13], v[20:21]
    v_pk_add_f32 v[14:15], v[14:15], v[22:23]
    v_pk_add_f32 v[16:17], v[16:17], v[24:25]
    v_pk_add_f32 v[18:19], v[18:19], v[26:27]
    v_cvt_pk_bf16_f32 v28, v12, v13
    v_cvt_pk_bf16_f32 v29, v14, v15
    v_cvt_pk_bf16_f32 v30, v16, v17
    v_cvt_pk_bf16_f32 v31, v18, v19
    v_lshlrev_b32 v12, 16, v28
    v_and_b32 v13, 0xffff0000, v28
    v_lshlrev_b32 v14, 16, v29
    v_and_b32 v15, 0xffff0000, v29
    v_lshlrev_b32 v16, 16, v30
    v_and_b32 v17, 0xffff0000, v30
    v_lshlrev_b32 v18, 16, v31
    v_and_b32 v19, 0xffff0000, v31
    v_cvt_pk_bf16_f32 v28, v152, v153
    v_cvt_pk_bf16_f32 v29, v154, v155
    v_cvt_pk_bf16_f32 v30, v156, v157
    v_cvt_pk_bf16_f32 v31, v158, v159
    v_lshlrev_b32 v20, 16, v28
    v_and_b32 v21, 0xffff0000, v28
    v_lshlrev_b32 v22, 16, v29
    v_and_b32 v23, 0xffff0000, v29
    v_lshlrev_b32 v24, 16, v30
    v_and_b32 v25, 0xffff0000, v30
    v_lshlrev_b32 v26, 16, v31
    v_and_b32 v27, 0xffff0000, v31
    v_lshlrev_b32 v32, 16, v100
    v_and_b32 v33, 0xffff0000, v100
    v_lshlrev_b32 v34, 16, v101
    v_and_b32 v35, 0xffff0000, v101
    v_lshlrev_b32 v36, 16, v102
    v_and_b32 v37, 0xffff0000, v102
    v_lshlrev_b32 v38, 16, v103
    v_and_b32 v39, 0xffff0000, v103
    v_pk_add_f32 v[20:21], v[20:21], v[32:33]
    v_pk_add_f32 v[22:23], v[22:23], v[34:35]
    v_pk_add_f32 v[24:25], v[24:25], v[36:37]
    v_pk_add_f32 v[26:27], v[26:27], v[38:39]
    v_cvt_pk_bf16_f32 v28, v20, v21
    v_cvt_pk_bf16_f32 v29, v22, v23
    v_cvt_pk_bf16_f32 v30, v24, v25
    v_cvt_pk_bf16_f32 v31, v26, v27
    v_lshlrev_b32 v20, 16, v28
    v_and_b32 v21, 0xffff0000, v28
    v_lshlrev_b32 v22, 16, v29
    v_and_b32 v23, 0xffff0000, v29
    v_lshlrev_b32 v24, 16, v30
    v_and_b32 v25, 0xffff0000, v30
    v_lshlrev_b32 v26, 16, v31
    v_and_b32 v27, 0xffff0000, v31
    v_lshlrev_b32 v28, 16, v76
    v_and_b32 v29, 0xffff0000, v76
    v_lshlrev_b32 v30, 16, v77
    v_and_b32 v31, 0xffff0000, v77
    v_pk_add_f32 v[20:21], v[20:21], v[28:29]
    v_pk_add_f32 v[22:23], v[22:23], v[30:31]
    v_lshlrev_b32 v28, 16, v78
    v_and_b32 v29, 0xffff0000, v78
    v_lshlrev_b32 v30, 16, v79
    v_and_b32 v31, 0xffff0000, v79
    v_pk_add_f32 v[24:25], v[24:25], v[28:29]
    v_pk_add_f32 v[26:27], v[26:27], v[30:31]
    v_cvt_pk_bf16_f32 v28, v20, v21
    v_cvt_pk_bf16_f32 v29, v22, v23
    v_cvt_pk_bf16_f32 v30, v24, v25
    v_cvt_pk_bf16_f32 v31, v26, v27
    v_lshlrev_b32 v20, 16, v28
    v_and_b32 v21, 0xffff0000, v28
    v_lshlrev_b32 v22, 16, v29
    v_and_b32 v23, 0xffff0000, v29
    v_lshlrev_b32 v24, 16, v30
    v_and_b32 v25, 0xffff0000, v30
    v_lshlrev_b32 v26, 16, v31
    v_and_b32 v27, 0xffff0000, v31
    v_mul_f32 v32, s37, v20
    v_mul_f32 v33, s37, v21
    v_mul_f32 v34, s37, v22
    v_mul_f32 v35, s37, v23
    v_mul_f32 v36, s37, v24
    v_mul_f32 v37, s37, v25
    v_mul_f32 v38, s37, v26
    v_mul_f32 v39, s37, v27
    v_exp_f32 v32, v32
    v_exp_f32 v33, v33
    v_exp_f32 v34, v34
    v_exp_f32 v35, v35
    v_exp_f32 v36, v36
    v_exp_f32 v37, v37
    v_exp_f32 v38, v38
    v_exp_f32 v39, v39
    v_add_f32 v32, 1.0, v32
    v_add_f32 v33, 1.0, v33
    v_add_f32 v34, 1.0, v34
    v_add_f32 v35, 1.0, v35
    v_add_f32 v36, 1.0, v36
    v_add_f32 v37, 1.0, v37
    v_add_f32 v38, 1.0, v38
    v_add_f32 v39, 1.0, v39
    v_rcp_f32 v32, v32
    v_rcp_f32 v33, v33
    v_rcp_f32 v34, v34
    v_rcp_f32 v35, v35
    v_rcp_f32 v36, v36
    v_rcp_f32 v37, v37
    v_rcp_f32 v38, v38
    v_rcp_f32 v39, v39
    v_pk_mul_f32 v[20:21], v[20:21], v[32:33]
    v_pk_mul_f32 v[22:23], v[22:23], v[34:35]
    v_pk_mul_f32 v[24:25], v[24:25], v[36:37]
    v_pk_mul_f32 v[26:27], v[26:27], v[38:39]
    v_cvt_pk_bf16_f32 v28, v20, v21
    v_cvt_pk_bf16_f32 v29, v22, v23
    v_cvt_pk_bf16_f32 v30, v24, v25
    v_cvt_pk_bf16_f32 v31, v26, v27
    v_lshlrev_b32 v20, 16, v28
    v_and_b32 v21, 0xffff0000, v28
    v_lshlrev_b32 v22, 16, v29
    v_and_b32 v23, 0xffff0000, v29
    v_lshlrev_b32 v24, 16, v30
    v_and_b32 v25, 0xffff0000, v30
    v_lshlrev_b32 v26, 16, v31
    v_and_b32 v27, 0xffff0000, v31
    v_pk_mul_f32 v[12:13], v[12:13], v[20:21]
    v_pk_mul_f32 v[14:15], v[14:15], v[22:23]
    v_pk_mul_f32 v[16:17], v[16:17], v[24:25]
    v_pk_mul_f32 v[18:19], v[18:19], v[26:27]
    v_cvt_pk_bf16_f32 v28, v12, v13
    v_cvt_pk_bf16_f32 v29, v14, v15
    v_cvt_pk_bf16_f32 v30, v16, v17
    v_cvt_pk_bf16_f32 v31, v18, v19
    v_lshlrev_b32 v12, 16, v28
    v_and_b32 v13, 0xffff0000, v28
    v_lshlrev_b32 v14, 16, v29
    v_and_b32 v15, 0xffff0000, v29
    v_lshlrev_b32 v16, 16, v30
    v_and_b32 v17, 0xffff0000, v30
    v_lshlrev_b32 v18, 16, v31
    v_and_b32 v19, 0xffff0000, v31
    v_lshlrev_b32 v20, 16, v244
    v_and_b32 v21, 0xffff0000, v244
    v_lshlrev_b32 v22, 16, v245
    v_and_b32 v23, 0xffff0000, v245
    v_lshlrev_b32 v24, 16, v246
    v_and_b32 v25, 0xffff0000, v246
    v_lshlrev_b32 v26, 16, v247
    v_and_b32 v27, 0xffff0000, v247
    v_pk_add_f32 v[12:13], v[12:13], v[20:21]
    v_pk_add_f32 v[14:15], v[14:15], v[22:23]
    v_pk_add_f32 v[16:17], v[16:17], v[24:25]
    v_pk_add_f32 v[18:19], v[18:19], v[26:27]
    v_cvt_pk_bf16_f32 v44, v12, v13
    v_cvt_pk_bf16_f32 v45, v14, v15
    v_cvt_pk_bf16_f32 v46, v16, v17
    v_cvt_pk_bf16_f32 v47, v18, v19
    s_mov_b32 s51, 0
    s_nop 0
    v_permlane16_swap_b32 v44, v46
    v_permlane16_swap_b32 v45, v47
    buffer_store_dwordx4 v[44:47], v9, s[72:75], s51 offen offset:64
    s_waitcnt vmcnt(2)
    v_lshlrev_b32 v12, 16, v104
    v_and_b32 v13, 0xffff0000, v104
    v_lshlrev_b32 v14, 16, v105
    v_and_b32 v15, 0xffff0000, v105
    v_lshlrev_b32 v16, 16, v106
    v_and_b32 v17, 0xffff0000, v106
    v_lshlrev_b32 v18, 16, v107
    v_and_b32 v19, 0xffff0000, v107
    v_lshlrev_b32 v20, 16, v112
    v_and_b32 v21, 0xffff0000, v112
    v_lshlrev_b32 v22, 16, v113
    v_and_b32 v23, 0xffff0000, v113
    v_lshlrev_b32 v24, 16, v114
    v_and_b32 v25, 0xffff0000, v114
    v_lshlrev_b32 v26, 16, v115
    v_and_b32 v27, 0xffff0000, v115
    v_pk_add_f32 v[12:13], v[12:13], v[20:21]
    v_pk_add_f32 v[14:15], v[14:15], v[22:23]
    v_pk_add_f32 v[16:17], v[16:17], v[24:25]
    v_pk_add_f32 v[18:19], v[18:19], v[26:27]
    v_cvt_pk_bf16_f32 v28, v12, v13
    v_cvt_pk_bf16_f32 v29, v14, v15
    v_cvt_pk_bf16_f32 v30, v16, v17
    v_cvt_pk_bf16_f32 v31, v18, v19
    v_lshlrev_b32 v12, 16, v28
    v_and_b32 v13, 0xffff0000, v28
    v_lshlrev_b32 v14, 16, v29
    v_and_b32 v15, 0xffff0000, v29
    v_lshlrev_b32 v16, 16, v30
    v_and_b32 v17, 0xffff0000, v30
    v_lshlrev_b32 v18, 16, v31
    v_and_b32 v19, 0xffff0000, v31
    v_cvt_pk_bf16_f32 v28, v160, v161
    v_cvt_pk_bf16_f32 v29, v162, v163
    v_cvt_pk_bf16_f32 v30, v164, v165
    v_cvt_pk_bf16_f32 v31, v166, v167
    v_lshlrev_b32 v20, 16, v28
    v_and_b32 v21, 0xffff0000, v28
    v_lshlrev_b32 v22, 16, v29
    v_and_b32 v23, 0xffff0000, v29
    v_lshlrev_b32 v24, 16, v30
    v_and_b32 v25, 0xffff0000, v30
    v_lshlrev_b32 v26, 16, v31
    v_and_b32 v27, 0xffff0000, v31
    v_lshlrev_b32 v32, 16, v120
    v_and_b32 v33, 0xffff0000, v120
    v_lshlrev_b32 v34, 16, v121
    v_and_b32 v35, 0xffff0000, v121
    v_lshlrev_b32 v36, 16, v122
    v_and_b32 v37, 0xffff0000, v122
    v_lshlrev_b32 v38, 16, v123
    v_and_b32 v39, 0xffff0000, v123
    v_pk_add_f32 v[20:21], v[20:21], v[32:33]
    v_pk_add_f32 v[22:23], v[22:23], v[34:35]
    v_pk_add_f32 v[24:25], v[24:25], v[36:37]
    v_pk_add_f32 v[26:27], v[26:27], v[38:39]
    v_cvt_pk_bf16_f32 v28, v20, v21
    v_cvt_pk_bf16_f32 v29, v22, v23
    v_cvt_pk_bf16_f32 v30, v24, v25
    v_cvt_pk_bf16_f32 v31, v26, v27
    v_lshlrev_b32 v20, 16, v28
    v_and_b32 v21, 0xffff0000, v28
    v_lshlrev_b32 v22, 16, v29
    v_and_b32 v23, 0xffff0000, v29
    v_lshlrev_b32 v24, 16, v30
    v_and_b32 v25, 0xffff0000, v30
    v_lshlrev_b32 v26, 16, v31
    v_and_b32 v27, 0xffff0000, v31
    v_lshlrev_b32 v28, 16, v72
    v_and_b32 v29, 0xffff0000, v72
    v_lshlrev_b32 v30, 16, v73
    v_and_b32 v31, 0xffff0000, v73
    v_pk_add_f32 v[20:21], v[20:21], v[28:29]
    v_pk_add_f32 v[22:23], v[22:23], v[30:31]
    v_lshlrev_b32 v28, 16, v74
    v_and_b32 v29, 0xffff0000, v74
    v_lshlrev_b32 v30, 16, v75
    v_and_b32 v31, 0xffff0000, v75
    v_pk_add_f32 v[24:25], v[24:25], v[28:29]
    v_pk_add_f32 v[26:27], v[26:27], v[30:31]
    v_cvt_pk_bf16_f32 v28, v20, v21
    v_cvt_pk_bf16_f32 v29, v22, v23
    v_cvt_pk_bf16_f32 v30, v24, v25
    v_cvt_pk_bf16_f32 v31, v26, v27
    v_lshlrev_b32 v20, 16, v28
    v_and_b32 v21, 0xffff0000, v28
    v_lshlrev_b32 v22, 16, v29
    v_and_b32 v23, 0xffff0000, v29
    v_lshlrev_b32 v24, 16, v30
    v_and_b32 v25, 0xffff0000, v30
    v_lshlrev_b32 v26, 16, v31
    v_and_b32 v27, 0xffff0000, v31
    v_mul_f32 v32, s37, v20
    v_mul_f32 v33, s37, v21
    v_mul_f32 v34, s37, v22
    v_mul_f32 v35, s37, v23
    v_mul_f32 v36, s37, v24
    v_mul_f32 v37, s37, v25
    v_mul_f32 v38, s37, v26
    v_mul_f32 v39, s37, v27
    v_exp_f32 v32, v32
    v_exp_f32 v33, v33
    v_exp_f32 v34, v34
    v_exp_f32 v35, v35
    v_exp_f32 v36, v36
    v_exp_f32 v37, v37
    v_exp_f32 v38, v38
    v_exp_f32 v39, v39
    v_add_f32 v32, 1.0, v32
    v_add_f32 v33, 1.0, v33
    v_add_f32 v34, 1.0, v34
    v_add_f32 v35, 1.0, v35
    v_add_f32 v36, 1.0, v36
    v_add_f32 v37, 1.0, v37
    v_add_f32 v38, 1.0, v38
    v_add_f32 v39, 1.0, v39
    v_rcp_f32 v32, v32
    v_rcp_f32 v33, v33
    v_rcp_f32 v34, v34
    v_rcp_f32 v35, v35
    v_rcp_f32 v36, v36
    v_rcp_f32 v37, v37
    v_rcp_f32 v38, v38
    v_rcp_f32 v39, v39
    v_pk_mul_f32 v[20:21], v[20:21], v[32:33]
    v_pk_mul_f32 v[22:23], v[22:23], v[34:35]
    v_pk_mul_f32 v[24:25], v[24:25], v[36:37]
    v_pk_mul_f32 v[26:27], v[26:27], v[38:39]
    v_cvt_pk_bf16_f32 v28, v20, v21
    v_cvt_pk_bf16_f32 v29, v22, v23
    v_cvt_pk_bf16_f32 v30, v24, v25
    v_cvt_pk_bf16_f32 v31, v26, v27
    v_lshlrev_b32 v20, 16, v28
    v_and_b32 v21, 0xffff0000, v28
    v_lshlrev_b32 v22, 16, v29
    v_and_b32 v23, 0xffff0000, v29
    v_lshlrev_b32 v24, 16, v30
    v_and_b32 v25, 0xffff0000, v30
    v_lshlrev_b32 v26, 16, v31
    v_and_b32 v27, 0xffff0000, v31
    v_pk_mul_f32 v[12:13], v[12:13], v[20:21]
    v_pk_mul_f32 v[14:15], v[14:15], v[22:23]
    v_pk_mul_f32 v[16:17], v[16:17], v[24:25]
    v_pk_mul_f32 v[18:19], v[18:19], v[26:27]
    v_cvt_pk_bf16_f32 v28, v12, v13
    v_cvt_pk_bf16_f32 v29, v14, v15
    v_cvt_pk_bf16_f32 v30, v16, v17
    v_cvt_pk_bf16_f32 v31, v18, v19
    v_lshlrev_b32 v12, 16, v28
    v_and_b32 v13, 0xffff0000, v28
    v_lshlrev_b32 v14, 16, v29
    v_and_b32 v15, 0xffff0000, v29
    v_lshlrev_b32 v16, 16, v30
    v_and_b32 v17, 0xffff0000, v30
    v_lshlrev_b32 v18, 16, v31
    v_and_b32 v19, 0xffff0000, v31
    v_lshlrev_b32 v20, 16, v248
    v_and_b32 v21, 0xffff0000, v248
    v_lshlrev_b32 v22, 16, v249
    v_and_b32 v23, 0xffff0000, v249
    v_lshlrev_b32 v24, 16, v250
    v_and_b32 v25, 0xffff0000, v250
    v_lshlrev_b32 v26, 16, v251
    v_and_b32 v27, 0xffff0000, v251
    v_pk_add_f32 v[12:13], v[12:13], v[20:21]
    v_pk_add_f32 v[14:15], v[14:15], v[22:23]
    v_pk_add_f32 v[16:17], v[16:17], v[24:25]
    v_pk_add_f32 v[18:19], v[18:19], v[26:27]
    v_cvt_pk_bf16_f32 v48, v12, v13
    v_cvt_pk_bf16_f32 v49, v14, v15
    v_cvt_pk_bf16_f32 v50, v16, v17
    v_cvt_pk_bf16_f32 v51, v18, v19
    s_mov_b32 s51, 32768
    s_nop 0
    v_permlane16_swap_b32 v48, v50
    v_permlane16_swap_b32 v49, v51
    buffer_store_dwordx4 v[48:51], v9, s[72:75], s51 offen offset:0
    v_lshlrev_b32 v12, 16, v108
    v_and_b32 v13, 0xffff0000, v108
    v_lshlrev_b32 v14, 16, v109
    v_and_b32 v15, 0xffff0000, v109
    v_lshlrev_b32 v16, 16, v110
    v_and_b32 v17, 0xffff0000, v110
    v_lshlrev_b32 v18, 16, v111
    v_and_b32 v19, 0xffff0000, v111
    v_lshlrev_b32 v20, 16, v116
    v_and_b32 v21, 0xffff0000, v116
    v_lshlrev_b32 v22, 16, v117
    v_and_b32 v23, 0xffff0000, v117
    v_lshlrev_b32 v24, 16, v118
    v_and_b32 v25, 0xffff0000, v118
    v_lshlrev_b32 v26, 16, v119
    v_and_b32 v27, 0xffff0000, v119
    v_pk_add_f32 v[12:13], v[12:13], v[20:21]
    v_pk_add_f32 v[14:15], v[14:15], v[22:23]
    v_pk_add_f32 v[16:17], v[16:17], v[24:25]
    v_pk_add_f32 v[18:19], v[18:19], v[26:27]
    v_cvt_pk_bf16_f32 v28, v12, v13
    v_cvt_pk_bf16_f32 v29, v14, v15
    v_cvt_pk_bf16_f32 v30, v16, v17
    v_cvt_pk_bf16_f32 v31, v18, v19
    v_lshlrev_b32 v12, 16, v28
    v_and_b32 v13, 0xffff0000, v28
    v_lshlrev_b32 v14, 16, v29
    v_and_b32 v15, 0xffff0000, v29
    v_lshlrev_b32 v16, 16, v30
    v_and_b32 v17, 0xffff0000, v30
    v_lshlrev_b32 v18, 16, v31
    v_and_b32 v19, 0xffff0000, v31
    v_cvt_pk_bf16_f32 v28, v168, v169
    v_cvt_pk_bf16_f32 v29, v170, v171
    v_cvt_pk_bf16_f32 v30, v172, v173
    v_cvt_pk_bf16_f32 v31, v174, v175
    v_lshlrev_b32 v20, 16, v28
    v_and_b32 v21, 0xffff0000, v28
    v_lshlrev_b32 v22, 16, v29
    v_and_b32 v23, 0xffff0000, v29
    v_lshlrev_b32 v24, 16, v30
    v_and_b32 v25, 0xffff0000, v30
    v_lshlrev_b32 v26, 16, v31
    v_and_b32 v27, 0xffff0000, v31
    v_lshlrev_b32 v32, 16, v124
    v_and_b32 v33, 0xffff0000, v124
    v_lshlrev_b32 v34, 16, v125
    v_and_b32 v35, 0xffff0000, v125
    v_lshlrev_b32 v36, 16, v126
    v_and_b32 v37, 0xffff0000, v126
    v_lshlrev_b32 v38, 16, v127
    v_and_b32 v39, 0xffff0000, v127
    v_pk_add_f32 v[20:21], v[20:21], v[32:33]
    v_pk_add_f32 v[22:23], v[22:23], v[34:35]
    v_pk_add_f32 v[24:25], v[24:25], v[36:37]
    v_pk_add_f32 v[26:27], v[26:27], v[38:39]
    v_cvt_pk_bf16_f32 v28, v20, v21
    v_cvt_pk_bf16_f32 v29, v22, v23
    v_cvt_pk_bf16_f32 v30, v24, v25
    v_cvt_pk_bf16_f32 v31, v26, v27
    v_lshlrev_b32 v20, 16, v28
    v_and_b32 v21, 0xffff0000, v28
    v_lshlrev_b32 v22, 16, v29
    v_and_b32 v23, 0xffff0000, v29
    v_lshlrev_b32 v24, 16, v30
    v_and_b32 v25, 0xffff0000, v30
    v_lshlrev_b32 v26, 16, v31
    v_and_b32 v27, 0xffff0000, v31
    v_lshlrev_b32 v28, 16, v76
    v_and_b32 v29, 0xffff0000, v76
    v_lshlrev_b32 v30, 16, v77
    v_and_b32 v31, 0xffff0000, v77
    v_pk_add_f32 v[20:21], v[20:21], v[28:29]
    v_pk_add_f32 v[22:23], v[22:23], v[30:31]
    v_lshlrev_b32 v28, 16, v78
    v_and_b32 v29, 0xffff0000, v78
    v_lshlrev_b32 v30, 16, v79
    v_and_b32 v31, 0xffff0000, v79
    v_pk_add_f32 v[24:25], v[24:25], v[28:29]
    v_pk_add_f32 v[26:27], v[26:27], v[30:31]
    v_cvt_pk_bf16_f32 v28, v20, v21
    v_cvt_pk_bf16_f32 v29, v22, v23
    v_cvt_pk_bf16_f32 v30, v24, v25
    v_cvt_pk_bf16_f32 v31, v26, v27
    v_lshlrev_b32 v20, 16, v28
    v_and_b32 v21, 0xffff0000, v28
    v_lshlrev_b32 v22, 16, v29
    v_and_b32 v23, 0xffff0000, v29
    v_lshlrev_b32 v24, 16, v30
    v_and_b32 v25, 0xffff0000, v30
    v_lshlrev_b32 v26, 16, v31
    v_and_b32 v27, 0xffff0000, v31
    v_mul_f32 v32, s37, v20
    v_mul_f32 v33, s37, v21
    v_mul_f32 v34, s37, v22
    v_mul_f32 v35, s37, v23
    v_mul_f32 v36, s37, v24
    v_mul_f32 v37, s37, v25
    v_mul_f32 v38, s37, v26
    v_mul_f32 v39, s37, v27
    v_exp_f32 v32, v32
    v_exp_f32 v33, v33
    v_exp_f32 v34, v34
    v_exp_f32 v35, v35
    v_exp_f32 v36, v36
    v_exp_f32 v37, v37
    v_exp_f32 v38, v38
    v_exp_f32 v39, v39
    v_add_f32 v32, 1.0, v32
    v_add_f32 v33, 1.0, v33
    v_add_f32 v34, 1.0, v34
    v_add_f32 v35, 1.0, v35
    v_add_f32 v36, 1.0, v36
    v_add_f32 v37, 1.0, v37
    v_add_f32 v38, 1.0, v38
    v_add_f32 v39, 1.0, v39
    v_rcp_f32 v32, v32
    v_rcp_f32 v33, v33
    v_rcp_f32 v34, v34
    v_rcp_f32 v35, v35
    v_rcp_f32 v36, v36
    v_rcp_f32 v37, v37
    v_rcp_f32 v38, v38
    v_rcp_f32 v39, v39
    v_pk_mul_f32 v[20:21], v[20:21], v[32:33]
    v_pk_mul_f32 v[22:23], v[22:23], v[34:35]
    v_pk_mul_f32 v[24:25], v[24:25], v[36:37]
    v_pk_mul_f32 v[26:27], v[26:27], v[38:39]
    v_cvt_pk_bf16_f32 v28, v20, v21
    v_cvt_pk_bf16_f32 v29, v22, v23
    v_cvt_pk_bf16_f32 v30, v24, v25
    v_cvt_pk_bf16_f32 v31, v26, v27
    v_lshlrev_b32 v20, 16, v28
    v_and_b32 v21, 0xffff0000, v28
    v_lshlrev_b32 v22, 16, v29
    v_and_b32 v23, 0xffff0000, v29
    v_lshlrev_b32 v24, 16, v30
    v_and_b32 v25, 0xffff0000, v30
    v_lshlrev_b32 v26, 16, v31
    v_and_b32 v27, 0xffff0000, v31
    v_pk_mul_f32 v[12:13], v[12:13], v[20:21]
    v_pk_mul_f32 v[14:15], v[14:15], v[22:23]
    v_pk_mul_f32 v[16:17], v[16:17], v[24:25]
    v_pk_mul_f32 v[18:19], v[18:19], v[26:27]
    v_cvt_pk_bf16_f32 v28, v12, v13
    v_cvt_pk_bf16_f32 v29, v14, v15
    v_cvt_pk_bf16_f32 v30, v16, v17
    v_cvt_pk_bf16_f32 v31, v18, v19
    v_lshlrev_b32 v12, 16, v28
    v_and_b32 v13, 0xffff0000, v28
    v_lshlrev_b32 v14, 16, v29
    v_and_b32 v15, 0xffff0000, v29
    v_lshlrev_b32 v16, 16, v30
    v_and_b32 v17, 0xffff0000, v30
    v_lshlrev_b32 v18, 16, v31
    v_and_b32 v19, 0xffff0000, v31
    v_lshlrev_b32 v20, 16, v252
    v_and_b32 v21, 0xffff0000, v252
    v_lshlrev_b32 v22, 16, v253
    v_and_b32 v23, 0xffff0000, v253
    v_lshlrev_b32 v24, 16, v254
    v_and_b32 v25, 0xffff0000, v254
    v_lshlrev_b32 v26, 16, v255
    v_and_b32 v27, 0xffff0000, v255
    v_pk_add_f32 v[12:13], v[12:13], v[20:21]
    v_pk_add_f32 v[14:15], v[14:15], v[22:23]
    v_pk_add_f32 v[16:17], v[16:17], v[24:25]
    v_pk_add_f32 v[18:19], v[18:19], v[26:27]
    v_cvt_pk_bf16_f32 v52, v12, v13
    v_cvt_pk_bf16_f32 v53, v14, v15
    v_cvt_pk_bf16_f32 v54, v16, v17
    v_cvt_pk_bf16_f32 v55, v18, v19
    s_mov_b32 s51, 32768
    s_nop 0
    v_permlane16_swap_b32 v52, v54
    v_permlane16_swap_b32 v53, v55
    buffer_store_dwordx4 v[52:55], v9, s[72:75], s51 offen offset:64
    s_endpgm
g2o_e1:
    v_mbcnt_lo_u32_b32 v1, -1, 0
    v_mbcnt_hi_u32_b32 v1, -1, v1
    v_and_b32 v2, 15, v1
    v_lshrrev_b32 v3, 4, v1
    v_lshlrev_b32 v5, 4, v1
    s_add_u32 s12, s28, 33554432
    s_addc_u32 s13, s29, 0
    s_mov_b32 s14, 33554432
    s_mov_b32 s15, 0x20000
    s_lshr_b32 s34, s40, 5
    s_lshr_b32 s35, s41, 7
    s_add_u32 s34, s34, s35
    s_lshl_b32 s34, s34, 4
    s_add_u32 s34, s34, s3
    s_lshl_b32 s34, s34, 15
    s_add_u32 s35, s34, 393216
    s_add_u32 s51, s35, 0
    v_cvt_pk_bf16_f32 v16, v80, v81
    v_cvt_pk_bf16_f32 v17, v82, v83
    v_cvt_pk_bf16_f32 v18, v84, v85
    v_cvt_pk_bf16_f32 v19, v86, v87
    buffer_store_dwordx4 v[16:19], v5, s[12:15], s51 offen offset:0 sc1
    v_cvt_pk_bf16_f32 v20, v88, v89
    v_cvt_pk_bf16_f32 v21, v90, v91
    v_cvt_pk_bf16_f32 v22, v92, v93
    v_cvt_pk_bf16_f32 v23, v94, v95
    buffer_store_dwordx4 v[20:23], v5, s[12:15], s51 offen offset:1024 sc1
    s_add_u32 s51, s35, 4096
    v_cvt_pk_bf16_f32 v24, v96, v97
    v_cvt_pk_bf16_f32 v25, v98, v99
    v_cvt_pk_bf16_f32 v26, v100, v101
    v_cvt_pk_bf16_f32 v27, v102, v103
    buffer_store_dwordx4 v[24:27], v5, s[12:15], s51 offen offset:0 sc1
    v_cvt_pk_bf16_f32 v28, v104, v105
    v_cvt_pk_bf16_f32 v29, v106, v107
    v_cvt_pk_bf16_f32 v30, v108, v109
    v_cvt_pk_bf16_f32 v31, v110, v111
    buffer_store_dwordx4 v[28:31], v5, s[12:15], s51 offen offset:1024 sc1
    s_add_u32 s51, s35, 8192
    v_cvt_pk_bf16_f32 v32, v112, v113
    v_cvt_pk_bf16_f32 v33, v114, v115
    v_cvt_pk_bf16_f32 v34, v116, v117
    v_cvt_pk_bf16_f32 v35, v118, v119
    buffer_store_dwordx4 v[32:35], v5, s[12:15], s51 offen offset:0 sc1
    v_cvt_pk_bf16_f32 v36, v120, v121
    v_cvt_pk_bf16_f32 v37, v122, v123
    v_cvt_pk_bf16_f32 v38, v124, v125
    v_cvt_pk_bf16_f32 v39, v126, v127
    buffer_store_dwordx4 v[36:39], v5, s[12:15], s51 offen offset:1024 sc1
    s_add_u32 s51, s35, 12288
    v_cvt_pk_bf16_f32 v40, v128, v129
    v_cvt_pk_bf16_f32 v41, v130, v131
    v_cvt_pk_bf16_f32 v42, v132, v133
    v_cvt_pk_bf16_f32 v43, v134, v135
    buffer_store_dwordx4 v[40:43], v5, s[12:15], s51 offen offset:0 sc1
    v_cvt_pk_bf16_f32 v44, v136, v137
    v_cvt_pk_bf16_f32 v45, v138, v139
    v_cvt_pk_bf16_f32 v46, v140, v141
    v_cvt_pk_bf16_f32 v47, v142, v143
    buffer_store_dwordx4 v[44:47], v5, s[12:15], s51 offen offset:1024 sc1
    s_add_u32 s51, s35, 16384
    v_cvt_pk_bf16_f32 v16, v144, v145
    v_cvt_pk_bf16_f32 v17, v146, v147
    v_cvt_pk_bf16_f32 v18, v148, v149
    v_cvt_pk_bf16_f32 v19, v150, v151
    buffer_store_dwordx4 v[16:19], v5, s[12:15], s51 offen offset:0 sc1
    v_cvt_pk_bf16_f32 v20, v152, v153
    v_cvt_pk_bf16_f32 v21, v154, v155
    v_cvt_pk_bf16_f32 v22, v156, v157
    v_cvt_pk_bf16_f32 v23, v158, v159
    buffer_store_dwordx4 v[20:23], v5, s[12:15], s51 offen offset:1024 sc1
    s_add_u32 s51, s35, 20480
    v_cvt_pk_bf16_f32 v24, v160, v161
    v_cvt_pk_bf16_f32 v25, v162, v163
    v_cvt_pk_bf16_f32 v26, v164, v165
    v_cvt_pk_bf16_f32 v27, v166, v167
    buffer_store_dwordx4 v[24:27], v5, s[12:15], s51 offen offset:0 sc1
    v_cvt_pk_bf16_f32 v28, v168, v169
    v_cvt_pk_bf16_f32 v29, v170, v171
    v_cvt_pk_bf16_f32 v30, v172, v173
    v_cvt_pk_bf16_f32 v31, v174, v175
    buffer_store_dwordx4 v[28:31], v5, s[12:15], s51 offen offset:1024 sc1
    s_lshr_b32 s36, s34, 12
    s_and_b32 s36, s36, 0xff80
    s_add_u32 s36, s36, 8192
    s_add_u32 s37, s36, 12
    s_waitcnt vmcnt(0)
    v_mov_b32 v0, 155660
    v_mov_b32 v1, 1
    s_mov_b64 exec, 1
    ds_add_rtn_u32 v1, v0, v1
    s_waitcnt lgkmcnt(0)
    v_cmp_eq_u32 vcc, 3, v1
    s_cbranch_vccz sig_c3
    v_mov_b32 v0, 0
    v_mov_b32 v1, s95
    buffer_store_dword v1, v0, s[96:99], s37 offen sc1
sig_c3:
    s_mov_b64 exec, -1
    s_load_dwordx2 s[20:21], s[0:1], 0
    s_load_dwordx4 s[24:27], s[0:1], 72
    v_mbcnt_lo_u32_b32 v1, -1, 0
    v_mbcnt_hi_u32_b32 v1, -1, v1
    s_lshr_b32 s49, s3, 1
    s_lshl_b32 s49, s49, 7
    s_add_u32 s49, s49, s40
    s_add_u32 s49, s49, 96
    s_and_b32 s50, s3, 1
    s_lshl_b32 s50, s50, 6
    s_add_u32 s50, s50, s41
    v_add_u32 v6, s49, v2
    v_lshlrev_b32 v6, 11, v6
    v_lshl_add_u32 v7, v3, 2, s50
    v_lshlrev_b32 v7, 1, v7
    v_add_u32 v8, v6, v7
    v_and_b32 v4, 1, v3
    v_lshlrev_b32 v4, 4, v4
    v_lshrrev_b32 v9, 1, v3
    v_lshl_add_u32 v4, v9, 3, v4
    v_add_u32 v4, s50, v4
    v_lshl_add_u32 v9, v4, 1, v6
    v_and_b32 v10, 3, v1
    v_lshl_add_u32 v10, v10, 2, s36
    s_waitcnt lgkmcnt(0)
    s_mov_b32 s64, s20
    s_mov_b32 s65, s21
    s_mov_b32 s66, 4194304
    s_mov_b32 s67, 0x20000
    s_mov_b32 s68, s24
    s_mov_b32 s69, s25
    s_mov_b32 s70, 2048
    s_mov_b32 s71, 0x20000
    s_mov_b32 s72, s26
    s_mov_b32 s73, s27
    s_mov_b32 s74, 4194304
    s_mov_b32 s75, 0x20000
    buffer_load_dwordx2 v[240:241], v8, s[64:67], 0 offen offset:0
    buffer_load_dwordx2 v[242:243], v8, s[64:67], 0 offen offset:32
    buffer_load_dwordx2 v[244:245], v8, s[64:67], 0 offen offset:64
    buffer_load_dwordx2 v[246:247], v8, s[64:67], 0 offen offset:96
    v_add_u32 v12, 0x8000, v8
    buffer_load_dwordx2 v[248:249], v12, s[64:67], 0 offen offset:0
    buffer_load_dwordx2 v[250:251], v12, s[64:67], 0 offen offset:32
    buffer_load_dwordx2 v[252:253], v12, s[64:67], 0 offen offset:64
    buffer_load_dwordx2 v[254:255], v12, s[64:67], 0 offen offset:96
    buffer_load_dwordx2 v[72:73], v7, s[68:71], 0 offen offset:0
    buffer_load_dwordx2 v[74:75], v7, s[68:71], 0 offen offset:32
    buffer_load_dwordx2 v[76:77], v7, s[68:71], 0 offen offset:64
    buffer_load_dwordx2 v[78:79], v7, s[68:71], 0 offen offset:96
    s_mov_b32 s51, 200000
poll_c3:
    buffer_load_dword v11, v10, s[96:99], 0 offen sc1
    s_waitcnt vmcnt(0)
    v_cmp_ne_u32 vcc, s95, v11
    s_cbranch_vccz polld_c3
    s_sleep 1
    s_sub_u32 s51, s51, 1
    s_cmp_lg_u32 s51, 0
    s_cbranch_scc1 poll_c3
polld_c3:
    s_add_u32 s51, s34, 24576
    buffer_load_dwordx4 v[80:83], v5, s[12:15], s51 offen offset:0 sc1
    buffer_load_dwordx4 v[84:87], v5, s[12:15], s51 offen offset:1024 sc1
    s_add_u32 s51, s34, 155648
    buffer_load_dwordx4 v[88:91], v5, s[12:15], s51 offen offset:0 sc1
    buffer_load_dwordx4 v[92:95], v5, s[12:15], s51 offen offset:1024 sc1
    s_add_u32 s51, s34, 286720
    buffer_load_dwordx4 v[96:99], v5, s[12:15], s51 offen offset:0 sc1
    buffer_load_dwordx4 v[100:103], v5, s[12:15], s51 offen offset:1024 sc1
    s_add_u32 s51, s34, 28672
    buffer_load_dwordx4 v[104:107], v5, s[12:15], s51 offen offset:0 sc1
    buffer_load_dwordx4 v[108:111], v5, s[12:15], s51 offen offset:1024 sc1
    s_add_u32 s51, s34, 159744
    buffer_load_dwordx4 v[112:115], v5, s[12:15], s51 offen offset:0 sc1
    buffer_load_dwordx4 v[116:119], v5, s[12:15], s51 offen offset:1024 sc1
    s_add_u32 s51, s34, 290816
    buffer_load_dwordx4 v[120:123], v5, s[12:15], s51 offen offset:0 sc1
    buffer_load_dwordx4 v[124:127], v5, s[12:15], s51 offen offset:1024 sc1
    s_mov_b32 s37, 0xbfb8aa3b
    s_waitcnt vmcnt(6)
    v_lshlrev_b32 v12, 16, v80
    v_and_b32 v13, 0xffff0000, v80
    v_lshlrev_b32 v14, 16, v81
    v_and_b32 v15, 0xffff0000, v81
    v_lshlrev_b32 v16, 16, v82
    v_and_b32 v17, 0xffff0000, v82
    v_lshlrev_b32 v18, 16, v83
    v_and_b32 v19, 0xffff0000, v83
    v_lshlrev_b32 v20, 16, v88
    v_and_b32 v21, 0xffff0000, v88
    v_lshlrev_b32 v22, 16, v89
    v_and_b32 v23, 0xffff0000, v89
    v_lshlrev_b32 v24, 16, v90
    v_and_b32 v25, 0xffff0000, v90
    v_lshlrev_b32 v26, 16, v91
    v_and_b32 v27, 0xffff0000, v91
    v_pk_add_f32 v[12:13], v[12:13], v[20:21]
    v_pk_add_f32 v[14:15], v[14:15], v[22:23]
    v_pk_add_f32 v[16:17], v[16:17], v[24:25]
    v_pk_add_f32 v[18:19], v[18:19], v[26:27]
    v_cvt_pk_bf16_f32 v28, v12, v13
    v_cvt_pk_bf16_f32 v29, v14, v15
    v_cvt_pk_bf16_f32 v30, v16, v17
    v_cvt_pk_bf16_f32 v31, v18, v19
    v_lshlrev_b32 v12, 16, v28
    v_and_b32 v13, 0xffff0000, v28
    v_lshlrev_b32 v14, 16, v29
    v_and_b32 v15, 0xffff0000, v29
    v_lshlrev_b32 v16, 16, v30
    v_and_b32 v17, 0xffff0000, v30
    v_lshlrev_b32 v18, 16, v31
    v_and_b32 v19, 0xffff0000, v31
    v_lshlrev_b32 v20, 16, v96
    v_and_b32 v21, 0xffff0000, v96
    v_lshlrev_b32 v22, 16, v97
    v_and_b32 v23, 0xffff0000, v97
    v_lshlrev_b32 v24, 16, v98
    v_and_b32 v25, 0xffff0000, v98
    v_lshlrev_b32 v26, 16, v99
    v_and_b32 v27, 0xffff0000, v99
    v_cvt_pk_bf16_f32 v28, v176, v177
    v_cvt_pk_bf16_f32 v29, v178, v179
    v_cvt_pk_bf16_f32 v30, v180, v181
    v_cvt_pk_bf16_f32 v31, v182, v183
    v_lshlrev_b32 v32, 16, v28
    v_and_b32 v33, 0xffff0000, v28
    v_lshlrev_b32 v34, 16, v29
    v_and_b32 v35, 0xffff0000, v29
    v_lshlrev_b32 v36, 16, v30
    v_and_b32 v37, 0xffff0000, v30
    v_lshlrev_b32 v38, 16, v31
    v_and_b32 v39, 0xffff0000, v31
    v_pk_add_f32 v[20:21], v[20:21], v[32:33]
    v_pk_add_f32 v[22:23], v[22:23], v[34:35]
    v_pk_add_f32 v[24:25], v[24:25], v[36:37]
    v_pk_add_f32 v[26:27], v[26:27], v[38:39]
    v_cvt_pk_bf16_f32 v28, v20, v21
    v_cvt_pk_bf16_f32 v29, v22, v23
    v_cvt_pk_bf16_f32 v30, v24, v25
    v_cvt_pk_bf16_f32 v31, v26, v27
    v_lshlrev_b32 v20, 16, v28
    v_and_b32 v21, 0xffff0000, v28
    v_lshlrev_b32 v22, 16, v29
    v_and_b32 v23, 0xffff0000, v29
    v_lshlrev_b32 v24, 16, v30
    v_and_b32 v25, 0xffff0000, v30
    v_lshlrev_b32 v26, 16, v31
    v_and_b32 v27, 0xffff0000, v31
    v_lshlrev_b32 v28, 16, v72
    v_and_b32 v29, 0xffff0000, v72
    v_lshlrev_b32 v30, 16, v73
    v_and_b32 v31, 0xffff0000, v73
    v_pk_add_f32 v[20:21], v[20:21], v[28:29]
    v_pk_add_f32 v[22:23], v[22:23], v[30:31]
    v_lshlrev_b32 v28, 16, v74
    v_and_b32 v29, 0xffff0000, v74
    v_lshlrev_b32 v30, 16, v75
    v_and_b32 v31, 0xffff0000, v75
    v_pk_add_f32 v[24:25], v[24:25], v[28:29]
    v_pk_add_f32 v[26:27], v[26:27], v[30:31]
    v_cvt_pk_bf16_f32 v28, v20, v21
    v_cvt_pk_bf16_f32 v29, v22, v23
    v_cvt_pk_bf16_f32 v30, v24, v25
    v_cvt_pk_bf16_f32 v31, v26, v27
    v_lshlrev_b32 v20, 16, v28
    v_and_b32 v21, 0xffff0000, v28
    v_lshlrev_b32 v22, 16, v29
    v_and_b32 v23, 0xffff0000, v29
    v_lshlrev_b32 v24, 16, v30
    v_and_b32 v25, 0xffff0000, v30
    v_lshlrev_b32 v26, 16, v31
    v_and_b32 v27, 0xffff0000, v31
    v_mul_f32 v32, s37, v20
    v_mul_f32 v33, s37, v21
    v_mul_f32 v34, s37, v22
    v_mul_f32 v35, s37, v23
    v_mul_f32 v36, s37, v24
    v_mul_f32 v37, s37, v25
    v_mul_f32 v38, s37, v26
    v_mul_f32 v39, s37, v27
    v_exp_f32 v32, v32
    v_exp_f32 v33, v33
    v_exp_f32 v34, v34
    v_exp_f32 v35, v35
    v_exp_f32 v36, v36
    v_exp_f32 v37, v37
    v_exp_f32 v38, v38
    v_exp_f32 v39, v39
    v_add_f32 v32, 1.0, v32
    v_add_f32 v33, 1.0, v33
    v_add_f32 v34, 1.0, v34
    v_add_f32 v35, 1.0, v35
    v_add_f32 v36, 1.0, v36
    v_add_f32 v37, 1.0, v37
    v_add_f32 v38, 1.0, v38
    v_add_f32 v39, 1.0, v39
    v_rcp_f32 v32, v32
    v_rcp_f32 v33, v33
    v_rcp_f32 v34, v34
    v_rcp_f32 v35, v35
    v_rcp_f32 v36, v36
    v_rcp_f32 v37, v37
    v_rcp_f32 v38, v38
    v_rcp_f32 v39, v39
    v_pk_mul_f32 v[20:21], v[20:21], v[32:33]
    v_pk_mul_f32 v[22:23], v[22:23], v[34:35]
    v_pk_mul_f32 v[24:25], v[24:25], v[36:37]
    v_pk_mul_f32 v[26:27], v[26:27], v[38:39]
    v_cvt_pk_bf16_f32 v28, v20, v21
    v_cvt_pk_bf16_f32 v29, v22, v23
    v_cvt_pk_bf16_f32 v30, v24, v25
    v_cvt_pk_bf16_f32 v31, v26, v27
    v_lshlrev_b32 v20, 16, v28
    v_and_b32 v21, 0xffff0000, v28
    v_lshlrev_b32 v22, 16, v29
    v_and_b32 v23, 0xffff0000, v29
    v_lshlrev_b32 v24, 16, v30
    v_and_b32 v25, 0xffff0000, v30
    v_lshlrev_b32 v26, 16, v31
    v_and_b32 v27, 0xffff0000, v31
    v_pk_mul_f32 v[12:13], v[12:13], v[20:21]
    v_pk_mul_f32 v[14:15], v[14:15], v[22:23]
    v_pk_mul_f32 v[16:17], v[16:17], v[24:25]
    v_pk_mul_f32 v[18:19], v[18:19], v[26:27]
    v_cvt_pk_bf16_f32 v28, v12, v13
    v_cvt_pk_bf16_f32 v29, v14, v15
    v_cvt_pk_bf16_f32 v30, v16, v17
    v_cvt_pk_bf16_f32 v31, v18, v19
    v_lshlrev_b32 v12, 16, v28
    v_and_b32 v13, 0xffff0000, v28
    v_lshlrev_b32 v14, 16, v29
    v_and_b32 v15, 0xffff0000, v29
    v_lshlrev_b32 v16, 16, v30
    v_and_b32 v17, 0xffff0000, v30
    v_lshlrev_b32 v18, 16, v31
    v_and_b32 v19, 0xffff0000, v31
    v_lshlrev_b32 v20, 16, v240
    v_and_b32 v21, 0xffff0000, v240
    v_lshlrev_b32 v22, 16, v241
    v_and_b32 v23, 0xffff0000, v241
    v_lshlrev_b32 v24, 16, v242
    v_and_b32 v25, 0xffff0000, v242
    v_lshlrev_b32 v26, 16, v243
    v_and_b32 v27, 0xffff0000, v243
    v_pk_add_f32 v[12:13], v[12:13], v[20:21]
    v_pk_add_f32 v[14:15], v[14:15], v[22:23]
    v_pk_add_f32 v[16:17], v[16:17], v[24:25]
    v_pk_add_f32 v[18:19], v[18:19], v[26:27]
    v_cvt_pk_bf16_f32 v40, v12, v13
    v_cvt_pk_bf16_f32 v41, v14, v15
    v_cvt_pk_bf16_f32 v42, v16, v17
    v_cvt_pk_bf16_f32 v43, v18, v19
    s_mov_b32 s51, 0
    s_nop 0
    v_permlane16_swap_b32 v40, v42
    v_permlane16_swap_b32 v41, v43
    buffer_store_dwordx4 v[40:43], v9, s[72:75], s51 offen offset:0
    v_lshlrev_b32 v12, 16, v84
    v_and_b32 v13, 0xffff0000, v84
    v_lshlrev_b32 v14, 16, v85
    v_and_b32 v15, 0xffff0000, v85
    v_lshlrev_b32 v16, 16, v86
    v_and_b32 v17, 0xffff0000, v86
    v_lshlrev_b32 v18, 16, v87
    v_and_b32 v19, 0xffff0000, v87
    v_lshlrev_b32 v20, 16, v92
    v_and_b32 v21, 0xffff0000, v92
    v_lshlrev_b32 v22, 16, v93
    v_and_b32 v23, 0xffff0000, v93
    v_lshlrev_b32 v24, 16, v94
    v_and_b32 v25, 0xffff0000, v94
    v_lshlrev_b32 v26, 16, v95
    v_and_b32 v27, 0xffff0000, v95
    v_pk_add_f32 v[12:13], v[12:13], v[20:21]
    v_pk_add_f32 v[14:15], v[14:15], v[22:23]
    v_pk_add_f32 v[16:17], v[16:17], v[24:25]
    v_pk_add_f32 v[18:19], v[18:19], v[26:27]
    v_cvt_pk_bf16_f32 v28, v12, v13
    v_cvt_pk_bf16_f32 v29, v14, v15
    v_cvt_pk_bf16_f32 v30, v16, v17
    v_cvt_pk_bf16_f32 v31, v18, v19
    v_lshlrev_b32 v12, 16, v28
    v_and_b32 v13, 0xffff0000, v28
    v_lshlrev_b32 v14, 16, v29
    v_and_b32 v15, 0xffff0000, v29
    v_lshlrev_b32 v16, 16, v30
    v_and_b32 v17, 0xffff0000, v30
    v_lshlrev_b32 v18, 16, v31
    v_and_b32 v19, 0xffff0000, v31
    v_lshlrev_b32 v20, 16, v100
    v_and_b32 v21, 0xffff0000, v100
    v_lshlrev_b32 v22, 16, v101
    v_and_b32 v23, 0xffff0000, v101
    v_lshlrev_b32 v24, 16, v102
    v_and_b32 v25, 0xffff0000, v102
    v_lshlrev_b32 v26, 16, v103
    v_and_b32 v27, 0xffff0000, v103
    v_cvt_pk_bf16_f32 v28, v184, v185
    v_cvt_pk_bf16_f32 v29, v186, v187
    v_cvt_pk_bf16_f32 v30, v188, v189
    v_cvt_pk_bf16_f32 v31, v190, v191
    v_lshlrev_b32 v32, 16, v28
    v_and_b32 v33, 0xffff0000, v28
    v_lshlrev_b32 v34, 16, v29
    v_and_b32 v35, 0xffff0000, v29
    v_lshlrev_b32 v36, 16, v30
    v_and_b32 v37, 0xffff0000, v30
    v_lshlrev_b32 v38, 16, v31
    v_and_b32 v39, 0xffff0000, v31
    v_pk_add_f32 v[20:21], v[20:21], v[32:33]
    v_pk_add_f32 v[22:23], v[22:23], v[34:35]
    v_pk_add_f32 v[24:25], v[24:25], v[36:37]
    v_pk_add_f32 v[26:27], v[26:27], v[38:39]
    v_cvt_pk_bf16_f32 v28, v20, v21
    v_cvt_pk_bf16_f32 v29, v22, v23
    v_cvt_pk_bf16_f32 v30, v24, v25
    v_cvt_pk_bf16_f32 v31, v26, v27
    v_lshlrev_b32 v20, 16, v28
    v_and_b32 v21, 0xffff0000, v28
    v_lshlrev_b32 v22, 16, v29
    v_and_b32 v23, 0xffff0000, v29
    v_lshlrev_b32 v24, 16, v30
    v_and_b32 v25, 0xffff0000, v30
    v_lshlrev_b32 v26, 16, v31
    v_and_b32 v27, 0xffff0000, v31
    v_lshlrev_b32 v28, 16, v76
    v_and_b32 v29, 0xffff0000, v76
    v_lshlrev_b32 v30, 16, v77
    v_and_b32 v31, 0xffff0000, v77
    v_pk_add_f32 v[20:21], v[20:21], v[28:29]
    v_pk_add_f32 v[22:23], v[22:23], v[30:31]
    v_lshlrev_b32 v28, 16, v78
    v_and_b32 v29, 0xffff0000, v78
    v_lshlrev_b32 v30, 16, v79
    v_and_b32 v31, 0xffff0000, v79
    v_pk_add_f32 v[24:25], v[24:25], v[28:29]
    v_pk_add_f32 v[26:27], v[26:27], v[30:31]
    v_cvt_pk_bf16_f32 v28, v20, v21
    v_cvt_pk_bf16_f32 v29, v22, v23
    v_cvt_pk_bf16_f32 v30, v24, v25
    v_cvt_pk_bf16_f32 v31, v26, v27
    v_lshlrev_b32 v20, 16, v28
    v_and_b32 v21, 0xffff0000, v28
    v_lshlrev_b32 v22, 16, v29
    v_and_b32 v23, 0xffff0000, v29
    v_lshlrev_b32 v24, 16, v30
    v_and_b32 v25, 0xffff0000, v30
    v_lshlrev_b32 v26, 16, v31
    v_and_b32 v27, 0xffff0000, v31
    v_mul_f32 v32, s37, v20
    v_mul_f32 v33, s37, v21
    v_mul_f32 v34, s37, v22
    v_mul_f32 v35, s37, v23
    v_mul_f32 v36, s37, v24
    v_mul_f32 v37, s37, v25
    v_mul_f32 v38, s37, v26
    v_mul_f32 v39, s37, v27
    v_exp_f32 v32, v32
    v_exp_f32 v33, v33
    v_exp_f32 v34, v34
    v_exp_f32 v35, v35
    v_exp_f32 v36, v36
    v_exp_f32 v37, v37
    v_exp_f32 v38, v38
    v_exp_f32 v39, v39
    v_add_f32 v32, 1.0, v32
    v_add_f32 v33, 1.0, v33
    v_add_f32 v34, 1.0, v34
    v_add_f32 v35, 1.0, v35
    v_add_f32 v36, 1.0, v36
    v_add_f32 v37, 1.0, v37
    v_add_f32 v38, 1.0, v38
    v_add_f32 v39, 1.0, v39
    v_rcp_f32 v32, v32
    v_rcp_f32 v33, v33
    v_rcp_f32 v34, v34
    v_rcp_f32 v35, v35
    v_rcp_f32 v36, v36
    v_rcp_f32 v37, v37
    v_rcp_f32 v38, v38
    v_rcp_f32 v39, v39
    v_pk_mul_f32 v[20:21], v[20:21], v[32:33]
    v_pk_mul_f32 v[22:23], v[22:23], v[34:35]
    v_pk_mul_f32 v[24:25], v[24:25], v[36:37]
    v_pk_mul_f32 v[26:27], v[26:27], v[38:39]
    v_cvt_pk_bf16_f32 v28, v20, v21
    v_cvt_pk_bf16_f32 v29, v22, v23
    v_cvt_pk_bf16_f32 v30, v24, v25
    v_cvt_pk_bf16_f32 v31, v26, v27
    v_lshlrev_b32 v20, 16, v28
    v_and_b32 v21, 0xffff0000, v28
    v_lshlrev_b32 v22, 16, v29
    v_and_b32 v23, 0xffff0000, v29
    v_lshlrev_b32 v24, 16, v30
    v_and_b32 v25, 0xffff0000, v30
    v_lshlrev_b32 v26, 16, v31
    v_and_b32 v27, 0xffff0000, v31
    v_pk_mul_f32 v[12:13], v[12:13], v[20:21]
    v_pk_mul_f32 v[14:15], v[14:15], v[22:23]
    v_pk_mul_f32 v[16:17], v[16:17], v[24:25]
    v_pk_mul_f32 v[18:19], v[18:19], v[26:27]
    v_cvt_pk_bf16_f32 v28, v12, v13
    v_cvt_pk_bf16_f32 v29, v14, v15
    v_cvt_pk_bf16_f32 v30, v16, v17
    v_cvt_pk_bf16_f32 v31, v18, v19
    v_lshlrev_b32 v12, 16, v28
    v_and_b32 v13, 0xffff0000, v28
    v_lshlrev_b32 v14, 16, v29
    v_and_b32 v15, 0xffff0000, v29
    v_lshlrev_b32 v16, 16, v30
    v_and_b32 v17, 0xffff0000, v30
    v_lshlrev_b32 v18, 16, v31
    v_and_b32 v19, 0xffff0000, v31
    v_lshlrev_b32 v20, 16, v244
    v_and_b32 v21, 0xffff0000, v244
    v_lshlrev_b32 v22, 16, v245
    v_and_b32 v23, 0xffff0000, v245
    v_lshlrev_b32 v24, 16, v246
    v_and_b32 v25, 0xffff0000, v246
    v_lshlrev_b32 v26, 16, v247
    v_and_b32 v27, 0xffff0000, v247
    v_pk_add_f32 v[12:13], v[12:13], v[20:21]
    v_pk_add_f32 v[14:15], v[14:15], v[22:23]
    v_pk_add_f32 v[16:17], v[16:17], v[24:25]
    v_pk_add_f32 v[18:19], v[18:19], v[26:27]
    v_cvt_pk_bf16_f32 v44, v12, v13
    v_cvt_pk_bf16_f32 v45, v14, v15
    v_cvt_pk_bf16_f32 v46, v16, v17
    v_cvt_pk_bf16_f32 v47, v18, v19
    s_mov_b32 s51, 0
    s_nop 0
    v_permlane16_swap_b32 v44, v46
    v_permlane16_swap_b32 v45, v47
    buffer_store_dwordx4 v[44:47], v9, s[72:75], s51 offen offset:64
    s_waitcnt vmcnt(2)
    v_lshlrev_b32 v12, 16, v104
    v_and_b32 v13, 0xffff0000, v104
    v_lshlrev_b32 v14, 16, v105
    v_and_b32 v15, 0xffff0000, v105
    v_lshlrev_b32 v16, 16, v106
    v_and_b32 v17, 0xffff0000, v106
    v_lshlrev_b32 v18, 16, v107
    v_and_b32 v19, 0xffff0000, v107
    v_lshlrev_b32 v20, 16, v112
    v_and_b32 v21, 0xffff0000, v112
    v_lshlrev_b32 v22, 16, v113
    v_and_b32 v23, 0xffff0000, v113
    v_lshlrev_b32 v24, 16, v114
    v_and_b32 v25, 0xffff0000, v114
    v_lshlrev_b32 v26, 16, v115
    v_and_b32 v27, 0xffff0000, v115
    v_pk_add_f32 v[12:13], v[12:13], v[20:21]
    v_pk_add_f32 v[14:15], v[14:15], v[22:23]
    v_pk_add_f32 v[16:17], v[16:17], v[24:25]
    v_pk_add_f32 v[18:19], v[18:19], v[26:27]
    v_cvt_pk_bf16_f32 v28, v12, v13
    v_cvt_pk_bf16_f32 v29, v14, v15
    v_cvt_pk_bf16_f32 v30, v16, v17
    v_cvt_pk_bf16_f32 v31, v18, v19
    v_lshlrev_b32 v12, 16, v28
    v_and_b32 v13, 0xffff0000, v28
    v_lshlrev_b32 v14, 16, v29
    v_and_b32 v15, 0xffff0000, v29
    v_lshlrev_b32 v16, 16, v30
    v_and_b32 v17, 0xffff0000, v30
    v_lshlrev_b32 v18, 16, v31
    v_and_b32 v19, 0xffff0000, v31
    v_lshlrev_b32 v20, 16, v120
    v_and_b32 v21, 0xffff0000, v120
    v_lshlrev_b32 v22, 16, v121
    v_and_b32 v23, 0xffff0000, v121
    v_lshlrev_b32 v24, 16, v122
    v_and_b32 v25, 0xffff0000, v122
    v_lshlrev_b32 v26, 16, v123
    v_and_b32 v27, 0xffff0000, v123
    v_cvt_pk_bf16_f32 v28, v192, v193
    v_cvt_pk_bf16_f32 v29, v194, v195
    v_cvt_pk_bf16_f32 v30, v196, v197
    v_cvt_pk_bf16_f32 v31, v198, v199
    v_lshlrev_b32 v32, 16, v28
    v_and_b32 v33, 0xffff0000, v28
    v_lshlrev_b32 v34, 16, v29
    v_and_b32 v35, 0xffff0000, v29
    v_lshlrev_b32 v36, 16, v30
    v_and_b32 v37, 0xffff0000, v30
    v_lshlrev_b32 v38, 16, v31
    v_and_b32 v39, 0xffff0000, v31
    v_pk_add_f32 v[20:21], v[20:21], v[32:33]
    v_pk_add_f32 v[22:23], v[22:23], v[34:35]
    v_pk_add_f32 v[24:25], v[24:25], v[36:37]
    v_pk_add_f32 v[26:27], v[26:27], v[38:39]
    v_cvt_pk_bf16_f32 v28, v20, v21
    v_cvt_pk_bf16_f32 v29, v22, v23
    v_cvt_pk_bf16_f32 v30, v24, v25
    v_cvt_pk_bf16_f32 v31, v26, v27
    v_lshlrev_b32 v20, 16, v28
    v_and_b32 v21, 0xffff0000, v28
    v_lshlrev_b32 v22, 16, v29
    v_and_b32 v23, 0xffff0000, v29
    v_lshlrev_b32 v24, 16, v30
    v_and_b32 v25, 0xffff0000, v30
    v_lshlrev_b32 v26, 16, v31
    v_and_b32 v27, 0xffff0000, v31
    v_lshlrev_b32 v28, 16, v72
    v_and_b32 v29, 0xffff0000, v72
    v_lshlrev_b32 v30, 16, v73
    v_and_b32 v31, 0xffff0000, v73
    v_pk_add_f32 v[20:21], v[20:21], v[28:29]
    v_pk_add_f32 v[22:23], v[22:23], v[30:31]
    v_lshlrev_b32 v28, 16, v74
    v_and_b32 v29, 0xffff0000, v74
    v_lshlrev_b32 v30, 16, v75
    v_and_b32 v31, 0xffff0000, v75
    v_pk_add_f32 v[24:25], v[24:25], v[28:29]
    v_pk_add_f32 v[26:27], v[26:27], v[30:31]
    v_cvt_pk_bf16_f32 v28, v20, v21
    v_cvt_pk_bf16_f32 v29, v22, v23
    v_cvt_pk_bf16_f32 v30, v24, v25
    v_cvt_pk_bf16_f32 v31, v26, v27
    v_lshlrev_b32 v20, 16, v28
    v_and_b32 v21, 0xffff0000, v28
    v_lshlrev_b32 v22, 16, v29
    v_and_b32 v23, 0xffff0000, v29
    v_lshlrev_b32 v24, 16, v30
    v_and_b32 v25, 0xffff0000, v30
    v_lshlrev_b32 v26, 16, v31
    v_and_b32 v27, 0xffff0000, v31
    v_mul_f32 v32, s37, v20
    v_mul_f32 v33, s37, v21
    v_mul_f32 v34, s37, v22
    v_mul_f32 v35, s37, v23
    v_mul_f32 v36, s37, v24
    v_mul_f32 v37, s37, v25
    v_mul_f32 v38, s37, v26
    v_mul_f32 v39, s37, v27
    v_exp_f32 v32, v32
    v_exp_f32 v33, v33
    v_exp_f32 v34, v34
    v_exp_f32 v35, v35
    v_exp_f32 v36, v36
    v_exp_f32 v37, v37
    v_exp_f32 v38, v38
    v_exp_f32 v39, v39
    v_add_f32 v32, 1.0, v32
    v_add_f32 v33, 1.0, v33
    v_add_f32 v34, 1.0, v34
    v_add_f32 v35, 1.0, v35
    v_add_f32 v36, 1.0, v36
    v_add_f32 v37, 1.0, v37
    v_add_f32 v38, 1.0, v38
    v_add_f32 v39, 1.0, v39
    v_rcp_f32 v32, v32
    v_rcp_f32 v33, v33
    v_rcp_f32 v34, v34
    v_rcp_f32 v35, v35
    v_rcp_f32 v36, v36
    v_rcp_f32 v37, v37
    v_rcp_f32 v38, v38
    v_rcp_f32 v39, v39
    v_pk_mul_f32 v[20:21], v[20:21], v[32:33]
    v_pk_mul_f32 v[22:23], v[22:23], v[34:35]
    v_pk_mul_f32 v[24:25], v[24:25], v[36:37]
    v_pk_mul_f32 v[26:27], v[26:27], v[38:39]
    v_cvt_pk_bf16_f32 v28, v20, v21
    v_cvt_pk_bf16_f32 v29, v22, v23
    v_cvt_pk_bf16_f32 v30, v24, v25
    v_cvt_pk_bf16_f32 v31, v26, v27
    v_lshlrev_b32 v20, 16, v28
    v_and_b32 v21, 0xffff0000, v28
    v_lshlrev_b32 v22, 16, v29
    v_and_b32 v23, 0xffff0000, v29
    v_lshlrev_b32 v24, 16, v30
    v_and_b32 v25, 0xffff0000, v30
    v_lshlrev_b32 v26, 16, v31
    v_and_b32 v27, 0xffff0000, v31
    v_pk_mul_f32 v[12:13], v[12:13], v[20:21]
    v_pk_mul_f32 v[14:15], v[14:15], v[22:23]
    v_pk_mul_f32 v[16:17], v[16:17], v[24:25]
    v_pk_mul_f32 v[18:19], v[18:19], v[26:27]
    v_cvt_pk_bf16_f32 v28, v12, v13
    v_cvt_pk_bf16_f32 v29, v14, v15
    v_cvt_pk_bf16_f32 v30, v16, v17
    v_cvt_pk_bf16_f32 v31, v18, v19
    v_lshlrev_b32 v12, 16, v28
    v_and_b32 v13, 0xffff0000, v28
    v_lshlrev_b32 v14, 16, v29
    v_and_b32 v15, 0xffff0000, v29
    v_lshlrev_b32 v16, 16, v30
    v_and_b32 v17, 0xffff0000, v30
    v_lshlrev_b32 v18, 16, v31
    v_and_b32 v19, 0xffff0000, v31
    v_lshlrev_b32 v20, 16, v248
    v_and_b32 v21, 0xffff0000, v248
    v_lshlrev_b32 v22, 16, v249
    v_and_b32 v23, 0xffff0000, v249
    v_lshlrev_b32 v24, 16, v250
    v_and_b32 v25, 0xffff0000, v250
    v_lshlrev_b32 v26, 16, v251
    v_and_b32 v27, 0xffff0000, v251
    v_pk_add_f32 v[12:13], v[12:13], v[20:21]
    v_pk_add_f32 v[14:15], v[14:15], v[22:23]
    v_pk_add_f32 v[16:17], v[16:17], v[24:25]
    v_pk_add_f32 v[18:19], v[18:19], v[26:27]
    v_cvt_pk_bf16_f32 v48, v12, v13
    v_cvt_pk_bf16_f32 v49, v14, v15
    v_cvt_pk_bf16_f32 v50, v16, v17
    v_cvt_pk_bf16_f32 v51, v18, v19
    s_mov_b32 s51, 32768
    s_nop 0
    v_permlane16_swap_b32 v48, v50
    v_permlane16_swap_b32 v49, v51
    buffer_store_dwordx4 v[48:51], v9, s[72:75], s51 offen offset:0
    v_lshlrev_b32 v12, 16, v108
    v_and_b32 v13, 0xffff0000, v108
    v_lshlrev_b32 v14, 16, v109
    v_and_b32 v15, 0xffff0000, v109
    v_lshlrev_b32 v16, 16, v110
    v_and_b32 v17, 0xffff0000, v110
    v_lshlrev_b32 v18, 16, v111
    v_and_b32 v19, 0xffff0000, v111
    v_lshlrev_b32 v20, 16, v116
    v_and_b32 v21, 0xffff0000, v116
    v_lshlrev_b32 v22, 16, v117
    v_and_b32 v23, 0xffff0000, v117
    v_lshlrev_b32 v24, 16, v118
    v_and_b32 v25, 0xffff0000, v118
    v_lshlrev_b32 v26, 16, v119
    v_and_b32 v27, 0xffff0000, v119
    v_pk_add_f32 v[12:13], v[12:13], v[20:21]
    v_pk_add_f32 v[14:15], v[14:15], v[22:23]
    v_pk_add_f32 v[16:17], v[16:17], v[24:25]
    v_pk_add_f32 v[18:19], v[18:19], v[26:27]
    v_cvt_pk_bf16_f32 v28, v12, v13
    v_cvt_pk_bf16_f32 v29, v14, v15
    v_cvt_pk_bf16_f32 v30, v16, v17
    v_cvt_pk_bf16_f32 v31, v18, v19
    v_lshlrev_b32 v12, 16, v28
    v_and_b32 v13, 0xffff0000, v28
    v_lshlrev_b32 v14, 16, v29
    v_and_b32 v15, 0xffff0000, v29
    v_lshlrev_b32 v16, 16, v30
    v_and_b32 v17, 0xffff0000, v30
    v_lshlrev_b32 v18, 16, v31
    v_and_b32 v19, 0xffff0000, v31
    v_lshlrev_b32 v20, 16, v124
    v_and_b32 v21, 0xffff0000, v124
    v_lshlrev_b32 v22, 16, v125
    v_and_b32 v23, 0xffff0000, v125
    v_lshlrev_b32 v24, 16, v126
    v_and_b32 v25, 0xffff0000, v126
    v_lshlrev_b32 v26, 16, v127
    v_and_b32 v27, 0xffff0000, v127
    v_cvt_pk_bf16_f32 v28, v200, v201
    v_cvt_pk_bf16_f32 v29, v202, v203
    v_cvt_pk_bf16_f32 v30, v204, v205
    v_cvt_pk_bf16_f32 v31, v206, v207
    v_lshlrev_b32 v32, 16, v28
    v_and_b32 v33, 0xffff0000, v28
    v_lshlrev_b32 v34, 16, v29
    v_and_b32 v35, 0xffff0000, v29
    v_lshlrev_b32 v36, 16, v30
    v_and_b32 v37, 0xffff0000, v30
    v_lshlrev_b32 v38, 16, v31
    v_and_b32 v39, 0xffff0000, v31
    v_pk_add_f32 v[20:21], v[20:21], v[32:33]
    v_pk_add_f32 v[22:23], v[22:23], v[34:35]
    v_pk_add_f32 v[24:25], v[24:25], v[36:37]
    v_pk_add_f32 v[26:27], v[26:27], v[38:39]
    v_cvt_pk_bf16_f32 v28, v20, v21
    v_cvt_pk_bf16_f32 v29, v22, v23
    v_cvt_pk_bf16_f32 v30, v24, v25
    v_cvt_pk_bf16_f32 v31, v26, v27
    v_lshlrev_b32 v20, 16, v28
    v_and_b32 v21, 0xffff0000, v28
    v_lshlrev_b32 v22, 16, v29
    v_and_b32 v23, 0xffff0000, v29
    v_lshlrev_b32 v24, 16, v30
    v_and_b32 v25, 0xffff0000, v30
    v_lshlrev_b32 v26, 16, v31
    v_and_b32 v27, 0xffff0000, v31
    v_lshlrev_b32 v28, 16, v76
    v_and_b32 v29, 0xffff0000, v76
    v_lshlrev_b32 v30, 16, v77
    v_and_b32 v31, 0xffff0000, v77
    v_pk_add_f32 v[20:21], v[20:21], v[28:29]
    v_pk_add_f32 v[22:23], v[22:23], v[30:31]
    v_lshlrev_b32 v28, 16, v78
    v_and_b32 v29, 0xffff0000, v78
    v_lshlrev_b32 v30, 16, v79
    v_and_b32 v31, 0xffff0000, v79
    v_pk_add_f32 v[24:25], v[24:25], v[28:29]
    v_pk_add_f32 v[26:27], v[26:27], v[30:31]
    v_cvt_pk_bf16_f32 v28, v20, v21
    v_cvt_pk_bf16_f32 v29, v22, v23
    v_cvt_pk_bf16_f32 v30, v24, v25
    v_cvt_pk_bf16_f32 v31, v26, v27
    v_lshlrev_b32 v20, 16, v28
    v_and_b32 v21, 0xffff0000, v28
    v_lshlrev_b32 v22, 16, v29
    v_and_b32 v23, 0xffff0000, v29
    v_lshlrev_b32 v24, 16, v30
    v_and_b32 v25, 0xffff0000, v30
    v_lshlrev_b32 v26, 16, v31
    v_and_b32 v27, 0xffff0000, v31
    v_mul_f32 v32, s37, v20
    v_mul_f32 v33, s37, v21
    v_mul_f32 v34, s37, v22
    v_mul_f32 v35, s37, v23
    v_mul_f32 v36, s37, v24
    v_mul_f32 v37, s37, v25
    v_mul_f32 v38, s37, v26
    v_mul_f32 v39, s37, v27
    v_exp_f32 v32, v32
    v_exp_f32 v33, v33
    v_exp_f32 v34, v34
    v_exp_f32 v35, v35
    v_exp_f32 v36, v36
    v_exp_f32 v37, v37
    v_exp_f32 v38, v38
    v_exp_f32 v39, v39
    v_add_f32 v32, 1.0, v32
    v_add_f32 v33, 1.0, v33
    v_add_f32 v34, 1.0, v34
    v_add_f32 v35, 1.0, v35
    v_add_f32 v36, 1.0, v36
    v_add_f32 v37, 1.0, v37
    v_add_f32 v38, 1.0, v38
    v_add_f32 v39, 1.0, v39
    v_rcp_f32 v32, v32
    v_rcp_f32 v33, v33
    v_rcp_f32 v34, v34
    v_rcp_f32 v35, v35
    v_rcp_f32 v36, v36
    v_rcp_f32 v37, v37
    v_rcp_f32 v38, v38
    v_rcp_f32 v39, v39
    v_pk_mul_f32 v[20:21], v[20:21], v[32:33]
    v_pk_mul_f32 v[22:23], v[22:23], v[34:35]
    v_pk_mul_f32 v[24:25], v[24:25], v[36:37]
    v_pk_mul_f32 v[26:27], v[26:27], v[38:39]
    v_cvt_pk_bf16_f32 v28, v20, v21
    v_cvt_pk_bf16_f32 v29, v22, v23
    v_cvt_pk_bf16_f32 v30, v24, v25
    v_cvt_pk_bf16_f32 v31, v26, v27
    v_lshlrev_b32 v20, 16, v28
    v_and_b32 v21, 0xffff0000, v28
    v_lshlrev_b32 v22, 16, v29
    v_and_b32 v23, 0xffff0000, v29
    v_lshlrev_b32 v24, 16, v30
    v_and_b32 v25, 0xffff0000, v30
    v_lshlrev_b32 v26, 16, v31
    v_and_b32 v27, 0xffff0000, v31
    v_pk_mul_f32 v[12:13], v[12:13], v[20:21]
    v_pk_mul_f32 v[14:15], v[14:15], v[22:23]
    v_pk_mul_f32 v[16:17], v[16:17], v[24:25]
    v_pk_mul_f32 v[18:19], v[18:19], v[26:27]
    v_cvt_pk_bf16_f32 v28, v12, v13
    v_cvt_pk_bf16_f32 v29, v14, v15
    v_cvt_pk_bf16_f32 v30, v16, v17
    v_cvt_pk_bf16_f32 v31, v18, v19
    v_lshlrev_b32 v12, 16, v28
    v_and_b32 v13, 0xffff0000, v28
    v_lshlrev_b32 v14, 16, v29
    v_and_b32 v15, 0xffff0000, v29
    v_lshlrev_b32 v16, 16, v30
    v_and_b32 v17, 0xffff0000, v30
    v_lshlrev_b32 v18, 16, v31
    v_and_b32 v19, 0xffff0000, v31
    v_lshlrev_b32 v20, 16, v252
    v_and_b32 v21, 0xffff0000, v252
    v_lshlrev_b32 v22, 16, v253
    v_and_b32 v23, 0xffff0000, v253
    v_lshlrev_b32 v24, 16, v254
    v_and_b32 v25, 0xffff0000, v254
    v_lshlrev_b32 v26, 16, v255
    v_and_b32 v27, 0xffff0000, v255
    v_pk_add_f32 v[12:13], v[12:13], v[20:21]
    v_pk_add_f32 v[14:15], v[14:15], v[22:23]
    v_pk_add_f32 v[16:17], v[16:17], v[24:25]
    v_pk_add_f32 v[18:19], v[18:19], v[26:27]
    v_cvt_pk_bf16_f32 v52, v12, v13
    v_cvt_pk_bf16_f32 v53, v14, v15
    v_cvt_pk_bf16_f32 v54, v16, v17
    v_cvt_pk_bf16_f32 v55, v18, v19
    s_mov_b32 s51, 32768
    s_nop 0
    v_permlane16_swap_b32 v52, v54
    v_permlane16_swap_b32 v53, v55
    buffer_store_dwordx4 v[52:55], v9, s[72:75], s51 offen offset:64
    s_endpgm
k_done:
    s_endpgm
.section .rodata,"a"
.p2align 6
.amdhsa_kernel recurrent_scan__spectral_fnet__dense_activation_gelu__prompt_kernel
  .amdhsa_next_free_vgpr 256
  .amdhsa_next_free_sgpr 102
  .amdhsa_accum_offset 256
  .amdhsa_group_segment_fixed_size 0
  .amdhsa_kernarg_size 104
  .amdhsa_user_sgpr_count 2
  .amdhsa_user_sgpr_kernarg_segment_ptr 1
  .amdhsa_system_sgpr_workgroup_id_x 1
.end_amdhsa_kernel
.text
```
